```python
import torch

def _softmax(x, axis=-1):
    return torch.softmax(x, dim=axis)
def _gelu(x):
    return torch.nn.functional.gelu(x, approximate="tanh")
def _silu(x):
    return torch.nn.functional.silu(x)
def _sigmoid(x):
    return torch.sigmoid(x)
def _layernorm(x, axis=-1, eps=1e-5):
    m = x.mean(dim=axis, keepdim=True)
    v = x.var(dim=axis, keepdim=True, unbiased=False)
    return (x - m) / torch.sqrt(v + eps)
def _scatter_add(tgt, idx, src, axis=0):
    return tgt.clone().index_add_(axis, idx, src)
def _segment_sum(src, seg, n):
    out = torch.zeros((n,) + src.shape[1:], dtype=src.dtype)
    return out.index_add_(0, seg, src)
def _pad(x, pw):
    flat = tuple(v for pair in reversed(pw) for v in pair)
    return torch.nn.functional.pad(x, flat)

kernel_name = 'standalone__mha_block_cached__near_ridge'

def setup_inputs():

    _w = (lambda a: (lambda t: t.to(torch.bfloat16) if t.is_floating_point() else t)(torch.as_tensor(a)))
    B, Sq, D = 16, 96, 512
    H, Sk, Dh = 32, 1024, 128
    return {
        "x": _w((lambda *s: torch.randn(*s, dtype=torch.bfloat16) * 0.8)(B, Sq, D)),
        "k_cache": _w((lambda *s: torch.randn(*s, dtype=torch.bfloat16) * 0.8)(B, H, Sk, Dh)),
        "v_cache": _w((lambda *s: torch.randn(*s, dtype=torch.bfloat16) * 0.05)(B, H, Sk, Dh)),
        "wq": _w((lambda *s: torch.randn(*s, dtype=torch.bfloat16) * 0.8)(D, H * Dh) * (D ** -0.5)),
        "wo": _w((lambda *s: torch.randn(*s, dtype=torch.bfloat16) * 0.05)(H * Dh, D) * ((H * Dh) ** -0.5)),
    }

def reference(x, k_cache, v_cache, wq, wo):
    B, Sq, D = x.shape
    H, Dh = 32, 128
    q = (lambda x, *d: x.permute(*d))((x @ wq).reshape(B, Sq, H, Dh), 0, 2, 1, 3)
    scores = torch.einsum("bhqd,bhkd->bhqk", q, k_cache) * (Dh ** -0.5)
    p = _softmax(scores, axis=-1)
    o = torch.einsum("bhqk,bhkd->bhqd", p, v_cache)
    return (lambda x, *d: x.permute(*d))(o, 0, 2, 1, 3).reshape(B, Sq, H * Dh) @ wo
```

```asm
; @launch grid=(256,1,1) block=(256,1,1) lds=163840
.amdgcn_target "amdgcn-amd-amdhsa--gfx950"
.text
.globl standalone__mha_block_cached__near_ridge_kernel
.p2align 8
.type standalone__mha_block_cached__near_ridge_kernel,@function
standalone__mha_block_cached__near_ridge_kernel:

s_cmp_ge_u32 s2, 256
s_cbranch_scc1 L_end
s_load_dwordx16 s[52:67], s[0:1], 0
v_lshrrev_b32 v2, 6, v0
v_and_b32 v1, 63, v0
v_readfirstlane_b32 s40, v2
v_lshrrev_b32 v2, 4, v1
v_and_b32 v3, 15, v1
v_add_u32 v4, 0, v2
v_lshlrev_b32 v4, 1, v4
v_xor_b32 v4, v3, v4
v_lshlrev_b32 v4, 4, v4
v_lshl_add_u32 v16, v2, 13, v4
v_add_u32 v4, 4, v2
v_lshlrev_b32 v4, 1, v4
v_xor_b32 v4, v3, v4
v_lshlrev_b32 v4, 4, v4
v_lshl_add_u32 v33, v2, 13, v4
v_and_b32 v5, 7, v1
v_lshrrev_b32 v6, 3, v1
s_add_u32 s3, s40, 0
s_and_b32 s3, s3, 1
s_lshl_b32 s3, s3, 2
v_add_u32 v4, s3, v2
v_xor_b32 v4, v5, v4
v_lshlrev_b32 v4, 4, v4
v_lshl_add_u32 v17, v6, 10, v4
s_add_u32 s3, s40, 1
s_and_b32 s3, s3, 1
s_lshl_b32 s3, s3, 2
v_add_u32 v4, s3, v2
v_xor_b32 v4, v5, v4
v_lshlrev_b32 v4, 4, v4
v_lshl_add_u32 v9, v6, 10, v4
s_and_b32 s16, s2, 7
s_lshr_b32 s17, s2, 3
s_and_b32 s18, s16, 3
s_lshl_b32 s18, s18, 2
s_and_b32 s3, s17, 3
s_add_u32 s18, s18, s3
s_lshl_b32 s41, s18, 1
s_lshr_b32 s42, s16, 2
s_lshl_b32 s42, s42, 3
s_lshr_b32 s17, s17, 2
s_add_u32 s42, s42, s17
s_add_u32 s3, s3, s17
s_and_b32 s3, s3, 3
s_lshl_b32 s19, s3, 1
s_and_b32 s17, s17, 3
s_lshr_b32 s51, s40, 1
s_and_b32 s43, s40, 1
s_mul_i32 s50, s42, 96
s_mul_i32 s3, s40, 24
s_add_u32 s50, s50, s3
s_lshl_b32 s50, s50, 10
s_waitcnt lgkmcnt(0)
s_mov_b32 s32, s58
s_and_b32 s33, s59, 0xffff
s_mov_b32 s34, 0x400000
s_mov_b32 s35, 0x00020000
s_mov_b32 s20, s52
s_and_b32 s21, s53, 0xffff
s_mov_b32 s22, 0x180000
s_mov_b32 s23, 0x00020000
s_mov_b32 s24, s54
s_and_b32 s25, s55, 0xffff
s_mov_b32 s26, 0x8000000
s_mov_b32 s27, 0x00020000
s_mov_b32 s28, s56
s_and_b32 s29, s57, 0xffff
s_mov_b32 s30, 0x8000000
s_mov_b32 s31, 0x00020000
s_mov_b32 s4, s60
s_and_b32 s5, s61, 0xffff
s_mov_b32 s6, 0x400000
s_mov_b32 s7, 0x00020000
s_mov_b32 s8, s62
s_and_b32 s9, s63, 0xffff
s_mov_b32 s10, 0x180000
s_mov_b32 s11, 0x00020000
s_mov_b32 s12, s64
s_and_b32 s13, s65, 0xffff
s_mov_b32 s14, 0x100
s_mov_b32 s15, 0x00020000
s_mov_b32 s36, s66
s_and_b32 s37, s67, 0xffff
s_mov_b32 s38, 0x20000000
s_mov_b32 s39, 0x00020000
s_mov_b32 s58, s18
s_mov_b32 s52, s19
s_mov_b32 s64, s17
s_lshl_b32 s53, s43, 18
s_add_u32 s3, s41, s51
s_lshl_b32 s3, s3, 8
s_add_u32 s53, s53, s3
s_lshl_b32 s59, s40, 13
s_mul_i32 s60, s40, 3072
s_add_u32 s61, s52, 0
s_and_b32 s61, s61, 7
s_lshl_b32 s62, s61, 7
s_add_u32 s62, s62, s50
s_lshl_b32 s61, s61, 19
s_add_u32 s61, s61, s53
s_add_u32 m0, s59, 28672
s_add_u32 s55, s61, 0
buffer_load_dwordx4 v16, s[32:35], s55 offen lds
s_add_u32 m0, s59, 29696
s_add_u32 s55, s61, 32768
buffer_load_dwordx4 v16, s[32:35], s55 offen lds
s_add_u32 m0, s59, 30720
s_add_u32 s55, s61, 65536
buffer_load_dwordx4 v33, s[32:35], s55 offen lds
s_add_u32 m0, s59, 31744
s_add_u32 s55, s61, 98304
buffer_load_dwordx4 v33, s[32:35], s55 offen lds
s_add_u32 m0, s59, 32768
s_add_u32 s55, s61, 131072
buffer_load_dwordx4 v16, s[32:35], s55 offen lds
s_add_u32 m0, s59, 33792
s_add_u32 s55, s61, 163840
buffer_load_dwordx4 v16, s[32:35], s55 offen lds
s_add_u32 m0, s59, 34816
s_add_u32 s55, s61, 196608
buffer_load_dwordx4 v33, s[32:35], s55 offen lds
s_add_u32 m0, s59, 35840
s_add_u32 s55, s61, 229376
buffer_load_dwordx4 v33, s[32:35], s55 offen lds
s_add_u32 m0, s60, 61440
s_add_u32 s55, s62, 0
buffer_load_dwordx4 v17, s[20:23], s55 offen lds
s_add_u32 m0, s60, 62464
s_add_u32 s55, s62, 8192
buffer_load_dwordx4 v9, s[20:23], s55 offen lds
s_add_u32 m0, s60, 63488
s_add_u32 s55, s62, 16384
buffer_load_dwordx4 v17, s[20:23], s55 offen lds
v_add_u32 v4, 0, v2
v_xor_b32 v4, v3, v4
v_lshlrev_b32 v4, 4, v4
v_lshl_add_u32 v10, v2, 8, v4
v_add_u32 v4, 4, v2
v_xor_b32 v4, v3, v4
v_lshlrev_b32 v4, 4, v4
v_lshl_add_u32 v11, v2, 8, v4
v_add_u32 v4, 8, v2
v_xor_b32 v4, v3, v4
v_lshlrev_b32 v4, 4, v4
v_lshl_add_u32 v12, v2, 8, v4
v_add_u32 v4, 12, v2
v_xor_b32 v4, v3, v4
v_lshlrev_b32 v4, 4, v4
v_lshl_add_u32 v13, v2, 8, v4
v_add_u32 v4, 0, v2
v_lshlrev_b32 v4, 1, v4
v_xor_b32 v4, v3, v4
v_lshlrev_b32 v4, 4, v4
v_lshl_add_u32 v14, v2, 8, v4
v_add_u32 v4, 4, v2
v_lshlrev_b32 v4, 1, v4
v_xor_b32 v4, v3, v4
v_lshlrev_b32 v4, 4, v4
v_lshl_add_u32 v15, v2, 8, v4
s_lshl_b32 s48, s51, 13
s_lshl_b32 s3, s43, 12
s_add_u32 s48, s48, s3
s_lshl_b32 s44, s42, 5
s_add_u32 s44, s44, s41
s_add_u32 s44, s44, s51
s_lshl_b32 s44, s44, 18
s_add_u32 s44, s44, s3
s_mov_b32 s73, s44
v_lshrrev_b32 v5, 2, v3
v_and_b32 v6, 3, v1
s_lshl_b32 s3, s51, 13
v_add_u32 v4, 0, v2
v_xor_b32 v4, v4, v3
v_lshlrev_b32 v4, 4, v4
v_lshl_add_u32 v4, v3, 8, v4
v_add_u32 v18, s3, v4
v_add_u32 v4, 4, v2
v_xor_b32 v4, v4, v3
v_lshlrev_b32 v4, 4, v4
v_lshl_add_u32 v4, v3, 8, v4
v_add_u32 v19, s3, v4
v_add_u32 v4, 8, v2
v_xor_b32 v4, v4, v3
v_lshlrev_b32 v4, 4, v4
v_lshl_add_u32 v4, v3, 8, v4
v_add_u32 v20, s3, v4
v_add_u32 v4, 12, v2
v_xor_b32 v4, v4, v3
v_lshlrev_b32 v4, 4, v4
v_lshl_add_u32 v4, v3, 8, v4
v_add_u32 v21, s3, v4
v_lshl_add_u32 v4, v2, 2, v5
v_and_b32 v0, 7, v4
v_lshlrev_b32 v0, 5, v0
v_lshl_add_u32 v0, v4, 8, v0
v_lshl_add_u32 v0, v6, 3, v0
s_add_u32 s55, s3, 16384
v_add_u32 v22, s55, v0
s_lshl_b32 s3, s51, 14
v_xor_b32 v23, 32, v22
v_xor_b32 v24, 64, v22
v_xor_b32 v25, 96, v22
v_xor_b32 v26, 128, v22
v_xor_b32 v27, 160, v22
v_xor_b32 v28, 192, v22
v_xor_b32 v29, 224, v22
v_and_b32 v7, 1, v2
v_lshl_add_u32 v7, v7, 2, v5
v_lshl_add_u32 v4, v2, 3, v5
v_lshlrev_b32 v4, 8, v4
v_lshl_add_u32 v4, v7, 5, v4
v_lshl_add_u32 v4, v6, 3, v4
v_add_u32 v112, s3, v4
v_xor_b32 v113, 32, v112
v_xor_b32 v114, 64, v112
v_xor_b32 v115, 96, v112
v_xor_b32 v116, 128, v112
v_xor_b32 v117, 160, v112
v_xor_b32 v118, 192, v112
v_xor_b32 v119, 224, v112
v_lshrrev_b32 v4, 1, v3
s_mul_i32 s3, s43, 6144
s_add_u32 s3, s3, 32768
v_add_u32 v5, 0, v2
v_xor_b32 v5, v5, v4
v_lshlrev_b32 v5, 4, v5
v_lshl_add_u32 v5, v3, 7, v5
v_add_u32 v7, s3, v5
v_add_u32 v5, 4, v2
v_xor_b32 v5, v5, v4
v_lshlrev_b32 v5, 4, v5
v_lshl_add_u32 v5, v3, 7, v5
v_add_u32 v8, s3, v5
s_mov_b32 s54, 0x3e0293ee
v_mov_b32 v4, 0x3f803f80
v_accvgpr_write_b32 a60, v4
v_accvgpr_write_b32 a61, v4
v_accvgpr_write_b32 a62, v4
v_accvgpr_write_b32 a63, v4
v_accvgpr_write_b32 a48, 0
v_accvgpr_write_b32 a49, 0
v_accvgpr_write_b32 a50, 0
v_accvgpr_write_b32 a51, 0
v_accvgpr_write_b32 a52, 0
v_accvgpr_write_b32 a53, 0
v_accvgpr_write_b32 a54, 0
v_accvgpr_write_b32 a55, 0
v_accvgpr_write_b32 a56, 0
v_accvgpr_write_b32 a57, 0
v_accvgpr_write_b32 a58, 0
v_accvgpr_write_b32 a59, 0
s_or_b32 s3, s2, s40
s_cmp_eq_u32 s3, 0
s_cbranch_scc0 L_nononce
s_memrealtime s[66:67]
s_waitcnt lgkmcnt(0)
s_or_b32 s66, s66, 1
v_mov_b32 v4, s66
v_mov_b32 v5, s67
v_mov_b32 v6, 0
buffer_store_dwordx2 v[4:5], v6, s[12:15], 0 offen sc1
L_nononce:
s_add_u32 s61, s52, 1
s_and_b32 s61, s61, 7
s_lshl_b32 s62, s61, 7
s_add_u32 s62, s62, s50
s_lshl_b32 s61, s61, 19
s_add_u32 s61, s61, s53
s_add_u32 m0, s59, 73728
s_add_u32 s55, s61, 0
buffer_load_dwordx4 v16, s[32:35], s55 offen lds
s_add_u32 m0, s59, 74752
s_add_u32 s55, s61, 32768
buffer_load_dwordx4 v16, s[32:35], s55 offen lds
s_add_u32 m0, s59, 75776
s_add_u32 s55, s61, 65536
buffer_load_dwordx4 v33, s[32:35], s55 offen lds
s_add_u32 m0, s59, 76800
s_add_u32 s55, s61, 98304
buffer_load_dwordx4 v33, s[32:35], s55 offen lds
s_add_u32 m0, s59, 77824
s_add_u32 s55, s61, 131072
buffer_load_dwordx4 v16, s[32:35], s55 offen lds
s_add_u32 m0, s59, 78848
s_add_u32 s55, s61, 163840
buffer_load_dwordx4 v16, s[32:35], s55 offen lds
s_add_u32 m0, s59, 79872
s_add_u32 s55, s61, 196608
buffer_load_dwordx4 v33, s[32:35], s55 offen lds
s_add_u32 m0, s59, 80896
s_add_u32 s55, s61, 229376
buffer_load_dwordx4 v33, s[32:35], s55 offen lds
s_add_u32 m0, s60, 106496
s_add_u32 s55, s62, 0
buffer_load_dwordx4 v17, s[20:23], s55 offen lds
s_add_u32 m0, s60, 107520
s_add_u32 s55, s62, 8192
buffer_load_dwordx4 v9, s[20:23], s55 offen lds
s_add_u32 m0, s60, 108544
s_add_u32 s55, s62, 16384
buffer_load_dwordx4 v17, s[20:23], s55 offen lds
s_waitcnt vmcnt(11)
s_barrier
v_add_u32 v120, 28672, v112
v_add_u32 v121, 28672, v113
v_add_u32 v122, 28672, v114
v_add_u32 v123, 28672, v115
v_add_u32 v124, 28672, v116
v_add_u32 v125, 28672, v117
v_add_u32 v126, 28672, v118
v_add_u32 v127, 28672, v119
v_add_u32 v41, 28672, v7
v_add_u32 v42, 28672, v8
ds_read_b128 v[52:55], v41 offset:0
ds_read_b128 v[56:59], v41 offset:2048
ds_read_b128 v[60:63], v41 offset:4096
ds_read_b64_tr_b16 a[128:129], v120 offset:0
ds_read_b64_tr_b16 a[130:131], v120 offset:1024
ds_read_b64_tr_b16 a[132:133], v121 offset:0
ds_read_b64_tr_b16 a[134:135], v121 offset:1024
ds_read_b64_tr_b16 a[136:137], v122 offset:0
ds_read_b64_tr_b16 a[138:139], v122 offset:1024
ds_read_b64_tr_b16 a[140:141], v123 offset:0
ds_read_b64_tr_b16 a[142:143], v123 offset:1024
s_waitcnt lgkmcnt(4)
v_mfma_f32_16x16x32_bf16 v[152:155], a[128:131], v[52:55], 0
ds_read_b64_tr_b16 a[144:145], v124 offset:0
ds_read_b64_tr_b16 a[146:147], v124 offset:1024
s_add_u32 s61, s52, 2
s_and_b32 s61, s61, 7
s_lshl_b32 s62, s61, 7
s_add_u32 s62, s62, s50
s_lshl_b32 s61, s61, 19
s_add_u32 s61, s61, s53
s_add_u32 m0, s59, 118784
s_add_u32 s55, s61, 0
buffer_load_dwordx4 v16, s[32:35], s55 offen lds
v_mfma_f32_16x16x32_bf16 v[156:159], a[128:131], v[56:59], 0
ds_read_b64_tr_b16 a[148:149], v125 offset:0
v_mfma_f32_16x16x32_bf16 v[160:163], a[128:131], v[60:63], 0
ds_read_b64_tr_b16 a[150:151], v125 offset:1024
s_add_u32 m0, s59, 119808
s_add_u32 s55, s61, 32768
buffer_load_dwordx4 v16, s[32:35], s55 offen lds
v_mfma_f32_16x16x32_bf16 v[164:167], a[132:135], v[52:55], 0
ds_read_b64_tr_b16 a[152:153], v126 offset:0
ds_read_b64_tr_b16 a[154:155], v126 offset:1024
v_mfma_f32_16x16x32_bf16 v[168:171], a[132:135], v[56:59], 0
ds_read_b64_tr_b16 a[156:157], v127 offset:0
s_add_u32 m0, s59, 120832
s_add_u32 s55, s61, 65536
buffer_load_dwordx4 v33, s[32:35], s55 offen lds
v_mfma_f32_16x16x32_bf16 v[172:175], a[132:135], v[60:63], 0
ds_read_b64_tr_b16 a[158:159], v127 offset:1024
s_waitcnt lgkmcnt(8)
v_mfma_f32_16x16x32_bf16 v[176:179], a[136:139], v[52:55], 0
s_add_u32 m0, s59, 121856
s_add_u32 s55, s61, 98304
buffer_load_dwordx4 v33, s[32:35], s55 offen lds
v_mfma_f32_16x16x32_bf16 v[180:183], a[136:139], v[56:59], 0
v_mfma_f32_16x16x32_bf16 v[184:187], a[136:139], v[60:63], 0
v_mfma_f32_16x16x32_bf16 v[188:191], a[140:143], v[52:55], 0
s_add_u32 m0, s59, 122880
s_add_u32 s55, s61, 131072
buffer_load_dwordx4 v16, s[32:35], s55 offen lds
v_mfma_f32_16x16x32_bf16 v[192:195], a[140:143], v[56:59], 0
v_mfma_f32_16x16x32_bf16 v[196:199], a[140:143], v[60:63], 0
s_add_u32 m0, s59, 123904
s_add_u32 s55, s61, 163840
buffer_load_dwordx4 v16, s[32:35], s55 offen lds
s_waitcnt lgkmcnt(4)
v_mfma_f32_16x16x32_bf16 v[200:203], a[144:147], v[52:55], 0
ds_read_b128 v[64:67], v42 offset:0
ds_read_b128 v[68:71], v42 offset:2048
v_mfma_f32_16x16x32_bf16 v[204:207], a[144:147], v[56:59], 0
ds_read_b128 v[72:75], v42 offset:4096
s_add_u32 m0, s59, 124928
s_add_u32 s55, s61, 196608
buffer_load_dwordx4 v33, s[32:35], s55 offen lds
v_mfma_f32_16x16x32_bf16 v[208:211], a[144:147], v[60:63], 0
ds_read_b64_tr_b16 a[160:161], v120 offset:8192
ds_read_b64_tr_b16 a[162:163], v120 offset:9216
v_mfma_f32_16x16x32_bf16 v[212:215], a[148:151], v[52:55], 0
ds_read_b64_tr_b16 a[164:165], v121 offset:8192
s_add_u32 m0, s59, 125952
s_add_u32 s55, s61, 229376
buffer_load_dwordx4 v33, s[32:35], s55 offen lds
v_mfma_f32_16x16x32_bf16 v[216:219], a[148:151], v[56:59], 0
ds_read_b64_tr_b16 a[166:167], v121 offset:9216
v_mfma_f32_16x16x32_bf16 v[220:223], a[148:151], v[60:63], 0
ds_read_b64_tr_b16 a[168:169], v122 offset:8192
ds_read_b64_tr_b16 a[170:171], v122 offset:9216
s_waitcnt lgkmcnt(9)
v_mfma_f32_16x16x32_bf16 v[224:227], a[152:155], v[52:55], 0
ds_read_b64_tr_b16 a[172:173], v123 offset:8192
s_add_u32 m0, s60, 151552
s_add_u32 s55, s62, 0
buffer_load_dwordx4 v17, s[20:23], s55 offen lds
v_mfma_f32_16x16x32_bf16 v[228:231], a[152:155], v[56:59], 0
ds_read_b64_tr_b16 a[174:175], v123 offset:9216
v_mfma_f32_16x16x32_bf16 v[232:235], a[152:155], v[60:63], 0
s_add_u32 m0, s60, 152576
s_add_u32 s55, s62, 8192
buffer_load_dwordx4 v9, s[20:23], s55 offen lds
v_mfma_f32_16x16x32_bf16 v[236:239], a[156:159], v[52:55], 0
v_mfma_f32_16x16x32_bf16 v[240:243], a[156:159], v[56:59], 0
s_add_u32 m0, s60, 153600
s_add_u32 s55, s62, 16384
buffer_load_dwordx4 v17, s[20:23], s55 offen lds
v_mfma_f32_16x16x32_bf16 v[244:247], a[156:159], v[60:63], 0
s_waitcnt lgkmcnt(4)
v_mfma_f32_16x16x32_bf16 v[152:155], a[160:163], v[64:67], v[152:155]
ds_read_b64_tr_b16 a[176:177], v124 offset:8192
ds_read_b64_tr_b16 a[178:179], v124 offset:9216
s_add_u32 m0, s48, 0
s_nop 0
buffer_load_dwordx4 v10, s[24:27], s44 offen offset:0 nt lds
v_mfma_f32_16x16x32_bf16 v[156:159], a[160:163], v[68:71], v[156:159]
ds_read_b64_tr_b16 a[180:181], v125 offset:8192
v_mfma_f32_16x16x32_bf16 v[160:163], a[160:163], v[72:75], v[160:163]
ds_read_b64_tr_b16 a[182:183], v125 offset:9216
v_mfma_f32_16x16x32_bf16 v[164:167], a[164:167], v[64:67], v[164:167]
ds_read_b64_tr_b16 a[184:185], v126 offset:8192
ds_read_b64_tr_b16 a[186:187], v126 offset:9216
s_add_u32 m0, s48, 0
s_nop 0
buffer_load_dwordx4 v11, s[24:27], s44 offen offset:1024 nt lds
v_mfma_f32_16x16x32_bf16 v[168:171], a[164:167], v[68:71], v[168:171]
ds_read_b64_tr_b16 a[188:189], v127 offset:8192
v_mfma_f32_16x16x32_bf16 v[172:175], a[164:167], v[72:75], v[172:175]
ds_read_b64_tr_b16 a[190:191], v127 offset:9216
s_add_u32 m0, s48, 0
s_nop 0
buffer_load_dwordx4 v12, s[24:27], s44 offen offset:2048 nt lds
s_waitcnt lgkmcnt(8)
v_mfma_f32_16x16x32_bf16 v[176:179], a[168:171], v[64:67], v[176:179]
v_mfma_f32_16x16x32_bf16 v[180:183], a[168:171], v[68:71], v[180:183]
s_add_u32 m0, s48, 0
s_nop 0
buffer_load_dwordx4 v13, s[24:27], s44 offen offset:3072 nt lds
s_add_u32 s44, s44, 8192
v_mfma_f32_16x16x32_bf16 v[184:187], a[168:171], v[72:75], v[184:187]
v_mfma_f32_16x16x32_bf16 v[188:191], a[172:175], v[64:67], v[188:191]
v_mfma_f32_16x16x32_bf16 v[192:195], a[172:175], v[68:71], v[192:195]
v_mfma_f32_16x16x32_bf16 v[196:199], a[172:175], v[72:75], v[196:199]
s_waitcnt lgkmcnt(4)
s_waitcnt lgkmcnt(0)
s_waitcnt vmcnt(15)
s_barrier
v_mfma_f32_16x16x32_bf16 v[200:203], a[176:179], v[64:67], v[200:203]
v_add_u32 v120, 73728, v112
v_add_u32 v121, 73728, v113
v_add_u32 v122, 73728, v114
v_add_u32 v123, 73728, v115
v_mfma_f32_16x16x32_bf16 v[204:207], a[176:179], v[68:71], v[204:207]
s_add_u32 s61, s52, 3
s_and_b32 s61, s61, 7
s_lshl_b32 s62, s61, 7
s_add_u32 s62, s62, s50
s_lshl_b32 s61, s61, 19
s_add_u32 s61, s61, s53
s_add_u32 m0, s59, 28672
s_add_u32 s55, s61, 0
buffer_load_dwordx4 v16, s[32:35], s55 offen lds
v_add_u32 v124, 73728, v116
v_add_u32 v125, 73728, v117
v_add_u32 v126, 73728, v118
v_mfma_f32_16x16x32_bf16 v[208:211], a[176:179], v[72:75], v[208:211]
v_add_u32 v127, 73728, v119
v_add_u32 v41, 73728, v7
v_add_u32 v42, 73728, v8
v_mfma_f32_16x16x32_bf16 v[212:215], a[180:183], v[64:67], v[212:215]
ds_read_b128 v[52:55], v41 offset:0
ds_read_b128 v[56:59], v41 offset:2048
v_mfma_f32_16x16x32_bf16 v[216:219], a[180:183], v[68:71], v[216:219]
ds_read_b128 v[60:63], v41 offset:4096
v_mfma_f32_16x16x32_bf16 v[220:223], a[180:183], v[72:75], v[220:223]
ds_read_b64_tr_b16 a[128:129], v120 offset:0
v_mfma_f32_16x16x32_bf16 v[224:227], a[184:187], v[64:67], v[224:227]
s_add_u32 m0, s59, 29696
s_add_u32 s55, s61, 32768
buffer_load_dwordx4 v16, s[32:35], s55 offen lds
ds_read_b64_tr_b16 a[130:131], v120 offset:1024
v_mfma_f32_16x16x32_bf16 v[228:231], a[184:187], v[68:71], v[228:231]
ds_read_b64_tr_b16 a[132:133], v121 offset:0
ds_read_b64_tr_b16 a[134:135], v121 offset:1024
v_mfma_f32_16x16x32_bf16 v[232:235], a[184:187], v[72:75], v[232:235]
ds_read_b64_tr_b16 a[136:137], v122 offset:0
v_mfma_f32_16x16x32_bf16 v[236:239], a[188:191], v[64:67], v[236:239]
ds_read_b64_tr_b16 a[138:139], v122 offset:1024
v_mfma_f32_16x16x32_bf16 v[240:243], a[188:191], v[68:71], v[240:243]
ds_read_b64_tr_b16 a[140:141], v123 offset:0
v_mfma_f32_16x16x32_bf16 v[244:247], a[188:191], v[72:75], v[244:247]
ds_read_b64_tr_b16 a[142:143], v123 offset:1024
s_waitcnt lgkmcnt(4)
v_mfma_f32_16x16x32_bf16 v[152:155], a[128:131], v[52:55], v[152:155]
ds_read_b64_tr_b16 a[144:145], v124 offset:0
ds_read_b64_tr_b16 a[146:147], v124 offset:1024
s_add_u32 m0, s59, 30720
s_add_u32 s55, s61, 65536
buffer_load_dwordx4 v33, s[32:35], s55 offen lds
v_mfma_f32_16x16x32_bf16 v[156:159], a[128:131], v[56:59], v[156:159]
ds_read_b64_tr_b16 a[148:149], v125 offset:0
v_mfma_f32_16x16x32_bf16 v[160:163], a[128:131], v[60:63], v[160:163]
ds_read_b64_tr_b16 a[150:151], v125 offset:1024
v_mfma_f32_16x16x32_bf16 v[164:167], a[132:135], v[52:55], v[164:167]
ds_read_b64_tr_b16 a[152:153], v126 offset:0
ds_read_b64_tr_b16 a[154:155], v126 offset:1024
s_add_u32 m0, s59, 31744
s_add_u32 s55, s61, 98304
buffer_load_dwordx4 v33, s[32:35], s55 offen lds
v_mfma_f32_16x16x32_bf16 v[168:171], a[132:135], v[56:59], v[168:171]
ds_read_b64_tr_b16 a[156:157], v127 offset:0
v_mfma_f32_16x16x32_bf16 v[172:175], a[132:135], v[60:63], v[172:175]
ds_read_b64_tr_b16 a[158:159], v127 offset:1024
s_waitcnt lgkmcnt(8)
v_mfma_f32_16x16x32_bf16 v[176:179], a[136:139], v[52:55], v[176:179]
v_mfma_f32_16x16x32_bf16 v[180:183], a[136:139], v[56:59], v[180:183]
s_add_u32 m0, s59, 32768
s_add_u32 s55, s61, 131072
buffer_load_dwordx4 v16, s[32:35], s55 offen lds
v_mfma_f32_16x16x32_bf16 v[184:187], a[136:139], v[60:63], v[184:187]
v_mfma_f32_16x16x32_bf16 v[188:191], a[140:143], v[52:55], v[188:191]
v_mfma_f32_16x16x32_bf16 v[192:195], a[140:143], v[56:59], v[192:195]
v_mfma_f32_16x16x32_bf16 v[196:199], a[140:143], v[60:63], v[196:199]
s_add_u32 m0, s59, 33792
s_add_u32 s55, s61, 163840
buffer_load_dwordx4 v16, s[32:35], s55 offen lds
s_waitcnt lgkmcnt(4)
v_mfma_f32_16x16x32_bf16 v[200:203], a[144:147], v[52:55], v[200:203]
ds_read_b128 v[64:67], v42 offset:0
ds_read_b128 v[68:71], v42 offset:2048
v_mfma_f32_16x16x32_bf16 v[204:207], a[144:147], v[56:59], v[204:207]
ds_read_b128 v[72:75], v42 offset:4096
v_mfma_f32_16x16x32_bf16 v[208:211], a[144:147], v[60:63], v[208:211]
ds_read_b64_tr_b16 a[160:161], v120 offset:8192
ds_read_b64_tr_b16 a[162:163], v120 offset:9216
v_mfma_f32_16x16x32_bf16 v[212:215], a[148:151], v[52:55], v[212:215]
ds_read_b64_tr_b16 a[164:165], v121 offset:8192
s_add_u32 m0, s59, 34816
s_add_u32 s55, s61, 196608
buffer_load_dwordx4 v33, s[32:35], s55 offen lds
v_mfma_f32_16x16x32_bf16 v[216:219], a[148:151], v[56:59], v[216:219]
ds_read_b64_tr_b16 a[166:167], v121 offset:9216
v_mfma_f32_16x16x32_bf16 v[220:223], a[148:151], v[60:63], v[220:223]
ds_read_b64_tr_b16 a[168:169], v122 offset:8192
ds_read_b64_tr_b16 a[170:171], v122 offset:9216
s_waitcnt lgkmcnt(9)
v_mfma_f32_16x16x32_bf16 v[224:227], a[152:155], v[52:55], v[224:227]
ds_read_b64_tr_b16 a[172:173], v123 offset:8192
s_add_u32 m0, s59, 35840
s_add_u32 s55, s61, 229376
buffer_load_dwordx4 v33, s[32:35], s55 offen lds
v_mfma_f32_16x16x32_bf16 v[228:231], a[152:155], v[56:59], v[228:231]
ds_read_b64_tr_b16 a[174:175], v123 offset:9216
v_mfma_f32_16x16x32_bf16 v[232:235], a[152:155], v[60:63], v[232:235]
v_mfma_f32_16x16x32_bf16 v[236:239], a[156:159], v[52:55], v[236:239]
v_mfma_f32_16x16x32_bf16 v[240:243], a[156:159], v[56:59], v[240:243]
s_add_u32 m0, s60, 61440
s_add_u32 s55, s62, 0
buffer_load_dwordx4 v17, s[20:23], s55 offen lds
v_mfma_f32_16x16x32_bf16 v[244:247], a[156:159], v[60:63], v[244:247]
s_waitcnt lgkmcnt(4)
v_mfma_f32_16x16x32_bf16 v[152:155], a[160:163], v[64:67], v[152:155]
ds_read_b64_tr_b16 a[176:177], v124 offset:8192
ds_read_b64_tr_b16 a[178:179], v124 offset:9216
v_mfma_f32_16x16x32_bf16 v[156:159], a[160:163], v[68:71], v[156:159]
ds_read_b64_tr_b16 a[180:181], v125 offset:8192
v_mfma_f32_16x16x32_bf16 v[160:163], a[160:163], v[72:75], v[160:163]
ds_read_b64_tr_b16 a[182:183], v125 offset:9216
s_add_u32 m0, s60, 62464
s_add_u32 s55, s62, 8192
buffer_load_dwordx4 v9, s[20:23], s55 offen lds
v_mfma_f32_16x16x32_bf16 v[164:167], a[164:167], v[64:67], v[164:167]
ds_read_b64_tr_b16 a[184:185], v126 offset:8192
ds_read_b64_tr_b16 a[186:187], v126 offset:9216
v_mfma_f32_16x16x32_bf16 v[168:171], a[164:167], v[68:71], v[168:171]
ds_read_b64_tr_b16 a[188:189], v127 offset:8192
v_mfma_f32_16x16x32_bf16 v[172:175], a[164:167], v[72:75], v[172:175]
ds_read_b64_tr_b16 a[190:191], v127 offset:9216
s_waitcnt lgkmcnt(8)
v_mfma_f32_16x16x32_bf16 v[176:179], a[168:171], v[64:67], v[176:179]
s_add_u32 m0, s60, 63488
s_add_u32 s55, s62, 16384
buffer_load_dwordx4 v17, s[20:23], s55 offen lds
v_mfma_f32_16x16x32_bf16 v[180:183], a[168:171], v[68:71], v[180:183]
v_mfma_f32_16x16x32_bf16 v[184:187], a[168:171], v[72:75], v[184:187]
v_mfma_f32_16x16x32_bf16 v[188:191], a[172:175], v[64:67], v[188:191]
v_mfma_f32_16x16x32_bf16 v[192:195], a[172:175], v[68:71], v[192:195]
v_mfma_f32_16x16x32_bf16 v[196:199], a[172:175], v[72:75], v[196:199]
s_waitcnt lgkmcnt(4)
s_waitcnt lgkmcnt(0)
s_waitcnt vmcnt(15)
s_barrier
v_mfma_f32_16x16x32_bf16 v[200:203], a[176:179], v[64:67], v[200:203]
v_add_u32 v120, 118784, v112
v_add_u32 v121, 118784, v113
v_add_u32 v122, 118784, v114
v_add_u32 v123, 118784, v115
v_mfma_f32_16x16x32_bf16 v[204:207], a[176:179], v[68:71], v[204:207]
s_add_u32 s61, s52, 4
s_and_b32 s61, s61, 7
s_lshl_b32 s62, s61, 7
s_add_u32 s62, s62, s50
s_lshl_b32 s61, s61, 19
s_add_u32 s61, s61, s53
s_add_u32 m0, s59, 73728
s_add_u32 s55, s61, 0
buffer_load_dwordx4 v16, s[32:35], s55 offen lds
v_add_u32 v124, 118784, v116
v_add_u32 v125, 118784, v117
v_add_u32 v126, 118784, v118
v_mfma_f32_16x16x32_bf16 v[208:211], a[176:179], v[72:75], v[208:211]
v_add_u32 v127, 118784, v119
v_add_u32 v41, 118784, v7
v_add_u32 v42, 118784, v8
v_mfma_f32_16x16x32_bf16 v[212:215], a[180:183], v[64:67], v[212:215]
ds_read_b128 v[52:55], v41 offset:0
ds_read_b128 v[56:59], v41 offset:2048
v_mfma_f32_16x16x32_bf16 v[216:219], a[180:183], v[68:71], v[216:219]
ds_read_b128 v[60:63], v41 offset:4096
v_mfma_f32_16x16x32_bf16 v[220:223], a[180:183], v[72:75], v[220:223]
ds_read_b64_tr_b16 a[128:129], v120 offset:0
v_mfma_f32_16x16x32_bf16 v[224:227], a[184:187], v[64:67], v[224:227]
s_add_u32 m0, s59, 74752
s_add_u32 s55, s61, 32768
buffer_load_dwordx4 v16, s[32:35], s55 offen lds
ds_read_b64_tr_b16 a[130:131], v120 offset:1024
v_mfma_f32_16x16x32_bf16 v[228:231], a[184:187], v[68:71], v[228:231]
ds_read_b64_tr_b16 a[132:133], v121 offset:0
ds_read_b64_tr_b16 a[134:135], v121 offset:1024
v_mfma_f32_16x16x32_bf16 v[232:235], a[184:187], v[72:75], v[232:235]
ds_read_b64_tr_b16 a[136:137], v122 offset:0
v_mfma_f32_16x16x32_bf16 v[236:239], a[188:191], v[64:67], v[236:239]
ds_read_b64_tr_b16 a[138:139], v122 offset:1024
v_mfma_f32_16x16x32_bf16 v[240:243], a[188:191], v[68:71], v[240:243]
ds_read_b64_tr_b16 a[140:141], v123 offset:0
v_mfma_f32_16x16x32_bf16 v[244:247], a[188:191], v[72:75], v[244:247]
ds_read_b64_tr_b16 a[142:143], v123 offset:1024
s_waitcnt lgkmcnt(4)
v_mfma_f32_16x16x32_bf16 v[152:155], a[128:131], v[52:55], v[152:155]
ds_read_b64_tr_b16 a[144:145], v124 offset:0
ds_read_b64_tr_b16 a[146:147], v124 offset:1024
s_add_u32 m0, s59, 75776
s_add_u32 s55, s61, 65536
buffer_load_dwordx4 v33, s[32:35], s55 offen lds
v_mfma_f32_16x16x32_bf16 v[156:159], a[128:131], v[56:59], v[156:159]
ds_read_b64_tr_b16 a[148:149], v125 offset:0
v_mfma_f32_16x16x32_bf16 v[160:163], a[128:131], v[60:63], v[160:163]
ds_read_b64_tr_b16 a[150:151], v125 offset:1024
v_mfma_f32_16x16x32_bf16 v[164:167], a[132:135], v[52:55], v[164:167]
ds_read_b64_tr_b16 a[152:153], v126 offset:0
ds_read_b64_tr_b16 a[154:155], v126 offset:1024
s_add_u32 m0, s59, 76800
s_add_u32 s55, s61, 98304
buffer_load_dwordx4 v33, s[32:35], s55 offen lds
v_mfma_f32_16x16x32_bf16 v[168:171], a[132:135], v[56:59], v[168:171]
ds_read_b64_tr_b16 a[156:157], v127 offset:0
v_mfma_f32_16x16x32_bf16 v[172:175], a[132:135], v[60:63], v[172:175]
ds_read_b64_tr_b16 a[158:159], v127 offset:1024
s_waitcnt lgkmcnt(8)
v_mfma_f32_16x16x32_bf16 v[176:179], a[136:139], v[52:55], v[176:179]
v_mfma_f32_16x16x32_bf16 v[180:183], a[136:139], v[56:59], v[180:183]
s_add_u32 m0, s59, 77824
s_add_u32 s55, s61, 131072
buffer_load_dwordx4 v16, s[32:35], s55 offen lds
v_mfma_f32_16x16x32_bf16 v[184:187], a[136:139], v[60:63], v[184:187]
v_mfma_f32_16x16x32_bf16 v[188:191], a[140:143], v[52:55], v[188:191]
v_mfma_f32_16x16x32_bf16 v[192:195], a[140:143], v[56:59], v[192:195]
v_mfma_f32_16x16x32_bf16 v[196:199], a[140:143], v[60:63], v[196:199]
s_add_u32 m0, s59, 78848
s_add_u32 s55, s61, 163840
buffer_load_dwordx4 v16, s[32:35], s55 offen lds
s_waitcnt lgkmcnt(4)
v_mfma_f32_16x16x32_bf16 v[200:203], a[144:147], v[52:55], v[200:203]
ds_read_b128 v[64:67], v42 offset:0
ds_read_b128 v[68:71], v42 offset:2048
v_mfma_f32_16x16x32_bf16 v[204:207], a[144:147], v[56:59], v[204:207]
ds_read_b128 v[72:75], v42 offset:4096
v_mfma_f32_16x16x32_bf16 v[208:211], a[144:147], v[60:63], v[208:211]
ds_read_b64_tr_b16 a[160:161], v120 offset:8192
ds_read_b64_tr_b16 a[162:163], v120 offset:9216
v_mfma_f32_16x16x32_bf16 v[212:215], a[148:151], v[52:55], v[212:215]
ds_read_b64_tr_b16 a[164:165], v121 offset:8192
s_add_u32 m0, s59, 79872
s_add_u32 s55, s61, 196608
buffer_load_dwordx4 v33, s[32:35], s55 offen lds
v_mfma_f32_16x16x32_bf16 v[216:219], a[148:151], v[56:59], v[216:219]
ds_read_b64_tr_b16 a[166:167], v121 offset:9216
v_mfma_f32_16x16x32_bf16 v[220:223], a[148:151], v[60:63], v[220:223]
ds_read_b64_tr_b16 a[168:169], v122 offset:8192
ds_read_b64_tr_b16 a[170:171], v122 offset:9216
s_waitcnt lgkmcnt(9)
v_mfma_f32_16x16x32_bf16 v[224:227], a[152:155], v[52:55], v[224:227]
ds_read_b64_tr_b16 a[172:173], v123 offset:8192
s_add_u32 m0, s59, 80896
s_add_u32 s55, s61, 229376
buffer_load_dwordx4 v33, s[32:35], s55 offen lds
v_mfma_f32_16x16x32_bf16 v[228:231], a[152:155], v[56:59], v[228:231]
ds_read_b64_tr_b16 a[174:175], v123 offset:9216
v_mfma_f32_16x16x32_bf16 v[232:235], a[152:155], v[60:63], v[232:235]
v_mfma_f32_16x16x32_bf16 v[236:239], a[156:159], v[52:55], v[236:239]
v_mfma_f32_16x16x32_bf16 v[240:243], a[156:159], v[56:59], v[240:243]
s_add_u32 m0, s60, 106496
s_add_u32 s55, s62, 0
buffer_load_dwordx4 v17, s[20:23], s55 offen lds
v_mfma_f32_16x16x32_bf16 v[244:247], a[156:159], v[60:63], v[244:247]
s_waitcnt lgkmcnt(4)
v_mfma_f32_16x16x32_bf16 v[152:155], a[160:163], v[64:67], v[152:155]
ds_read_b64_tr_b16 a[176:177], v124 offset:8192
ds_read_b64_tr_b16 a[178:179], v124 offset:9216
v_mfma_f32_16x16x32_bf16 v[156:159], a[160:163], v[68:71], v[156:159]
ds_read_b64_tr_b16 a[180:181], v125 offset:8192
v_mfma_f32_16x16x32_bf16 v[160:163], a[160:163], v[72:75], v[160:163]
ds_read_b64_tr_b16 a[182:183], v125 offset:9216
s_add_u32 m0, s60, 107520
s_add_u32 s55, s62, 8192
buffer_load_dwordx4 v9, s[20:23], s55 offen lds
v_mfma_f32_16x16x32_bf16 v[164:167], a[164:167], v[64:67], v[164:167]
ds_read_b64_tr_b16 a[184:185], v126 offset:8192
ds_read_b64_tr_b16 a[186:187], v126 offset:9216
v_mfma_f32_16x16x32_bf16 v[168:171], a[164:167], v[68:71], v[168:171]
ds_read_b64_tr_b16 a[188:189], v127 offset:8192
v_mfma_f32_16x16x32_bf16 v[172:175], a[164:167], v[72:75], v[172:175]
ds_read_b64_tr_b16 a[190:191], v127 offset:9216
s_waitcnt lgkmcnt(8)
v_mfma_f32_16x16x32_bf16 v[176:179], a[168:171], v[64:67], v[176:179]
s_add_u32 m0, s60, 108544
s_add_u32 s55, s62, 16384
buffer_load_dwordx4 v17, s[20:23], s55 offen lds
v_mfma_f32_16x16x32_bf16 v[180:183], a[168:171], v[68:71], v[180:183]
v_mfma_f32_16x16x32_bf16 v[184:187], a[168:171], v[72:75], v[184:187]
v_mfma_f32_16x16x32_bf16 v[188:191], a[172:175], v[64:67], v[188:191]
v_mfma_f32_16x16x32_bf16 v[192:195], a[172:175], v[68:71], v[192:195]
v_mfma_f32_16x16x32_bf16 v[196:199], a[172:175], v[72:75], v[196:199]
s_waitcnt lgkmcnt(4)
s_waitcnt lgkmcnt(0)
s_waitcnt vmcnt(11)
s_barrier
v_mfma_f32_16x16x32_bf16 v[200:203], a[176:179], v[64:67], v[200:203]
v_add_u32 v120, 28672, v112
v_add_u32 v121, 28672, v113
v_add_u32 v122, 28672, v114
v_add_u32 v123, 28672, v115
v_mfma_f32_16x16x32_bf16 v[204:207], a[176:179], v[68:71], v[204:207]
s_add_u32 s61, s52, 5
s_and_b32 s61, s61, 7
s_lshl_b32 s62, s61, 7
s_add_u32 s62, s62, s50
s_lshl_b32 s61, s61, 19
s_add_u32 s61, s61, s53
s_add_u32 m0, s59, 118784
s_add_u32 s55, s61, 0
buffer_load_dwordx4 v16, s[32:35], s55 offen lds
v_add_u32 v124, 28672, v116
v_add_u32 v125, 28672, v117
v_add_u32 v126, 28672, v118
v_mfma_f32_16x16x32_bf16 v[208:211], a[176:179], v[72:75], v[208:211]
v_add_u32 v127, 28672, v119
v_add_u32 v41, 28672, v7
v_add_u32 v42, 28672, v8
v_mfma_f32_16x16x32_bf16 v[212:215], a[180:183], v[64:67], v[212:215]
ds_read_b128 v[52:55], v41 offset:0
ds_read_b128 v[56:59], v41 offset:2048
v_mfma_f32_16x16x32_bf16 v[216:219], a[180:183], v[68:71], v[216:219]
ds_read_b128 v[60:63], v41 offset:4096
v_mfma_f32_16x16x32_bf16 v[220:223], a[180:183], v[72:75], v[220:223]
ds_read_b64_tr_b16 a[128:129], v120 offset:0
v_mfma_f32_16x16x32_bf16 v[224:227], a[184:187], v[64:67], v[224:227]
s_add_u32 m0, s59, 119808
s_add_u32 s55, s61, 32768
buffer_load_dwordx4 v16, s[32:35], s55 offen lds
ds_read_b64_tr_b16 a[130:131], v120 offset:1024
v_mfma_f32_16x16x32_bf16 v[228:231], a[184:187], v[68:71], v[228:231]
ds_read_b64_tr_b16 a[132:133], v121 offset:0
ds_read_b64_tr_b16 a[134:135], v121 offset:1024
v_mfma_f32_16x16x32_bf16 v[232:235], a[184:187], v[72:75], v[232:235]
ds_read_b64_tr_b16 a[136:137], v122 offset:0
v_mfma_f32_16x16x32_bf16 v[236:239], a[188:191], v[64:67], v[236:239]
ds_read_b64_tr_b16 a[138:139], v122 offset:1024
v_mfma_f32_16x16x32_bf16 v[240:243], a[188:191], v[68:71], v[240:243]
ds_read_b64_tr_b16 a[140:141], v123 offset:0
v_mfma_f32_16x16x32_bf16 v[244:247], a[188:191], v[72:75], v[244:247]
ds_read_b64_tr_b16 a[142:143], v123 offset:1024
s_waitcnt lgkmcnt(4)
v_mfma_f32_16x16x32_bf16 v[152:155], a[128:131], v[52:55], v[152:155]
ds_read_b64_tr_b16 a[144:145], v124 offset:0
ds_read_b64_tr_b16 a[146:147], v124 offset:1024
s_add_u32 m0, s59, 120832
s_add_u32 s55, s61, 65536
buffer_load_dwordx4 v33, s[32:35], s55 offen lds
v_mfma_f32_16x16x32_bf16 v[156:159], a[128:131], v[56:59], v[156:159]
ds_read_b64_tr_b16 a[148:149], v125 offset:0
v_mfma_f32_16x16x32_bf16 v[160:163], a[128:131], v[60:63], v[160:163]
ds_read_b64_tr_b16 a[150:151], v125 offset:1024
v_mfma_f32_16x16x32_bf16 v[164:167], a[132:135], v[52:55], v[164:167]
ds_read_b64_tr_b16 a[152:153], v126 offset:0
ds_read_b64_tr_b16 a[154:155], v126 offset:1024
s_add_u32 m0, s59, 121856
s_add_u32 s55, s61, 98304
buffer_load_dwordx4 v33, s[32:35], s55 offen lds
v_mfma_f32_16x16x32_bf16 v[168:171], a[132:135], v[56:59], v[168:171]
ds_read_b64_tr_b16 a[156:157], v127 offset:0
v_mfma_f32_16x16x32_bf16 v[172:175], a[132:135], v[60:63], v[172:175]
ds_read_b64_tr_b16 a[158:159], v127 offset:1024
s_waitcnt lgkmcnt(8)
v_mfma_f32_16x16x32_bf16 v[176:179], a[136:139], v[52:55], v[176:179]
v_mfma_f32_16x16x32_bf16 v[180:183], a[136:139], v[56:59], v[180:183]
s_add_u32 m0, s59, 122880
s_add_u32 s55, s61, 131072
buffer_load_dwordx4 v16, s[32:35], s55 offen lds
v_mfma_f32_16x16x32_bf16 v[184:187], a[136:139], v[60:63], v[184:187]
v_mfma_f32_16x16x32_bf16 v[188:191], a[140:143], v[52:55], v[188:191]
v_mfma_f32_16x16x32_bf16 v[192:195], a[140:143], v[56:59], v[192:195]
v_mfma_f32_16x16x32_bf16 v[196:199], a[140:143], v[60:63], v[196:199]
s_add_u32 m0, s59, 123904
s_add_u32 s55, s61, 163840
buffer_load_dwordx4 v16, s[32:35], s55 offen lds
s_waitcnt lgkmcnt(4)
v_mfma_f32_16x16x32_bf16 v[200:203], a[144:147], v[52:55], v[200:203]
ds_read_b128 v[64:67], v42 offset:0
ds_read_b128 v[68:71], v42 offset:2048
v_mfma_f32_16x16x32_bf16 v[204:207], a[144:147], v[56:59], v[204:207]
ds_read_b128 v[72:75], v42 offset:4096
v_mfma_f32_16x16x32_bf16 v[208:211], a[144:147], v[60:63], v[208:211]
ds_read_b64_tr_b16 a[160:161], v120 offset:8192
ds_read_b64_tr_b16 a[162:163], v120 offset:9216
v_mfma_f32_16x16x32_bf16 v[212:215], a[148:151], v[52:55], v[212:215]
ds_read_b64_tr_b16 a[164:165], v121 offset:8192
s_add_u32 m0, s59, 124928
s_add_u32 s55, s61, 196608
buffer_load_dwordx4 v33, s[32:35], s55 offen lds
v_mfma_f32_16x16x32_bf16 v[216:219], a[148:151], v[56:59], v[216:219]
ds_read_b64_tr_b16 a[166:167], v121 offset:9216
v_mfma_f32_16x16x32_bf16 v[220:223], a[148:151], v[60:63], v[220:223]
ds_read_b64_tr_b16 a[168:169], v122 offset:8192
ds_read_b64_tr_b16 a[170:171], v122 offset:9216
s_waitcnt lgkmcnt(9)
v_mfma_f32_16x16x32_bf16 v[224:227], a[152:155], v[52:55], v[224:227]
ds_read_b64_tr_b16 a[172:173], v123 offset:8192
s_add_u32 m0, s59, 125952
s_add_u32 s55, s61, 229376
buffer_load_dwordx4 v33, s[32:35], s55 offen lds
v_mfma_f32_16x16x32_bf16 v[228:231], a[152:155], v[56:59], v[228:231]
ds_read_b64_tr_b16 a[174:175], v123 offset:9216
v_mfma_f32_16x16x32_bf16 v[232:235], a[152:155], v[60:63], v[232:235]
v_mfma_f32_16x16x32_bf16 v[236:239], a[156:159], v[52:55], v[236:239]
v_mfma_f32_16x16x32_bf16 v[240:243], a[156:159], v[56:59], v[240:243]
s_add_u32 m0, s60, 151552
s_add_u32 s55, s62, 0
buffer_load_dwordx4 v17, s[20:23], s55 offen lds
v_mfma_f32_16x16x32_bf16 v[244:247], a[156:159], v[60:63], v[244:247]
s_waitcnt lgkmcnt(4)
v_mfma_f32_16x16x32_bf16 v[152:155], a[160:163], v[64:67], v[152:155]
ds_read_b64_tr_b16 a[176:177], v124 offset:8192
ds_read_b64_tr_b16 a[178:179], v124 offset:9216
v_mfma_f32_16x16x32_bf16 v[156:159], a[160:163], v[68:71], v[156:159]
ds_read_b64_tr_b16 a[180:181], v125 offset:8192
v_mfma_f32_16x16x32_bf16 v[160:163], a[160:163], v[72:75], v[160:163]
ds_read_b64_tr_b16 a[182:183], v125 offset:9216
s_add_u32 m0, s60, 152576
s_add_u32 s55, s62, 8192
buffer_load_dwordx4 v9, s[20:23], s55 offen lds
v_mfma_f32_16x16x32_bf16 v[164:167], a[164:167], v[64:67], v[164:167]
ds_read_b64_tr_b16 a[184:185], v126 offset:8192
ds_read_b64_tr_b16 a[186:187], v126 offset:9216
v_mfma_f32_16x16x32_bf16 v[168:171], a[164:167], v[68:71], v[168:171]
ds_read_b64_tr_b16 a[188:189], v127 offset:8192
v_mfma_f32_16x16x32_bf16 v[172:175], a[164:167], v[72:75], v[172:175]
ds_read_b64_tr_b16 a[190:191], v127 offset:9216
s_waitcnt lgkmcnt(8)
v_mfma_f32_16x16x32_bf16 v[176:179], a[168:171], v[64:67], v[176:179]
s_add_u32 m0, s60, 153600
s_add_u32 s55, s62, 16384
buffer_load_dwordx4 v17, s[20:23], s55 offen lds
v_mfma_f32_16x16x32_bf16 v[180:183], a[168:171], v[68:71], v[180:183]
v_mfma_f32_16x16x32_bf16 v[184:187], a[168:171], v[72:75], v[184:187]
v_mfma_f32_16x16x32_bf16 v[188:191], a[172:175], v[64:67], v[188:191]
v_mfma_f32_16x16x32_bf16 v[192:195], a[172:175], v[68:71], v[192:195]
v_mfma_f32_16x16x32_bf16 v[196:199], a[172:175], v[72:75], v[196:199]
s_waitcnt lgkmcnt(4)
s_waitcnt lgkmcnt(0)
s_waitcnt vmcnt(11)
s_barrier
v_mfma_f32_16x16x32_bf16 v[200:203], a[176:179], v[64:67], v[200:203]
v_add_u32 v120, 73728, v112
v_add_u32 v121, 73728, v113
v_add_u32 v122, 73728, v114
v_add_u32 v123, 73728, v115
v_mfma_f32_16x16x32_bf16 v[204:207], a[176:179], v[68:71], v[204:207]
s_add_u32 m0, s48, 16384
s_nop 0
buffer_load_dwordx4 v14, s[28:31], s73 offen offset:0 nt lds
v_add_u32 v124, 73728, v116
v_add_u32 v125, 73728, v117
v_add_u32 v126, 73728, v118
v_mfma_f32_16x16x32_bf16 v[208:211], a[176:179], v[72:75], v[208:211]
v_add_u32 v127, 73728, v119
v_add_u32 v41, 73728, v7
v_add_u32 v42, 73728, v8
v_mfma_f32_16x16x32_bf16 v[212:215], a[180:183], v[64:67], v[212:215]
ds_read_b128 v[52:55], v41 offset:0
ds_read_b128 v[56:59], v41 offset:2048
v_mfma_f32_16x16x32_bf16 v[216:219], a[180:183], v[68:71], v[216:219]
ds_read_b128 v[60:63], v41 offset:4096
v_mfma_f32_16x16x32_bf16 v[220:223], a[180:183], v[72:75], v[220:223]
ds_read_b64_tr_b16 a[128:129], v120 offset:0
v_mfma_f32_16x16x32_bf16 v[224:227], a[184:187], v[64:67], v[224:227]
ds_read_b64_tr_b16 a[130:131], v120 offset:1024
v_mfma_f32_16x16x32_bf16 v[228:231], a[184:187], v[68:71], v[228:231]
ds_read_b64_tr_b16 a[132:133], v121 offset:0
ds_read_b64_tr_b16 a[134:135], v121 offset:1024
v_mfma_f32_16x16x32_bf16 v[232:235], a[184:187], v[72:75], v[232:235]
ds_read_b64_tr_b16 a[136:137], v122 offset:0
v_mfma_f32_16x16x32_bf16 v[236:239], a[188:191], v[64:67], v[236:239]
ds_read_b64_tr_b16 a[138:139], v122 offset:1024
v_mfma_f32_16x16x32_bf16 v[240:243], a[188:191], v[68:71], v[240:243]
ds_read_b64_tr_b16 a[140:141], v123 offset:0
v_mfma_f32_16x16x32_bf16 v[244:247], a[188:191], v[72:75], v[244:247]
ds_read_b64_tr_b16 a[142:143], v123 offset:1024
s_waitcnt lgkmcnt(4)
v_mfma_f32_16x16x32_bf16 v[152:155], a[128:131], v[52:55], v[152:155]
ds_read_b64_tr_b16 a[144:145], v124 offset:0
ds_read_b64_tr_b16 a[146:147], v124 offset:1024
s_add_u32 m0, s48, 16384
s_nop 0
buffer_load_dwordx4 v15, s[28:31], s73 offen offset:1024 nt lds
v_mfma_f32_16x16x32_bf16 v[156:159], a[128:131], v[56:59], v[156:159]
ds_read_b64_tr_b16 a[148:149], v125 offset:0
v_mfma_f32_16x16x32_bf16 v[160:163], a[128:131], v[60:63], v[160:163]
ds_read_b64_tr_b16 a[150:151], v125 offset:1024
v_mfma_f32_16x16x32_bf16 v[164:167], a[132:135], v[52:55], v[164:167]
ds_read_b64_tr_b16 a[152:153], v126 offset:0
ds_read_b64_tr_b16 a[154:155], v126 offset:1024
v_mfma_f32_16x16x32_bf16 v[168:171], a[132:135], v[56:59], v[168:171]
ds_read_b64_tr_b16 a[156:157], v127 offset:0
v_mfma_f32_16x16x32_bf16 v[172:175], a[132:135], v[60:63], v[172:175]
ds_read_b64_tr_b16 a[158:159], v127 offset:1024
s_waitcnt lgkmcnt(8)
v_mfma_f32_16x16x32_bf16 v[176:179], a[136:139], v[52:55], v[176:179]
s_add_u32 m0, s48, 16384
s_nop 0
buffer_load_dwordx4 v14, s[28:31], s73 offen offset:2048 nt lds
v_mfma_f32_16x16x32_bf16 v[180:183], a[136:139], v[56:59], v[180:183]
v_mfma_f32_16x16x32_bf16 v[184:187], a[136:139], v[60:63], v[184:187]
v_mfma_f32_16x16x32_bf16 v[188:191], a[140:143], v[52:55], v[188:191]
v_mfma_f32_16x16x32_bf16 v[192:195], a[140:143], v[56:59], v[192:195]
v_mfma_f32_16x16x32_bf16 v[196:199], a[140:143], v[60:63], v[196:199]
s_waitcnt lgkmcnt(4)
v_mfma_f32_16x16x32_bf16 v[200:203], a[144:147], v[52:55], v[200:203]
ds_read_b128 v[64:67], v42 offset:0
ds_read_b128 v[68:71], v42 offset:2048
v_mfma_f32_16x16x32_bf16 v[204:207], a[144:147], v[56:59], v[204:207]
ds_read_b128 v[72:75], v42 offset:4096
s_add_u32 m0, s48, 16384
s_nop 0
buffer_load_dwordx4 v15, s[28:31], s73 offen offset:3072 nt lds
s_add_u32 s73, s73, 8192
v_mfma_f32_16x16x32_bf16 v[208:211], a[144:147], v[60:63], v[208:211]
ds_read_b64_tr_b16 a[160:161], v120 offset:8192
ds_read_b64_tr_b16 a[162:163], v120 offset:9216
v_mfma_f32_16x16x32_bf16 v[212:215], a[148:151], v[52:55], v[212:215]
ds_read_b64_tr_b16 a[164:165], v121 offset:8192
v_mfma_f32_16x16x32_bf16 v[216:219], a[148:151], v[56:59], v[216:219]
ds_read_b64_tr_b16 a[166:167], v121 offset:9216
v_mfma_f32_16x16x32_bf16 v[220:223], a[148:151], v[60:63], v[220:223]
ds_read_b64_tr_b16 a[168:169], v122 offset:8192
ds_read_b64_tr_b16 a[170:171], v122 offset:9216
s_waitcnt lgkmcnt(9)
v_mfma_f32_16x16x32_bf16 v[224:227], a[152:155], v[52:55], v[224:227]
ds_read_b64_tr_b16 a[172:173], v123 offset:8192
v_mfma_f32_16x16x32_bf16 v[228:231], a[152:155], v[56:59], v[228:231]
ds_read_b64_tr_b16 a[174:175], v123 offset:9216
v_mfma_f32_16x16x32_bf16 v[232:235], a[152:155], v[60:63], v[232:235]
s_add_u32 m0, s48, 32768
s_nop 0
buffer_load_dwordx4 v10, s[24:27], s44 offen offset:0 nt lds
v_mfma_f32_16x16x32_bf16 v[236:239], a[156:159], v[52:55], v[236:239]
v_mfma_f32_16x16x32_bf16 v[240:243], a[156:159], v[56:59], v[240:243]
v_mfma_f32_16x16x32_bf16 v[244:247], a[156:159], v[60:63], v[244:247]
s_waitcnt lgkmcnt(4)
v_mfma_f32_16x16x32_bf16 v[152:155], a[160:163], v[64:67], v[152:155]
ds_read_b64_tr_b16 a[176:177], v124 offset:8192
ds_read_b64_tr_b16 a[178:179], v124 offset:9216
v_mfma_f32_16x16x32_bf16 v[156:159], a[160:163], v[68:71], v[156:159]
ds_read_b64_tr_b16 a[180:181], v125 offset:8192
v_mfma_f32_16x16x32_bf16 v[160:163], a[160:163], v[72:75], v[160:163]
ds_read_b64_tr_b16 a[182:183], v125 offset:9216
v_mfma_f32_16x16x32_bf16 v[164:167], a[164:167], v[64:67], v[164:167]
ds_read_b64_tr_b16 a[184:185], v126 offset:8192
ds_read_b64_tr_b16 a[186:187], v126 offset:9216
s_add_u32 m0, s48, 32768
s_nop 0
buffer_load_dwordx4 v11, s[24:27], s44 offen offset:1024 nt lds
v_mfma_f32_16x16x32_bf16 v[168:171], a[164:167], v[68:71], v[168:171]
ds_read_b64_tr_b16 a[188:189], v127 offset:8192
v_mfma_f32_16x16x32_bf16 v[172:175], a[164:167], v[72:75], v[172:175]
ds_read_b64_tr_b16 a[190:191], v127 offset:9216
s_waitcnt lgkmcnt(8)
v_mfma_f32_16x16x32_bf16 v[176:179], a[168:171], v[64:67], v[176:179]
v_mfma_f32_16x16x32_bf16 v[180:183], a[168:171], v[68:71], v[180:183]
v_mfma_f32_16x16x32_bf16 v[184:187], a[168:171], v[72:75], v[184:187]
v_mfma_f32_16x16x32_bf16 v[188:191], a[172:175], v[64:67], v[188:191]
v_mfma_f32_16x16x32_bf16 v[192:195], a[172:175], v[68:71], v[192:195]
v_mfma_f32_16x16x32_bf16 v[196:199], a[172:175], v[72:75], v[196:199]
s_waitcnt lgkmcnt(4)
s_waitcnt lgkmcnt(0)
s_waitcnt vmcnt(6)
s_barrier
v_mfma_f32_16x16x32_bf16 v[200:203], a[176:179], v[64:67], v[200:203]
v_add_u32 v120, 118784, v112
v_add_u32 v121, 118784, v113
v_add_u32 v122, 118784, v114
v_add_u32 v123, 118784, v115
v_mfma_f32_16x16x32_bf16 v[204:207], a[176:179], v[68:71], v[204:207]
s_add_u32 s61, s52, 6
s_and_b32 s61, s61, 7
s_lshl_b32 s62, s61, 7
s_add_u32 s62, s62, s50
s_lshl_b32 s61, s61, 19
s_add_u32 s61, s61, s53
s_add_u32 m0, s59, 73728
s_add_u32 s55, s61, 0
buffer_load_dwordx4 v16, s[32:35], s55 offen lds
v_add_u32 v124, 118784, v116
v_add_u32 v125, 118784, v117
v_add_u32 v126, 118784, v118
v_mfma_f32_16x16x32_bf16 v[208:211], a[176:179], v[72:75], v[208:211]
s_add_u32 m0, s59, 74752
s_add_u32 s55, s61, 32768
buffer_load_dwordx4 v16, s[32:35], s55 offen lds
v_add_u32 v127, 118784, v119
v_add_u32 v41, 118784, v7
v_add_u32 v42, 118784, v8
v_mfma_f32_16x16x32_bf16 v[212:215], a[180:183], v[64:67], v[212:215]
ds_read_b128 v[52:55], v41 offset:0
ds_read_b128 v[56:59], v41 offset:2048
v_mfma_f32_16x16x32_bf16 v[216:219], a[180:183], v[68:71], v[216:219]
s_add_u32 m0, s59, 75776
s_add_u32 s55, s61, 65536
buffer_load_dwordx4 v33, s[32:35], s55 offen lds
ds_read_b128 v[60:63], v41 offset:4096
v_mfma_f32_16x16x32_bf16 v[220:223], a[180:183], v[72:75], v[220:223]
ds_read_b64_tr_b16 a[128:129], v120 offset:0
v_mfma_f32_16x16x32_bf16 v[224:227], a[184:187], v[64:67], v[224:227]
s_add_u32 m0, s59, 76800
s_add_u32 s55, s61, 98304
buffer_load_dwordx4 v33, s[32:35], s55 offen lds
ds_read_b64_tr_b16 a[130:131], v120 offset:1024
v_mfma_f32_16x16x32_bf16 v[228:231], a[184:187], v[68:71], v[228:231]
ds_read_b64_tr_b16 a[132:133], v121 offset:0
ds_read_b64_tr_b16 a[134:135], v121 offset:1024
v_mfma_f32_16x16x32_bf16 v[232:235], a[184:187], v[72:75], v[232:235]
s_add_u32 m0, s59, 77824
s_add_u32 s55, s61, 131072
buffer_load_dwordx4 v16, s[32:35], s55 offen lds
ds_read_b64_tr_b16 a[136:137], v122 offset:0
v_mfma_f32_16x16x32_bf16 v[236:239], a[188:191], v[64:67], v[236:239]
ds_read_b64_tr_b16 a[138:139], v122 offset:1024
v_mfma_f32_16x16x32_bf16 v[240:243], a[188:191], v[68:71], v[240:243]
s_add_u32 m0, s59, 78848
s_add_u32 s55, s61, 163840
buffer_load_dwordx4 v16, s[32:35], s55 offen lds
ds_read_b64_tr_b16 a[140:141], v123 offset:0
v_mfma_f32_16x16x32_bf16 v[244:247], a[188:191], v[72:75], v[244:247]
ds_read_b64_tr_b16 a[142:143], v123 offset:1024
s_waitcnt lgkmcnt(4)
v_mfma_f32_16x16x32_bf16 v[152:155], a[128:131], v[52:55], v[152:155]
ds_read_b64_tr_b16 a[144:145], v124 offset:0
ds_read_b64_tr_b16 a[146:147], v124 offset:1024
s_add_u32 m0, s59, 79872
s_add_u32 s55, s61, 196608
buffer_load_dwordx4 v33, s[32:35], s55 offen lds
v_mfma_f32_16x16x32_bf16 v[156:159], a[128:131], v[56:59], v[156:159]
ds_read_b64_tr_b16 a[148:149], v125 offset:0
v_mfma_f32_16x16x32_bf16 v[160:163], a[128:131], v[60:63], v[160:163]
ds_read_b64_tr_b16 a[150:151], v125 offset:1024
s_add_u32 m0, s59, 80896
s_add_u32 s55, s61, 229376
buffer_load_dwordx4 v33, s[32:35], s55 offen lds
v_mfma_f32_16x16x32_bf16 v[164:167], a[132:135], v[52:55], v[164:167]
ds_read_b64_tr_b16 a[152:153], v126 offset:0
ds_read_b64_tr_b16 a[154:155], v126 offset:1024
v_mfma_f32_16x16x32_bf16 v[168:171], a[132:135], v[56:59], v[168:171]
ds_read_b64_tr_b16 a[156:157], v127 offset:0
v_mfma_f32_16x16x32_bf16 v[172:175], a[132:135], v[60:63], v[172:175]
ds_read_b64_tr_b16 a[158:159], v127 offset:1024
s_add_u32 m0, s60, 106496
s_add_u32 s55, s62, 0
buffer_load_dwordx4 v17, s[20:23], s55 offen lds
s_waitcnt lgkmcnt(8)
v_mfma_f32_16x16x32_bf16 v[176:179], a[136:139], v[52:55], v[176:179]
v_mfma_f32_16x16x32_bf16 v[180:183], a[136:139], v[56:59], v[180:183]
v_mfma_f32_16x16x32_bf16 v[184:187], a[136:139], v[60:63], v[184:187]
s_add_u32 m0, s60, 107520
s_add_u32 s55, s62, 8192
buffer_load_dwordx4 v9, s[20:23], s55 offen lds
v_mfma_f32_16x16x32_bf16 v[188:191], a[140:143], v[52:55], v[188:191]
v_mfma_f32_16x16x32_bf16 v[192:195], a[140:143], v[56:59], v[192:195]
v_mfma_f32_16x16x32_bf16 v[196:199], a[140:143], v[60:63], v[196:199]
s_add_u32 m0, s60, 108544
s_add_u32 s55, s62, 16384
buffer_load_dwordx4 v17, s[20:23], s55 offen lds
s_waitcnt lgkmcnt(4)
v_mfma_f32_16x16x32_bf16 v[200:203], a[144:147], v[52:55], v[200:203]
ds_read_b128 v[64:67], v42 offset:0
ds_read_b128 v[68:71], v42 offset:2048
v_mfma_f32_16x16x32_bf16 v[204:207], a[144:147], v[56:59], v[204:207]
ds_read_b128 v[72:75], v42 offset:4096
v_mfma_f32_16x16x32_bf16 v[208:211], a[144:147], v[60:63], v[208:211]
ds_read_b64_tr_b16 a[160:161], v120 offset:8192
ds_read_b64_tr_b16 a[162:163], v120 offset:9216
v_mfma_f32_16x16x32_bf16 v[212:215], a[148:151], v[52:55], v[212:215]
ds_read_b64_tr_b16 a[164:165], v121 offset:8192
v_mfma_f32_16x16x32_bf16 v[216:219], a[148:151], v[56:59], v[216:219]
ds_read_b64_tr_b16 a[166:167], v121 offset:9216
v_mfma_f32_16x16x32_bf16 v[220:223], a[148:151], v[60:63], v[220:223]
ds_read_b64_tr_b16 a[168:169], v122 offset:8192
ds_read_b64_tr_b16 a[170:171], v122 offset:9216
s_waitcnt lgkmcnt(9)
v_mfma_f32_16x16x32_bf16 v[224:227], a[152:155], v[52:55], v[224:227]
ds_read_b64_tr_b16 a[172:173], v123 offset:8192
v_mfma_f32_16x16x32_bf16 v[228:231], a[152:155], v[56:59], v[228:231]
ds_read_b64_tr_b16 a[174:175], v123 offset:9216
v_mfma_f32_16x16x32_bf16 v[232:235], a[152:155], v[60:63], v[232:235]
v_mfma_f32_16x16x32_bf16 v[236:239], a[156:159], v[52:55], v[236:239]
v_mfma_f32_16x16x32_bf16 v[240:243], a[156:159], v[56:59], v[240:243]
v_mfma_f32_16x16x32_bf16 v[244:247], a[156:159], v[60:63], v[244:247]
s_waitcnt lgkmcnt(4)
v_mfma_f32_16x16x32_bf16 v[152:155], a[160:163], v[64:67], v[152:155]
ds_read_b64_tr_b16 a[176:177], v124 offset:8192
ds_read_b64_tr_b16 a[178:179], v124 offset:9216
v_mfma_f32_16x16x32_bf16 v[156:159], a[160:163], v[68:71], v[156:159]
ds_read_b64_tr_b16 a[180:181], v125 offset:8192
v_mfma_f32_16x16x32_bf16 v[160:163], a[160:163], v[72:75], v[160:163]
ds_read_b64_tr_b16 a[182:183], v125 offset:9216
v_mfma_f32_16x16x32_bf16 v[164:167], a[164:167], v[64:67], v[164:167]
ds_read_b64_tr_b16 a[184:185], v126 offset:8192
ds_read_b64_tr_b16 a[186:187], v126 offset:9216
v_mfma_f32_16x16x32_bf16 v[168:171], a[164:167], v[68:71], v[168:171]
ds_read_b64_tr_b16 a[188:189], v127 offset:8192
v_mfma_f32_16x16x32_bf16 v[172:175], a[164:167], v[72:75], v[172:175]
ds_read_b64_tr_b16 a[190:191], v127 offset:9216
s_waitcnt lgkmcnt(8)
v_mfma_f32_16x16x32_bf16 v[176:179], a[168:171], v[64:67], v[176:179]
v_mfma_f32_16x16x32_bf16 v[180:183], a[168:171], v[68:71], v[180:183]
v_mfma_f32_16x16x32_bf16 v[184:187], a[168:171], v[72:75], v[184:187]
v_mfma_f32_16x16x32_bf16 v[188:191], a[172:175], v[64:67], v[188:191]
v_mfma_f32_16x16x32_bf16 v[192:195], a[172:175], v[68:71], v[192:195]
v_mfma_f32_16x16x32_bf16 v[196:199], a[172:175], v[72:75], v[196:199]
s_waitcnt lgkmcnt(4)
s_waitcnt lgkmcnt(0)
s_waitcnt vmcnt(0)
s_barrier
v_mfma_f32_16x16x32_bf16 v[200:203], a[176:179], v[64:67], v[200:203]
v_add_u32 v120, 73728, v112
v_add_u32 v121, 73728, v113
v_add_u32 v122, 73728, v114
v_add_u32 v123, 73728, v115
v_mfma_f32_16x16x32_bf16 v[204:207], a[176:179], v[68:71], v[204:207]
s_add_u32 s61, s52, 7
s_and_b32 s61, s61, 7
s_lshl_b32 s62, s61, 7
s_add_u32 s62, s62, s50
s_lshl_b32 s61, s61, 19
s_add_u32 s61, s61, s53
s_add_u32 m0, s59, 118784
s_add_u32 s55, s61, 0
buffer_load_dwordx4 v16, s[32:35], s55 offen lds
v_add_u32 v124, 73728, v116
v_add_u32 v125, 73728, v117
v_add_u32 v126, 73728, v118
v_mfma_f32_16x16x32_bf16 v[208:211], a[176:179], v[72:75], v[208:211]
s_add_u32 m0, s59, 119808
s_add_u32 s55, s61, 32768
buffer_load_dwordx4 v16, s[32:35], s55 offen lds
v_add_u32 v127, 73728, v119
v_add_u32 v41, 73728, v7
v_add_u32 v42, 73728, v8
v_mfma_f32_16x16x32_bf16 v[212:215], a[180:183], v[64:67], v[212:215]
ds_read_b128 v[52:55], v41 offset:0
ds_read_b128 v[56:59], v41 offset:2048
v_mfma_f32_16x16x32_bf16 v[216:219], a[180:183], v[68:71], v[216:219]
s_add_u32 m0, s59, 120832
s_add_u32 s55, s61, 65536
buffer_load_dwordx4 v33, s[32:35], s55 offen lds
ds_read_b128 v[60:63], v41 offset:4096
v_mfma_f32_16x16x32_bf16 v[220:223], a[180:183], v[72:75], v[220:223]
ds_read_b64_tr_b16 a[128:129], v120 offset:0
v_mfma_f32_16x16x32_bf16 v[224:227], a[184:187], v[64:67], v[224:227]
s_add_u32 m0, s59, 121856
s_add_u32 s55, s61, 98304
buffer_load_dwordx4 v33, s[32:35], s55 offen lds
ds_read_b64_tr_b16 a[130:131], v120 offset:1024
v_mfma_f32_16x16x32_bf16 v[228:231], a[184:187], v[68:71], v[228:231]
ds_read_b64_tr_b16 a[132:133], v121 offset:0
ds_read_b64_tr_b16 a[134:135], v121 offset:1024
v_mfma_f32_16x16x32_bf16 v[232:235], a[184:187], v[72:75], v[232:235]
s_add_u32 m0, s59, 122880
s_add_u32 s55, s61, 131072
buffer_load_dwordx4 v16, s[32:35], s55 offen lds
ds_read_b64_tr_b16 a[136:137], v122 offset:0
v_mfma_f32_16x16x32_bf16 v[236:239], a[188:191], v[64:67], v[236:239]
ds_read_b64_tr_b16 a[138:139], v122 offset:1024
v_mfma_f32_16x16x32_bf16 v[240:243], a[188:191], v[68:71], v[240:243]
s_add_u32 m0, s59, 123904
s_add_u32 s55, s61, 163840
buffer_load_dwordx4 v16, s[32:35], s55 offen lds
ds_read_b64_tr_b16 a[140:141], v123 offset:0
v_mfma_f32_16x16x32_bf16 v[244:247], a[188:191], v[72:75], v[244:247]
ds_read_b64_tr_b16 a[142:143], v123 offset:1024
s_waitcnt lgkmcnt(4)
v_mfma_f32_16x16x32_bf16 v[152:155], a[128:131], v[52:55], v[152:155]
ds_read_b64_tr_b16 a[144:145], v124 offset:0
ds_read_b64_tr_b16 a[146:147], v124 offset:1024
s_add_u32 m0, s59, 124928
s_add_u32 s55, s61, 196608
buffer_load_dwordx4 v33, s[32:35], s55 offen lds
v_mfma_f32_16x16x32_bf16 v[156:159], a[128:131], v[56:59], v[156:159]
ds_read_b64_tr_b16 a[148:149], v125 offset:0
v_mfma_f32_16x16x32_bf16 v[160:163], a[128:131], v[60:63], v[160:163]
ds_read_b64_tr_b16 a[150:151], v125 offset:1024
s_add_u32 m0, s59, 125952
s_add_u32 s55, s61, 229376
buffer_load_dwordx4 v33, s[32:35], s55 offen lds
v_mfma_f32_16x16x32_bf16 v[164:167], a[132:135], v[52:55], v[164:167]
ds_read_b64_tr_b16 a[152:153], v126 offset:0
ds_read_b64_tr_b16 a[154:155], v126 offset:1024
v_mfma_f32_16x16x32_bf16 v[168:171], a[132:135], v[56:59], v[168:171]
ds_read_b64_tr_b16 a[156:157], v127 offset:0
s_add_u32 m0, s60, 151552
s_add_u32 s55, s62, 0
buffer_load_dwordx4 v17, s[20:23], s55 offen lds
v_mfma_f32_16x16x32_bf16 v[172:175], a[132:135], v[60:63], v[172:175]
ds_read_b64_tr_b16 a[158:159], v127 offset:1024
s_waitcnt lgkmcnt(8)
v_mfma_f32_16x16x32_bf16 v[176:179], a[136:139], v[52:55], v[176:179]
s_add_u32 m0, s60, 152576
s_add_u32 s55, s62, 8192
buffer_load_dwordx4 v9, s[20:23], s55 offen lds
v_mfma_f32_16x16x32_bf16 v[180:183], a[136:139], v[56:59], v[180:183]
v_mfma_f32_16x16x32_bf16 v[184:187], a[136:139], v[60:63], v[184:187]
s_add_u32 m0, s60, 153600
s_add_u32 s55, s62, 16384
buffer_load_dwordx4 v17, s[20:23], s55 offen lds
v_mfma_f32_16x16x32_bf16 v[188:191], a[140:143], v[52:55], v[188:191]
v_mfma_f32_16x16x32_bf16 v[192:195], a[140:143], v[56:59], v[192:195]
s_add_u32 m0, s48, 32768
s_nop 0
buffer_load_dwordx4 v12, s[24:27], s44 offen offset:2048 nt lds
v_mfma_f32_16x16x32_bf16 v[196:199], a[140:143], v[60:63], v[196:199]
s_waitcnt lgkmcnt(4)
v_mfma_f32_16x16x32_bf16 v[200:203], a[144:147], v[52:55], v[200:203]
ds_read_b128 v[64:67], v42 offset:0
ds_read_b128 v[68:71], v42 offset:2048
s_add_u32 m0, s48, 32768
s_nop 0
buffer_load_dwordx4 v13, s[24:27], s44 offen offset:3072 nt lds
s_add_u32 s44, s44, 8192
v_mfma_f32_16x16x32_bf16 v[204:207], a[144:147], v[56:59], v[204:207]
ds_read_b128 v[72:75], v42 offset:4096
v_mfma_f32_16x16x32_bf16 v[208:211], a[144:147], v[60:63], v[208:211]
ds_read_b64_tr_b16 a[160:161], v120 offset:8192
ds_read_b64_tr_b16 a[162:163], v120 offset:9216
v_mfma_f32_16x16x32_bf16 v[212:215], a[148:151], v[52:55], v[212:215]
ds_read_b64_tr_b16 a[164:165], v121 offset:8192
v_mfma_f32_16x16x32_bf16 v[216:219], a[148:151], v[56:59], v[216:219]
ds_read_b64_tr_b16 a[166:167], v121 offset:9216
v_mfma_f32_16x16x32_bf16 v[220:223], a[148:151], v[60:63], v[220:223]
ds_read_b64_tr_b16 a[168:169], v122 offset:8192
ds_read_b64_tr_b16 a[170:171], v122 offset:9216
s_waitcnt lgkmcnt(9)
v_mfma_f32_16x16x32_bf16 v[224:227], a[152:155], v[52:55], v[224:227]
ds_read_b64_tr_b16 a[172:173], v123 offset:8192
v_mfma_f32_16x16x32_bf16 v[228:231], a[152:155], v[56:59], v[228:231]
ds_read_b64_tr_b16 a[174:175], v123 offset:9216
v_mfma_f32_16x16x32_bf16 v[232:235], a[152:155], v[60:63], v[232:235]
v_mfma_f32_16x16x32_bf16 v[236:239], a[156:159], v[52:55], v[236:239]
v_mfma_f32_16x16x32_bf16 v[240:243], a[156:159], v[56:59], v[240:243]
v_mfma_f32_16x16x32_bf16 v[244:247], a[156:159], v[60:63], v[244:247]
s_waitcnt lgkmcnt(4)
v_mfma_f32_16x16x32_bf16 v[152:155], a[160:163], v[64:67], v[152:155]
ds_read_b64_tr_b16 a[176:177], v124 offset:8192
ds_read_b64_tr_b16 a[178:179], v124 offset:9216
v_mfma_f32_16x16x32_bf16 v[156:159], a[160:163], v[68:71], v[156:159]
ds_read_b64_tr_b16 a[180:181], v125 offset:8192
v_mfma_f32_16x16x32_bf16 v[160:163], a[160:163], v[72:75], v[160:163]
ds_read_b64_tr_b16 a[182:183], v125 offset:9216
v_mfma_f32_16x16x32_bf16 v[164:167], a[164:167], v[64:67], v[164:167]
ds_read_b64_tr_b16 a[184:185], v126 offset:8192
ds_read_b64_tr_b16 a[186:187], v126 offset:9216
v_mfma_f32_16x16x32_bf16 v[168:171], a[164:167], v[68:71], v[168:171]
ds_read_b64_tr_b16 a[188:189], v127 offset:8192
v_mfma_f32_16x16x32_bf16 v[172:175], a[164:167], v[72:75], v[172:175]
ds_read_b64_tr_b16 a[190:191], v127 offset:9216
s_waitcnt lgkmcnt(8)
v_mfma_f32_16x16x32_bf16 v[176:179], a[168:171], v[64:67], v[176:179]
v_mfma_f32_16x16x32_bf16 v[180:183], a[168:171], v[68:71], v[180:183]
v_mfma_f32_16x16x32_bf16 v[184:187], a[168:171], v[72:75], v[184:187]
v_mfma_f32_16x16x32_bf16 v[188:191], a[172:175], v[64:67], v[188:191]
v_mfma_f32_16x16x32_bf16 v[192:195], a[172:175], v[68:71], v[192:195]
v_mfma_f32_16x16x32_bf16 v[196:199], a[172:175], v[72:75], v[196:199]
s_waitcnt lgkmcnt(4)
s_waitcnt lgkmcnt(0)
s_waitcnt vmcnt(2)
s_barrier
v_mfma_f32_16x16x32_bf16 v[200:203], a[176:179], v[64:67], v[200:203]
v_add_u32 v120, 118784, v112
v_add_u32 v121, 118784, v113
v_add_u32 v122, 118784, v114
v_add_u32 v123, 118784, v115
v_mfma_f32_16x16x32_bf16 v[204:207], a[176:179], v[68:71], v[204:207]
s_add_u32 m0, s48, 65536
s_nop 0
buffer_load_dwordx4 v10, s[24:27], s44 offen offset:0 nt lds
v_add_u32 v124, 118784, v116
v_add_u32 v125, 118784, v117
v_add_u32 v126, 118784, v118
v_mfma_f32_16x16x32_bf16 v[208:211], a[176:179], v[72:75], v[208:211]
v_add_u32 v127, 118784, v119
v_add_u32 v41, 118784, v7
v_add_u32 v42, 118784, v8
v_mfma_f32_16x16x32_bf16 v[212:215], a[180:183], v[64:67], v[212:215]
ds_read_b128 v[52:55], v41 offset:0
ds_read_b128 v[56:59], v41 offset:2048
v_mfma_f32_16x16x32_bf16 v[216:219], a[180:183], v[68:71], v[216:219]
ds_read_b128 v[60:63], v41 offset:4096
v_mfma_f32_16x16x32_bf16 v[220:223], a[180:183], v[72:75], v[220:223]
ds_read_b64_tr_b16 a[128:129], v120 offset:0
v_mfma_f32_16x16x32_bf16 v[224:227], a[184:187], v[64:67], v[224:227]
s_add_u32 m0, s48, 65536
s_nop 0
buffer_load_dwordx4 v11, s[24:27], s44 offen offset:1024 nt lds
ds_read_b64_tr_b16 a[130:131], v120 offset:1024
v_mfma_f32_16x16x32_bf16 v[228:231], a[184:187], v[68:71], v[228:231]
ds_read_b64_tr_b16 a[132:133], v121 offset:0
ds_read_b64_tr_b16 a[134:135], v121 offset:1024
v_mfma_f32_16x16x32_bf16 v[232:235], a[184:187], v[72:75], v[232:235]
ds_read_b64_tr_b16 a[136:137], v122 offset:0
v_mfma_f32_16x16x32_bf16 v[236:239], a[188:191], v[64:67], v[236:239]
ds_read_b64_tr_b16 a[138:139], v122 offset:1024
v_mfma_f32_16x16x32_bf16 v[240:243], a[188:191], v[68:71], v[240:243]
ds_read_b64_tr_b16 a[140:141], v123 offset:0
v_mfma_f32_16x16x32_bf16 v[244:247], a[188:191], v[72:75], v[244:247]
ds_read_b64_tr_b16 a[142:143], v123 offset:1024
s_waitcnt lgkmcnt(4)
v_mfma_f32_16x16x32_bf16 v[152:155], a[128:131], v[52:55], v[152:155]
ds_read_b64_tr_b16 a[144:145], v124 offset:0
ds_read_b64_tr_b16 a[146:147], v124 offset:1024
s_add_u32 m0, s48, 65536
s_nop 0
buffer_load_dwordx4 v12, s[24:27], s44 offen offset:2048 nt lds
v_mfma_f32_16x16x32_bf16 v[156:159], a[128:131], v[56:59], v[156:159]
ds_read_b64_tr_b16 a[148:149], v125 offset:0
v_mfma_f32_16x16x32_bf16 v[160:163], a[128:131], v[60:63], v[160:163]
ds_read_b64_tr_b16 a[150:151], v125 offset:1024
v_mfma_f32_16x16x32_bf16 v[164:167], a[132:135], v[52:55], v[164:167]
ds_read_b64_tr_b16 a[152:153], v126 offset:0
ds_read_b64_tr_b16 a[154:155], v126 offset:1024
v_mfma_f32_16x16x32_bf16 v[168:171], a[132:135], v[56:59], v[168:171]
ds_read_b64_tr_b16 a[156:157], v127 offset:0
v_mfma_f32_16x16x32_bf16 v[172:175], a[132:135], v[60:63], v[172:175]
ds_read_b64_tr_b16 a[158:159], v127 offset:1024
s_add_u32 m0, s48, 65536
s_nop 0
buffer_load_dwordx4 v13, s[24:27], s44 offen offset:3072 nt lds
s_add_u32 s44, s44, 8192
s_waitcnt lgkmcnt(8)
v_mfma_f32_16x16x32_bf16 v[176:179], a[136:139], v[52:55], v[176:179]
v_mfma_f32_16x16x32_bf16 v[180:183], a[136:139], v[56:59], v[180:183]
v_mfma_f32_16x16x32_bf16 v[184:187], a[136:139], v[60:63], v[184:187]
v_mfma_f32_16x16x32_bf16 v[188:191], a[140:143], v[52:55], v[188:191]
v_mfma_f32_16x16x32_bf16 v[192:195], a[140:143], v[56:59], v[192:195]
v_mfma_f32_16x16x32_bf16 v[196:199], a[140:143], v[60:63], v[196:199]
s_add_u32 m0, s48, 98304
s_nop 0
buffer_load_dwordx4 v10, s[24:27], s44 offen offset:0 nt lds
s_waitcnt lgkmcnt(4)
v_mfma_f32_16x16x32_bf16 v[200:203], a[144:147], v[52:55], v[200:203]
ds_read_b128 v[64:67], v42 offset:0
ds_read_b128 v[68:71], v42 offset:2048
v_mfma_f32_16x16x32_bf16 v[204:207], a[144:147], v[56:59], v[204:207]
ds_read_b128 v[72:75], v42 offset:4096
v_mfma_f32_16x16x32_bf16 v[208:211], a[144:147], v[60:63], v[208:211]
ds_read_b64_tr_b16 a[160:161], v120 offset:8192
ds_read_b64_tr_b16 a[162:163], v120 offset:9216
v_mfma_f32_16x16x32_bf16 v[212:215], a[148:151], v[52:55], v[212:215]
ds_read_b64_tr_b16 a[164:165], v121 offset:8192
v_mfma_f32_16x16x32_bf16 v[216:219], a[148:151], v[56:59], v[216:219]
ds_read_b64_tr_b16 a[166:167], v121 offset:9216
v_mfma_f32_16x16x32_bf16 v[220:223], a[148:151], v[60:63], v[220:223]
ds_read_b64_tr_b16 a[168:169], v122 offset:8192
ds_read_b64_tr_b16 a[170:171], v122 offset:9216
s_add_u32 m0, s48, 98304
s_nop 0
buffer_load_dwordx4 v11, s[24:27], s44 offen offset:1024 nt lds
s_waitcnt lgkmcnt(9)
v_mfma_f32_16x16x32_bf16 v[224:227], a[152:155], v[52:55], v[224:227]
ds_read_b64_tr_b16 a[172:173], v123 offset:8192
v_mfma_f32_16x16x32_bf16 v[228:231], a[152:155], v[56:59], v[228:231]
ds_read_b64_tr_b16 a[174:175], v123 offset:9216
v_mfma_f32_16x16x32_bf16 v[232:235], a[152:155], v[60:63], v[232:235]
v_mfma_f32_16x16x32_bf16 v[236:239], a[156:159], v[52:55], v[236:239]
v_mfma_f32_16x16x32_bf16 v[240:243], a[156:159], v[56:59], v[240:243]
s_add_u32 m0, s48, 98304
s_nop 0
buffer_load_dwordx4 v12, s[24:27], s44 offen offset:2048 nt lds
v_mfma_f32_16x16x32_bf16 v[244:247], a[156:159], v[60:63], v[244:247]
s_waitcnt lgkmcnt(4)
v_mfma_f32_16x16x32_bf16 v[152:155], a[160:163], v[64:67], v[152:155]
ds_read_b64_tr_b16 a[176:177], v124 offset:8192
ds_read_b64_tr_b16 a[178:179], v124 offset:9216
v_mfma_f32_16x16x32_bf16 v[156:159], a[160:163], v[68:71], v[156:159]
ds_read_b64_tr_b16 a[180:181], v125 offset:8192
v_mfma_f32_16x16x32_bf16 v[160:163], a[160:163], v[72:75], v[160:163]
ds_read_b64_tr_b16 a[182:183], v125 offset:9216
v_mfma_f32_16x16x32_bf16 v[164:167], a[164:167], v[64:67], v[164:167]
ds_read_b64_tr_b16 a[184:185], v126 offset:8192
ds_read_b64_tr_b16 a[186:187], v126 offset:9216
v_mfma_f32_16x16x32_bf16 v[168:171], a[164:167], v[68:71], v[168:171]
ds_read_b64_tr_b16 a[188:189], v127 offset:8192
s_add_u32 m0, s48, 98304
s_nop 0
buffer_load_dwordx4 v13, s[24:27], s44 offen offset:3072 nt lds
s_add_u32 s44, s44, 8192
v_mfma_f32_16x16x32_bf16 v[172:175], a[164:167], v[72:75], v[172:175]
ds_read_b64_tr_b16 a[190:191], v127 offset:9216
s_waitcnt lgkmcnt(8)
v_mfma_f32_16x16x32_bf16 v[176:179], a[168:171], v[64:67], v[176:179]
v_mfma_f32_16x16x32_bf16 v[180:183], a[168:171], v[68:71], v[180:183]
v_mfma_f32_16x16x32_bf16 v[184:187], a[168:171], v[72:75], v[184:187]
v_mfma_f32_16x16x32_bf16 v[188:191], a[172:175], v[64:67], v[188:191]
v_mfma_f32_16x16x32_bf16 v[192:195], a[172:175], v[68:71], v[192:195]
v_mfma_f32_16x16x32_bf16 v[196:199], a[172:175], v[72:75], v[196:199]
s_waitcnt lgkmcnt(4)
s_waitcnt lgkmcnt(0)
s_waitcnt vmcnt(8)
s_barrier
v_mfma_f32_16x16x32_bf16 v[200:203], a[176:179], v[64:67], v[200:203]
v_mfma_f32_16x16x32_bf16 v[204:207], a[176:179], v[68:71], v[204:207]
v_mfma_f32_16x16x32_bf16 v[208:211], a[176:179], v[72:75], v[208:211]
v_mfma_f32_16x16x32_bf16 v[212:215], a[180:183], v[64:67], v[212:215]
v_mfma_f32_16x16x32_bf16 v[216:219], a[180:183], v[68:71], v[216:219]
v_mfma_f32_16x16x32_bf16 v[220:223], a[180:183], v[72:75], v[220:223]
v_mfma_f32_16x16x32_bf16 v[224:227], a[184:187], v[64:67], v[224:227]
v_mfma_f32_16x16x32_bf16 v[228:231], a[184:187], v[68:71], v[228:231]
v_mfma_f32_16x16x32_bf16 v[232:235], a[184:187], v[72:75], v[232:235]
v_mfma_f32_16x16x32_bf16 v[236:239], a[188:191], v[64:67], v[236:239]
v_mfma_f32_16x16x32_bf16 v[240:243], a[188:191], v[68:71], v[240:243]
v_mfma_f32_16x16x32_bf16 v[244:247], a[188:191], v[72:75], v[244:247]
ds_read_b128 a[64:67], v18 offset:0
ds_read_b128 a[68:71], v18 offset:4096
ds_read_b128 a[72:75], v19 offset:0
ds_read_b128 a[76:79], v19 offset:4096
ds_read_b128 a[80:83], v20 offset:0
ds_read_b128 a[84:87], v20 offset:4096
ds_read_b128 a[88:91], v21 offset:0
ds_read_b128 a[92:95], v21 offset:4096
v_add_u32 v18, 32768, v18
v_add_u32 v19, 32768, v19
v_add_u32 v20, 32768, v20
v_add_u32 v21, 32768, v21
v_cvt_pk_bf16_f32 v112, v152, v153
v_cvt_pk_bf16_f32 v113, v154, v155
v_cvt_pk_bf16_f32 v114, v164, v165
v_cvt_pk_bf16_f32 v115, v166, v167
v_cvt_pk_bf16_f32 v116, v156, v157
v_cvt_pk_bf16_f32 v117, v158, v159
v_cvt_pk_bf16_f32 v118, v168, v169
v_cvt_pk_bf16_f32 v119, v170, v171
v_permlane32_swap_b32 v112, v114
v_permlane32_swap_b32 v113, v115
v_cvt_pk_bf16_f32 v120, v160, v161
v_cvt_pk_bf16_f32 v121, v162, v163
v_cvt_pk_bf16_f32 v122, v172, v173
v_cvt_pk_bf16_f32 v123, v174, v175
v_permlane32_swap_b32 v116, v118
v_permlane32_swap_b32 v117, v119
v_permlane16_swap_b32 v112, v114
v_permlane16_swap_b32 v113, v115
v_cvt_pk_bf16_f32 v124, v176, v177
v_cvt_pk_bf16_f32 v125, v178, v179
v_cvt_pk_bf16_f32 v126, v188, v189
v_cvt_pk_bf16_f32 v127, v190, v191
v_permlane32_swap_b32 v120, v122
v_permlane32_swap_b32 v121, v123
v_permlane16_swap_b32 v116, v118
v_permlane16_swap_b32 v117, v119
v_accvgpr_write_b32 a0, v112
v_accvgpr_write_b32 a1, v113
v_accvgpr_write_b32 a2, v114
v_accvgpr_write_b32 a3, v115
v_cvt_pk_bf16_f32 v112, v180, v181
v_cvt_pk_bf16_f32 v113, v182, v183
v_cvt_pk_bf16_f32 v114, v192, v193
v_cvt_pk_bf16_f32 v115, v194, v195
v_permlane32_swap_b32 v124, v126
v_permlane32_swap_b32 v125, v127
v_permlane16_swap_b32 v120, v122
v_permlane16_swap_b32 v121, v123
v_accvgpr_write_b32 a4, v116
v_accvgpr_write_b32 a5, v117
v_accvgpr_write_b32 a6, v118
v_accvgpr_write_b32 a7, v119
v_cvt_pk_bf16_f32 v116, v184, v185
v_cvt_pk_bf16_f32 v117, v186, v187
v_cvt_pk_bf16_f32 v118, v196, v197
v_cvt_pk_bf16_f32 v119, v198, v199
v_permlane32_swap_b32 v112, v114
v_permlane32_swap_b32 v113, v115
v_permlane16_swap_b32 v124, v126
v_permlane16_swap_b32 v125, v127
v_accvgpr_write_b32 a8, v120
v_accvgpr_write_b32 a9, v121
v_accvgpr_write_b32 a10, v122
v_accvgpr_write_b32 a11, v123
s_waitcnt lgkmcnt(6)
v_mfma_f32_16x16x32_bf16 v[52:55], a[64:67], a[0:3], 0
v_mfma_f32_16x16x32_bf16 v[56:59], a[64:67], a[4:7], 0
v_cvt_pk_bf16_f32 v120, v200, v201
v_cvt_pk_bf16_f32 v121, v202, v203
v_cvt_pk_bf16_f32 v122, v212, v213
v_cvt_pk_bf16_f32 v123, v214, v215
v_permlane32_swap_b32 v116, v118
v_permlane32_swap_b32 v117, v119
v_permlane16_swap_b32 v112, v114
v_permlane16_swap_b32 v113, v115
v_accvgpr_write_b32 a12, v124
v_accvgpr_write_b32 a13, v125
v_accvgpr_write_b32 a14, v126
v_accvgpr_write_b32 a15, v127
v_mfma_f32_16x16x32_bf16 v[60:63], a[64:67], a[8:11], 0
v_mfma_f32_16x16x32_bf16 v[64:67], a[68:71], a[0:3], 0
v_cvt_pk_bf16_f32 v124, v204, v205
v_cvt_pk_bf16_f32 v125, v206, v207
v_cvt_pk_bf16_f32 v126, v216, v217
v_cvt_pk_bf16_f32 v127, v218, v219
v_permlane32_swap_b32 v120, v122
v_permlane32_swap_b32 v121, v123
v_permlane16_swap_b32 v116, v118
v_permlane16_swap_b32 v117, v119
v_accvgpr_write_b32 a16, v112
v_accvgpr_write_b32 a17, v113
v_accvgpr_write_b32 a18, v114
v_accvgpr_write_b32 a19, v115
v_mfma_f32_16x16x32_bf16 v[68:71], a[68:71], a[4:7], 0
v_cvt_pk_bf16_f32 v112, v208, v209
v_cvt_pk_bf16_f32 v113, v210, v211
v_cvt_pk_bf16_f32 v114, v220, v221
v_cvt_pk_bf16_f32 v115, v222, v223
v_permlane32_swap_b32 v124, v126
v_permlane32_swap_b32 v125, v127
v_permlane16_swap_b32 v120, v122
v_permlane16_swap_b32 v121, v123
v_accvgpr_write_b32 a20, v116
v_accvgpr_write_b32 a21, v117
v_accvgpr_write_b32 a22, v118
v_accvgpr_write_b32 a23, v119
v_mfma_f32_16x16x32_bf16 v[72:75], a[68:71], a[8:11], 0
s_waitcnt lgkmcnt(4)
v_mfma_f32_16x16x32_bf16 v[52:55], a[72:75], a[12:15], v[52:55]
v_mfma_f32_16x16x32_bf16 v[56:59], a[72:75], a[16:19], v[56:59]
v_cvt_pk_bf16_f32 v116, v224, v225
v_cvt_pk_bf16_f32 v117, v226, v227
v_cvt_pk_bf16_f32 v118, v236, v237
v_cvt_pk_bf16_f32 v119, v238, v239
v_permlane32_swap_b32 v112, v114
v_permlane32_swap_b32 v113, v115
v_permlane16_swap_b32 v124, v126
v_permlane16_swap_b32 v125, v127
v_accvgpr_write_b32 a24, v120
v_accvgpr_write_b32 a25, v121
v_accvgpr_write_b32 a26, v122
v_accvgpr_write_b32 a27, v123
ds_read_b128 a[128:131], v18 offset:0
v_mfma_f32_16x16x32_bf16 v[60:63], a[72:75], a[20:23], v[60:63]
ds_read_b128 a[132:135], v18 offset:4096
v_mfma_f32_16x16x32_bf16 v[64:67], a[76:79], a[12:15], v[64:67]
v_cvt_pk_bf16_f32 v120, v228, v229
v_cvt_pk_bf16_f32 v121, v230, v231
v_cvt_pk_bf16_f32 v122, v240, v241
v_cvt_pk_bf16_f32 v123, v242, v243
v_permlane32_swap_b32 v116, v118
v_permlane32_swap_b32 v117, v119
v_permlane16_swap_b32 v112, v114
v_permlane16_swap_b32 v113, v115
v_accvgpr_write_b32 a28, v124
v_accvgpr_write_b32 a29, v125
v_accvgpr_write_b32 a30, v126
v_accvgpr_write_b32 a31, v127
ds_read_b128 a[136:139], v19 offset:0
v_mfma_f32_16x16x32_bf16 v[68:71], a[76:79], a[16:19], v[68:71]
v_cvt_pk_bf16_f32 v124, v232, v233
v_cvt_pk_bf16_f32 v125, v234, v235
v_cvt_pk_bf16_f32 v126, v244, v245
v_cvt_pk_bf16_f32 v127, v246, v247
v_permlane32_swap_b32 v120, v122
v_permlane32_swap_b32 v121, v123
v_permlane16_swap_b32 v116, v118
v_permlane16_swap_b32 v117, v119
v_accvgpr_write_b32 a32, v112
v_accvgpr_write_b32 a33, v113
v_accvgpr_write_b32 a34, v114
v_accvgpr_write_b32 a35, v115
ds_read_b128 a[140:143], v19 offset:4096
v_mfma_f32_16x16x32_bf16 v[72:75], a[76:79], a[20:23], v[72:75]
s_waitcnt lgkmcnt(6)
v_mfma_f32_16x16x32_bf16 v[52:55], a[80:83], a[24:27], v[52:55]
v_mfma_f32_16x16x32_bf16 v[56:59], a[80:83], a[28:31], v[56:59]
v_permlane32_swap_b32 v124, v126
v_permlane32_swap_b32 v125, v127
v_permlane16_swap_b32 v120, v122
v_permlane16_swap_b32 v121, v123
v_accvgpr_write_b32 a36, v116
v_accvgpr_write_b32 a37, v117
v_accvgpr_write_b32 a38, v118
v_accvgpr_write_b32 a39, v119
ds_read_b128 a[144:147], v20 offset:0
v_mfma_f32_16x16x32_bf16 v[60:63], a[80:83], a[32:35], v[60:63]
ds_read_b128 a[148:151], v20 offset:4096
v_mfma_f32_16x16x32_bf16 v[64:67], a[84:87], a[24:27], v[64:67]
v_permlane16_swap_b32 v124, v126
v_permlane16_swap_b32 v125, v127
v_accvgpr_write_b32 a40, v120
v_accvgpr_write_b32 a41, v121
v_accvgpr_write_b32 a42, v122
v_accvgpr_write_b32 a43, v123
ds_read_b128 a[152:155], v21 offset:0
v_mfma_f32_16x16x32_bf16 v[68:71], a[84:87], a[28:31], v[68:71]
v_accvgpr_write_b32 a44, v124
v_accvgpr_write_b32 a45, v125
v_accvgpr_write_b32 a46, v126
v_accvgpr_write_b32 a47, v127
ds_read_b128 a[156:159], v21 offset:4096
v_mfma_f32_16x16x32_bf16 v[72:75], a[84:87], a[32:35], v[72:75]
s_waitcnt lgkmcnt(8)
v_mfma_f32_16x16x32_bf16 v[52:55], a[88:91], a[36:39], v[52:55]
v_add_u32 v18, 32768, v18
v_add_u32 v19, 32768, v19
v_mfma_f32_16x16x32_bf16 v[56:59], a[88:91], a[40:43], v[56:59]
v_add_u32 v20, 32768, v20
v_add_u32 v21, 32768, v21
v_add_u32 v4, 0, v2
v_lshlrev_b32 v4, 1, v4
v_xor_b32 v4, v3, v4
v_mfma_f32_16x16x32_bf16 v[60:63], a[88:91], a[44:47], v[60:63]
v_lshlrev_b32 v4, 4, v4
v_lshl_add_u32 v30, v2, 10, v4
v_add_u32 v4, 4, v2
v_mfma_f32_16x16x32_bf16 v[64:67], a[92:95], a[36:39], v[64:67]
v_lshlrev_b32 v4, 1, v4
v_xor_b32 v4, v3, v4
v_lshlrev_b32 v4, 4, v4
v_mfma_f32_16x16x32_bf16 v[68:71], a[92:95], a[40:43], v[68:71]
v_lshl_add_u32 v31, v2, 10, v4
v_lshlrev_b32 v32, 4, v1
s_lshl_b32 s63, s41, 17
v_mfma_f32_16x16x32_bf16 v[72:75], a[92:95], a[44:47], v[72:75]
s_lshl_b32 s3, s40, 15
s_add_u32 s63, s63, s3
v_max3_f32 v37, v52, v53, v54
v_max3_f32 v38, v55, v64, v65
v_max3_f32 v37, v37, v66, v67
v_max_f32 v37, v37, v38
v_mov_b32 v38, v37
s_nop 1
v_permlane16_swap_b32 v38, v37
v_max_f32 v37, v37, v38
v_mov_b32 v38, v37
s_nop 1
v_permlane32_swap_b32 v38, v37
v_max_f32 v37, v37, v38
v_mul_f32 v34, s54, v37
v_max3_f32 v37, v56, v57, v58
v_max3_f32 v38, v59, v68, v69
v_max3_f32 v37, v37, v70, v71
v_max_f32 v37, v37, v38
v_mov_b32 v38, v37
s_nop 1
v_permlane16_swap_b32 v38, v37
v_max_f32 v37, v37, v38
v_mov_b32 v38, v37
s_nop 1
v_permlane32_swap_b32 v38, v37
v_max_f32 v37, v37, v38
v_mul_f32 v35, s54, v37
v_max3_f32 v37, v60, v61, v62
v_max3_f32 v38, v63, v72, v73
v_max3_f32 v37, v37, v74, v75
v_max_f32 v37, v37, v38
v_mov_b32 v38, v37
s_nop 1
v_permlane16_swap_b32 v38, v37
v_max_f32 v37, v37, v38
v_mov_b32 v38, v37
s_nop 1
v_permlane32_swap_b32 v38, v37
v_max_f32 v37, v37, v38
v_mul_f32 v36, s54, v37
s_mov_b32 s45, 0
s_mov_b32 s68, 65536
s_mov_b32 s46, 131072
s_mov_b32 s49, 0
v_fma_f32 v52, v52, s54, -v34
v_fma_f32 v53, v53, s54, -v34
v_fma_f32 v54, v54, s54, -v34
v_fma_f32 v55, v55, s54, -v34
v_fma_f32 v64, v64, s54, -v34
v_fma_f32 v65, v65, s54, -v34
v_fma_f32 v66, v66, s54, -v34
v_fma_f32 v67, v67, s54, -v34
s_waitcnt lgkmcnt(6)
v_mfma_f32_16x16x32_bf16 v[76:79], a[128:131], a[0:3], 0
v_fma_f32 v56, v56, s54, -v35
v_fma_f32 v57, v57, s54, -v35
v_fma_f32 v58, v58, s54, -v35
v_mfma_f32_16x16x32_bf16 v[80:83], a[128:131], a[4:7], 0
v_fma_f32 v59, v59, s54, -v35
v_fma_f32 v68, v68, s54, -v35
v_fma_f32 v69, v69, s54, -v35
v_mfma_f32_16x16x32_bf16 v[84:87], a[128:131], a[8:11], 0
v_fma_f32 v70, v70, s54, -v35
v_fma_f32 v71, v71, s54, -v35
v_mfma_f32_16x16x32_bf16 v[88:91], a[132:135], a[0:3], 0
v_fma_f32 v60, v60, s54, -v36
v_fma_f32 v61, v61, s54, -v36
v_fma_f32 v62, v62, s54, -v36
v_mfma_f32_16x16x32_bf16 v[92:95], a[132:135], a[4:7], 0
v_fma_f32 v63, v63, s54, -v36
v_fma_f32 v72, v72, s54, -v36
v_fma_f32 v73, v73, s54, -v36
v_mfma_f32_16x16x32_bf16 v[96:99], a[132:135], a[8:11], 0
v_fma_f32 v74, v74, s54, -v36
v_fma_f32 v75, v75, s54, -v36
s_waitcnt vmcnt(4)
s_barrier
s_waitcnt lgkmcnt(4)
v_mfma_f32_16x16x32_bf16 v[76:79], a[136:139], a[12:15], v[76:79]
v_max3_f32 v37, v52, v53, v54
v_max3_f32 v37, v37, v55, v64
v_max3_f32 v38, v66, v67, v56
ds_read_b64_tr_b16 a[96:97], v22 offset:0
ds_read_b64_tr_b16 a[98:99], v22 offset:4096
v_mfma_f32_16x16x32_bf16 v[80:83], a[136:139], a[16:19], v[80:83]
v_max3_f32 v38, v38, v57, v58
v_max3_f32 v39, v68, v69, v70
v_max3_f32 v39, v39, v71, v60
ds_read_b64_tr_b16 a[100:101], v23 offset:0
s_waitcnt vmcnt(4)
s_add_u32 s74, s45, 131072
s_cmp_ge_u32 s74, 163840
s_cselect_b32 s3, 163840, 0
s_sub_u32 s74, s74, s3
s_add_u32 s75, s45, 32768
s_cmp_ge_u32 s75, 163840
s_cselect_b32 s3, 163840, 0
s_sub_u32 s75, s75, s3
s_add_u32 m0, s75, s48
s_add_u32 m0, m0, 16384
s_nop 0
buffer_load_dwordx4 v14, s[28:31], s73 offen offset:0 nt lds
v_mfma_f32_16x16x32_bf16 v[84:87], a[136:139], a[20:23], v[84:87]
v_max3_f32 v40, v62, v63, v72
v_max3_f32 v40, v40, v73, v74
v_max3_f32 v37, v37, v38, v65
ds_read_b64_tr_b16 a[102:103], v23 offset:4096
ds_read_b64_tr_b16 a[104:105], v24 offset:0
v_mfma_f32_16x16x32_bf16 v[88:91], a[140:143], a[12:15], v[88:91]
v_max3_f32 v39, v39, v40, v59
v_max3_f32 v37, v37, v61, v75
v_max_f32 v37, v37, v39
v_cmp_lt_f32 vcc, 0x41000000, v37
s_cbranch_vccnz L_rare_f0
L_cont_f0:
ds_read_b64_tr_b16 a[106:107], v24 offset:4096
v_mfma_f32_16x16x32_bf16 v[92:95], a[140:143], a[16:19], v[92:95]
v_exp_f32 v52, v52
v_exp_f32 v53, v53
v_mfma_f32_16x16x32_bf16 v[96:99], a[140:143], a[20:23], v[96:99]
v_exp_f32 v54, v54
s_waitcnt vmcnt(4)
buffer_load_dwordx4 v15, s[28:31], s73 offen offset:1024 nt lds
s_waitcnt lgkmcnt(8)
v_mfma_f32_16x16x32_bf16 v[76:79], a[144:147], a[24:27], v[76:79]
ds_read_b64_tr_b16 a[108:109], v25 offset:0
ds_read_b64_tr_b16 a[110:111], v25 offset:4096
v_exp_f32 v55, v55
v_mfma_f32_16x16x32_bf16 v[80:83], a[144:147], a[28:31], v[80:83]
ds_read_b64_tr_b16 a[112:113], v26 offset:0
v_exp_f32 v64, v64
v_exp_f32 v65, v65
v_mfma_f32_16x16x32_bf16 v[84:87], a[144:147], a[32:35], v[84:87]
ds_read_b64_tr_b16 a[114:115], v26 offset:4096
v_exp_f32 v66, v66
v_mfma_f32_16x16x32_bf16 v[88:91], a[148:151], a[24:27], v[88:91]
ds_read_b64_tr_b16 a[116:117], v27 offset:0
v_exp_f32 v67, v67
v_mfma_f32_16x16x32_bf16 v[92:95], a[148:151], a[28:31], v[92:95]
ds_read_b64_tr_b16 a[118:119], v27 offset:4096
v_cvt_pk_bf16_f32 v100, v52, v53
v_cvt_pk_bf16_f32 v101, v54, v55
s_waitcnt vmcnt(4)
buffer_load_dwordx4 v14, s[28:31], s73 offen offset:2048 nt lds
v_mfma_f32_16x16x32_bf16 v[96:99], a[148:151], a[32:35], v[96:99]
v_cvt_pk_bf16_f32 v102, v64, v65
s_waitcnt lgkmcnt(12)
v_mfma_f32_16x16x32_bf16 v[76:79], a[152:155], a[36:39], v[76:79]
s_waitcnt lgkmcnt(8)
v_cvt_pk_bf16_f32 v103, v66, v67
v_mfma_f32_16x16x32_bf16 v[80:83], a[152:155], a[40:43], v[80:83]
ds_read_b64_tr_b16 a[120:121], v28 offset:0
v_exp_f32 v56, v56
v_mfma_f32_16x16x32_bf16 v[84:87], a[152:155], a[44:47], v[84:87]
ds_read_b64_tr_b16 a[122:123], v28 offset:4096
v_exp_f32 v57, v57
v_mfma_f32_16x16x32_bf16 v[88:91], a[156:159], a[36:39], v[88:91]
ds_read_b64_tr_b16 a[124:125], v29 offset:0
v_exp_f32 v58, v58
s_waitcnt vmcnt(4)
buffer_load_dwordx4 v15, s[28:31], s73 offen offset:3072 nt lds
s_add_u32 s73, s73, 8192
v_mfma_f32_16x16x32_bf16 v[92:95], a[156:159], a[40:43], v[92:95]
ds_read_b64_tr_b16 a[126:127], v29 offset:4096
v_exp_f32 v59, v59
v_mfma_f32_16x16x32_bf16 v[96:99], a[156:159], a[44:47], v[96:99]
v_exp_f32 v68, v68
v_mfma_f32_16x16x32_bf16 a[48:51], a[60:63], v[100:103], 0
v_exp_f32 v69, v69
s_waitcnt lgkmcnt(8)
v_mfma_f32_16x16x32_bf16 v[152:155], a[96:99], v[100:103], 0
v_exp_f32 v70, v70
v_mfma_f32_16x16x32_bf16 v[164:167], a[100:103], v[100:103], 0
v_exp_f32 v71, v71
s_waitcnt vmcnt(4)
s_add_u32 m0, s74, s48
s_nop 0
buffer_load_dwordx4 v10, s[24:27], s44 offen offset:0 nt lds
v_mfma_f32_16x16x32_bf16 v[176:179], a[104:107], v[100:103], 0
v_cvt_pk_bf16_f32 v104, v56, v57
v_mfma_f32_16x16x32_bf16 v[188:191], a[108:111], v[100:103], 0
v_cvt_pk_bf16_f32 v105, v58, v59
s_waitcnt lgkmcnt(0)
v_mfma_f32_16x16x32_bf16 v[200:203], a[112:115], v[100:103], 0
v_cvt_pk_bf16_f32 v106, v68, v69
v_mfma_f32_16x16x32_bf16 v[212:215], a[116:119], v[100:103], 0
v_cvt_pk_bf16_f32 v107, v70, v71
v_mfma_f32_16x16x32_bf16 v[224:227], a[120:123], v[100:103], 0
v_exp_f32 v60, v60
v_exp_f32 v61, v61
s_waitcnt vmcnt(4)
buffer_load_dwordx4 v11, s[24:27], s44 offen offset:1024 nt lds
v_mfma_f32_16x16x32_bf16 v[236:239], a[124:127], v[100:103], 0
v_exp_f32 v62, v62
v_mfma_f32_16x16x32_bf16 a[52:55], a[60:63], v[104:107], 0
v_exp_f32 v63, v63
ds_read_b128 a[64:67], v18 offset:0
v_mfma_f32_16x16x32_bf16 v[156:159], a[96:99], v[104:107], 0
v_exp_f32 v72, v72
ds_read_b128 a[68:71], v18 offset:4096
v_mfma_f32_16x16x32_bf16 v[168:171], a[100:103], v[104:107], 0
v_exp_f32 v73, v73
v_mfma_f32_16x16x32_bf16 v[180:183], a[104:107], v[104:107], 0
v_exp_f32 v74, v74
v_exp_f32 v75, v75
ds_read_b128 a[72:75], v19 offset:0
s_waitcnt vmcnt(4)
buffer_load_dwordx4 v12, s[24:27], s44 offen offset:2048 nt lds
v_mfma_f32_16x16x32_bf16 v[192:195], a[108:111], v[104:107], 0
v_cvt_pk_bf16_f32 v108, v60, v61
ds_read_b128 a[76:79], v19 offset:4096
v_mfma_f32_16x16x32_bf16 v[204:207], a[112:115], v[104:107], 0
v_cvt_pk_bf16_f32 v109, v62, v63
v_mfma_f32_16x16x32_bf16 v[216:219], a[116:119], v[104:107], 0
v_cvt_pk_bf16_f32 v110, v72, v73
ds_read_b128 a[80:83], v20 offset:0
v_mfma_f32_16x16x32_bf16 v[228:231], a[120:123], v[104:107], 0
v_cvt_pk_bf16_f32 v111, v74, v75
ds_read_b128 a[84:87], v20 offset:4096
v_mfma_f32_16x16x32_bf16 v[240:243], a[124:127], v[104:107], 0
s_waitcnt vmcnt(4)
buffer_load_dwordx4 v13, s[24:27], s44 offen offset:3072 nt lds
s_add_u32 s44, s44, 8192
v_mfma_f32_16x16x32_bf16 a[56:59], a[60:63], v[108:111], 0
ds_read_b128 a[88:91], v21 offset:0
v_mfma_f32_16x16x32_bf16 v[160:163], a[96:99], v[108:111], 0
ds_read_b128 a[92:95], v21 offset:4096
v_mfma_f32_16x16x32_bf16 v[172:175], a[100:103], v[108:111], 0
v_mfma_f32_16x16x32_bf16 v[184:187], a[104:107], v[108:111], 0
s_mov_b32 s46, s45
s_add_u32 s45, s45, 32768
s_cmp_eq_u32 s45, 163840
s_cselect_b32 s45, 0, s45
s_sub_u32 s57, s45, s46
s_mov_b32 s3, s68
s_add_u32 s68, s68, 32768
s_cmp_eq_u32 s68, 163840
s_cselect_b32 s68, 0, s68
s_sub_u32 s47, s68, s3
v_mfma_f32_16x16x32_bf16 v[196:199], a[108:111], v[108:111], 0
v_add_u32 v18, s47, v18
v_add_u32 v19, s47, v19
v_add_u32 v20, s47, v20
v_mfma_f32_16x16x32_bf16 v[208:211], a[112:115], v[108:111], 0
v_add_u32 v21, s47, v21
v_add_u32 v22, s57, v22
v_mfma_f32_16x16x32_bf16 v[220:223], a[116:119], v[108:111], 0
v_add_u32 v23, s57, v23
v_add_u32 v24, s57, v24
v_add_u32 v25, s57, v25
v_mfma_f32_16x16x32_bf16 v[232:235], a[120:123], v[108:111], 0
v_add_u32 v26, s57, v26
v_add_u32 v27, s57, v27
v_mfma_f32_16x16x32_bf16 v[244:247], a[124:127], v[108:111], 0
v_add_u32 v28, s57, v28
v_add_u32 v29, s57, v29
v_fma_f32 v76, v76, s54, -v34
v_fma_f32 v77, v77, s54, -v34
v_fma_f32 v78, v78, s54, -v34
v_fma_f32 v79, v79, s54, -v34
v_fma_f32 v88, v88, s54, -v34
v_fma_f32 v89, v89, s54, -v34
v_fma_f32 v90, v90, s54, -v34
v_fma_f32 v91, v91, s54, -v34
s_waitcnt lgkmcnt(6)
v_mfma_f32_16x16x32_bf16 v[52:55], a[64:67], a[0:3], 0
v_fma_f32 v80, v80, s54, -v35
v_fma_f32 v81, v81, s54, -v35
v_fma_f32 v82, v82, s54, -v35
v_mfma_f32_16x16x32_bf16 v[56:59], a[64:67], a[4:7], 0
v_fma_f32 v83, v83, s54, -v35
v_fma_f32 v92, v92, s54, -v35
v_fma_f32 v93, v93, s54, -v35
v_mfma_f32_16x16x32_bf16 v[60:63], a[64:67], a[8:11], 0
v_fma_f32 v94, v94, s54, -v35
v_fma_f32 v95, v95, s54, -v35
v_mfma_f32_16x16x32_bf16 v[64:67], a[68:71], a[0:3], 0
v_fma_f32 v84, v84, s54, -v36
v_fma_f32 v85, v85, s54, -v36
v_fma_f32 v86, v86, s54, -v36
v_mfma_f32_16x16x32_bf16 v[68:71], a[68:71], a[4:7], 0
v_fma_f32 v87, v87, s54, -v36
v_fma_f32 v96, v96, s54, -v36
v_fma_f32 v97, v97, s54, -v36
v_mfma_f32_16x16x32_bf16 v[72:75], a[68:71], a[8:11], 0
v_fma_f32 v98, v98, s54, -v36
v_fma_f32 v99, v99, s54, -v36
s_waitcnt vmcnt(4)
s_barrier
s_waitcnt lgkmcnt(4)
v_mfma_f32_16x16x32_bf16 v[52:55], a[72:75], a[12:15], v[52:55]
v_max3_f32 v37, v76, v77, v78
v_max3_f32 v37, v37, v79, v88
v_max3_f32 v38, v90, v91, v80
ds_read_b64_tr_b16 a[96:97], v22 offset:0
ds_read_b64_tr_b16 a[98:99], v22 offset:4096
v_mfma_f32_16x16x32_bf16 v[56:59], a[72:75], a[16:19], v[56:59]
v_max3_f32 v38, v38, v81, v82
v_max3_f32 v39, v92, v93, v94
v_max3_f32 v39, v39, v95, v84
ds_read_b64_tr_b16 a[100:101], v23 offset:0
s_waitcnt vmcnt(4)
s_add_u32 s74, s45, 131072
s_cmp_ge_u32 s74, 163840
s_cselect_b32 s3, 163840, 0
s_sub_u32 s74, s74, s3
s_add_u32 s75, s45, 32768
s_cmp_ge_u32 s75, 163840
s_cselect_b32 s3, 163840, 0
s_sub_u32 s75, s75, s3
s_add_u32 m0, s75, s48
s_add_u32 m0, m0, 16384
s_nop 0
buffer_load_dwordx4 v14, s[28:31], s73 offen offset:0 nt lds
v_mfma_f32_16x16x32_bf16 v[60:63], a[72:75], a[20:23], v[60:63]
v_max3_f32 v40, v86, v87, v96
v_max3_f32 v40, v40, v97, v98
v_max3_f32 v37, v37, v38, v89
ds_read_b64_tr_b16 a[102:103], v23 offset:4096
ds_read_b64_tr_b16 a[104:105], v24 offset:0
v_mfma_f32_16x16x32_bf16 v[64:67], a[76:79], a[12:15], v[64:67]
v_max3_f32 v39, v39, v40, v83
v_max3_f32 v37, v37, v85, v99
v_max_f32 v37, v37, v39
v_cmp_lt_f32 vcc, 0x41000000, v37
s_cbranch_vccnz L_rare_f1
L_cont_f1:
ds_read_b64_tr_b16 a[106:107], v24 offset:4096
v_mfma_f32_16x16x32_bf16 v[68:71], a[76:79], a[16:19], v[68:71]
v_exp_f32 v76, v76
v_exp_f32 v77, v77
v_mfma_f32_16x16x32_bf16 v[72:75], a[76:79], a[20:23], v[72:75]
v_exp_f32 v78, v78
s_waitcnt vmcnt(4)
buffer_load_dwordx4 v15, s[28:31], s73 offen offset:1024 nt lds
s_waitcnt lgkmcnt(8)
v_mfma_f32_16x16x32_bf16 v[52:55], a[80:83], a[24:27], v[52:55]
ds_read_b64_tr_b16 a[108:109], v25 offset:0
ds_read_b64_tr_b16 a[110:111], v25 offset:4096
v_exp_f32 v79, v79
v_mfma_f32_16x16x32_bf16 v[56:59], a[80:83], a[28:31], v[56:59]
ds_read_b64_tr_b16 a[112:113], v26 offset:0
v_exp_f32 v88, v88
v_exp_f32 v89, v89
v_mfma_f32_16x16x32_bf16 v[60:63], a[80:83], a[32:35], v[60:63]
ds_read_b64_tr_b16 a[114:115], v26 offset:4096
v_exp_f32 v90, v90
v_mfma_f32_16x16x32_bf16 v[64:67], a[84:87], a[24:27], v[64:67]
ds_read_b64_tr_b16 a[116:117], v27 offset:0
v_exp_f32 v91, v91
v_mfma_f32_16x16x32_bf16 v[68:71], a[84:87], a[28:31], v[68:71]
ds_read_b64_tr_b16 a[118:119], v27 offset:4096
v_cvt_pk_bf16_f32 v100, v76, v77
v_cvt_pk_bf16_f32 v101, v78, v79
s_waitcnt vmcnt(4)
buffer_load_dwordx4 v14, s[28:31], s73 offen offset:2048 nt lds
v_mfma_f32_16x16x32_bf16 v[72:75], a[84:87], a[32:35], v[72:75]
v_cvt_pk_bf16_f32 v102, v88, v89
s_waitcnt lgkmcnt(12)
v_mfma_f32_16x16x32_bf16 v[52:55], a[88:91], a[36:39], v[52:55]
s_waitcnt lgkmcnt(8)
v_cvt_pk_bf16_f32 v103, v90, v91
v_mfma_f32_16x16x32_bf16 v[56:59], a[88:91], a[40:43], v[56:59]
ds_read_b64_tr_b16 a[120:121], v28 offset:0
v_exp_f32 v80, v80
v_mfma_f32_16x16x32_bf16 v[60:63], a[88:91], a[44:47], v[60:63]
ds_read_b64_tr_b16 a[122:123], v28 offset:4096
v_exp_f32 v81, v81
v_mfma_f32_16x16x32_bf16 v[64:67], a[92:95], a[36:39], v[64:67]
ds_read_b64_tr_b16 a[124:125], v29 offset:0
v_exp_f32 v82, v82
s_waitcnt vmcnt(4)
buffer_load_dwordx4 v15, s[28:31], s73 offen offset:3072 nt lds
s_add_u32 s73, s73, 8192
v_mfma_f32_16x16x32_bf16 v[68:71], a[92:95], a[40:43], v[68:71]
ds_read_b64_tr_b16 a[126:127], v29 offset:4096
v_exp_f32 v83, v83
v_mfma_f32_16x16x32_bf16 v[72:75], a[92:95], a[44:47], v[72:75]
v_exp_f32 v92, v92
v_mfma_f32_16x16x32_bf16 a[48:51], a[60:63], v[100:103], a[48:51]
v_exp_f32 v93, v93
s_waitcnt lgkmcnt(8)
v_mfma_f32_16x16x32_bf16 v[152:155], a[96:99], v[100:103], v[152:155]
v_exp_f32 v94, v94
v_mfma_f32_16x16x32_bf16 v[164:167], a[100:103], v[100:103], v[164:167]
v_exp_f32 v95, v95
s_waitcnt vmcnt(4)
s_add_u32 m0, s74, s48
s_nop 0
buffer_load_dwordx4 v10, s[24:27], s44 offen offset:0 nt lds
v_mfma_f32_16x16x32_bf16 v[176:179], a[104:107], v[100:103], v[176:179]
v_cvt_pk_bf16_f32 v104, v80, v81
v_mfma_f32_16x16x32_bf16 v[188:191], a[108:111], v[100:103], v[188:191]
v_cvt_pk_bf16_f32 v105, v82, v83
s_waitcnt lgkmcnt(0)
v_mfma_f32_16x16x32_bf16 v[200:203], a[112:115], v[100:103], v[200:203]
v_cvt_pk_bf16_f32 v106, v92, v93
v_mfma_f32_16x16x32_bf16 v[212:215], a[116:119], v[100:103], v[212:215]
v_cvt_pk_bf16_f32 v107, v94, v95
v_mfma_f32_16x16x32_bf16 v[224:227], a[120:123], v[100:103], v[224:227]
v_exp_f32 v84, v84
v_exp_f32 v85, v85
s_waitcnt vmcnt(4)
buffer_load_dwordx4 v11, s[24:27], s44 offen offset:1024 nt lds
v_mfma_f32_16x16x32_bf16 v[236:239], a[124:127], v[100:103], v[236:239]
v_exp_f32 v86, v86
v_mfma_f32_16x16x32_bf16 a[52:55], a[60:63], v[104:107], a[52:55]
v_exp_f32 v87, v87
ds_read_b128 a[128:131], v18 offset:0
v_mfma_f32_16x16x32_bf16 v[156:159], a[96:99], v[104:107], v[156:159]
v_exp_f32 v96, v96
ds_read_b128 a[132:135], v18 offset:4096
v_mfma_f32_16x16x32_bf16 v[168:171], a[100:103], v[104:107], v[168:171]
v_exp_f32 v97, v97
v_mfma_f32_16x16x32_bf16 v[180:183], a[104:107], v[104:107], v[180:183]
v_exp_f32 v98, v98
v_exp_f32 v99, v99
ds_read_b128 a[136:139], v19 offset:0
s_waitcnt vmcnt(4)
buffer_load_dwordx4 v12, s[24:27], s44 offen offset:2048 nt lds
v_mfma_f32_16x16x32_bf16 v[192:195], a[108:111], v[104:107], v[192:195]
v_cvt_pk_bf16_f32 v108, v84, v85
ds_read_b128 a[140:143], v19 offset:4096
v_mfma_f32_16x16x32_bf16 v[204:207], a[112:115], v[104:107], v[204:207]
v_cvt_pk_bf16_f32 v109, v86, v87
v_mfma_f32_16x16x32_bf16 v[216:219], a[116:119], v[104:107], v[216:219]
v_cvt_pk_bf16_f32 v110, v96, v97
ds_read_b128 a[144:147], v20 offset:0
v_mfma_f32_16x16x32_bf16 v[228:231], a[120:123], v[104:107], v[228:231]
v_cvt_pk_bf16_f32 v111, v98, v99
ds_read_b128 a[148:151], v20 offset:4096
v_mfma_f32_16x16x32_bf16 v[240:243], a[124:127], v[104:107], v[240:243]
s_waitcnt vmcnt(4)
buffer_load_dwordx4 v13, s[24:27], s44 offen offset:3072 nt lds
s_add_u32 s44, s44, 8192
v_mfma_f32_16x16x32_bf16 a[56:59], a[60:63], v[108:111], a[56:59]
ds_read_b128 a[152:155], v21 offset:0
v_mfma_f32_16x16x32_bf16 v[160:163], a[96:99], v[108:111], v[160:163]
ds_read_b128 a[156:159], v21 offset:4096
v_mfma_f32_16x16x32_bf16 v[172:175], a[100:103], v[108:111], v[172:175]
v_mfma_f32_16x16x32_bf16 v[184:187], a[104:107], v[108:111], v[184:187]
s_mov_b32 s46, s45
s_add_u32 s45, s45, 32768
s_cmp_eq_u32 s45, 163840
s_cselect_b32 s45, 0, s45
s_sub_u32 s57, s45, s46
s_mov_b32 s3, s68
s_add_u32 s68, s68, 32768
s_cmp_eq_u32 s68, 163840
s_cselect_b32 s68, 0, s68
s_sub_u32 s47, s68, s3
v_mfma_f32_16x16x32_bf16 v[196:199], a[108:111], v[108:111], v[196:199]
v_add_u32 v18, s47, v18
v_add_u32 v19, s47, v19
v_add_u32 v20, s47, v20
v_mfma_f32_16x16x32_bf16 v[208:211], a[112:115], v[108:111], v[208:211]
v_add_u32 v21, s47, v21
v_add_u32 v22, s57, v22
v_mfma_f32_16x16x32_bf16 v[220:223], a[116:119], v[108:111], v[220:223]
v_add_u32 v23, s57, v23
v_add_u32 v24, s57, v24
v_add_u32 v25, s57, v25
v_mfma_f32_16x16x32_bf16 v[232:235], a[120:123], v[108:111], v[232:235]
v_add_u32 v26, s57, v26
v_add_u32 v27, s57, v27
v_mfma_f32_16x16x32_bf16 v[244:247], a[124:127], v[108:111], v[244:247]
v_add_u32 v28, s57, v28
v_add_u32 v29, s57, v29
s_mov_b32 s49, 2
L_loop:
v_fma_f32 v52, v52, s54, -v34
v_fma_f32 v53, v53, s54, -v34
v_fma_f32 v54, v54, s54, -v34
v_fma_f32 v55, v55, s54, -v34
v_fma_f32 v64, v64, s54, -v34
v_fma_f32 v65, v65, s54, -v34
v_fma_f32 v66, v66, s54, -v34
v_fma_f32 v67, v67, s54, -v34
s_waitcnt lgkmcnt(6)
v_mfma_f32_16x16x32_bf16 v[76:79], a[128:131], a[0:3], 0
v_fma_f32 v56, v56, s54, -v35
v_fma_f32 v57, v57, s54, -v35
v_fma_f32 v58, v58, s54, -v35
v_mfma_f32_16x16x32_bf16 v[80:83], a[128:131], a[4:7], 0
v_fma_f32 v59, v59, s54, -v35
v_fma_f32 v68, v68, s54, -v35
v_fma_f32 v69, v69, s54, -v35
v_mfma_f32_16x16x32_bf16 v[84:87], a[128:131], a[8:11], 0
v_fma_f32 v70, v70, s54, -v35
v_fma_f32 v71, v71, s54, -v35
v_mfma_f32_16x16x32_bf16 v[88:91], a[132:135], a[0:3], 0
v_fma_f32 v60, v60, s54, -v36
v_fma_f32 v61, v61, s54, -v36
v_fma_f32 v62, v62, s54, -v36
v_mfma_f32_16x16x32_bf16 v[92:95], a[132:135], a[4:7], 0
v_fma_f32 v63, v63, s54, -v36
v_fma_f32 v72, v72, s54, -v36
v_fma_f32 v73, v73, s54, -v36
v_mfma_f32_16x16x32_bf16 v[96:99], a[132:135], a[8:11], 0
v_fma_f32 v74, v74, s54, -v36
v_fma_f32 v75, v75, s54, -v36
s_waitcnt vmcnt(4)
s_barrier
s_waitcnt lgkmcnt(4)
v_mfma_f32_16x16x32_bf16 v[76:79], a[136:139], a[12:15], v[76:79]
v_max3_f32 v37, v52, v53, v54
v_max3_f32 v37, v37, v55, v64
v_max3_f32 v38, v66, v67, v56
ds_read_b64_tr_b16 a[96:97], v22 offset:0
ds_read_b64_tr_b16 a[98:99], v22 offset:4096
v_mfma_f32_16x16x32_bf16 v[80:83], a[136:139], a[16:19], v[80:83]
v_max3_f32 v38, v38, v57, v58
v_max3_f32 v39, v68, v69, v70
v_max3_f32 v39, v39, v71, v60
ds_read_b64_tr_b16 a[100:101], v23 offset:0
s_waitcnt vmcnt(4)
s_add_u32 s74, s45, 131072
s_cmp_ge_u32 s74, 163840
s_cselect_b32 s3, 163840, 0
s_sub_u32 s74, s74, s3
s_add_u32 s75, s45, 32768
s_cmp_ge_u32 s75, 163840
s_cselect_b32 s3, 163840, 0
s_sub_u32 s75, s75, s3
s_add_u32 m0, s75, s48
s_add_u32 m0, m0, 16384
s_nop 0
buffer_load_dwordx4 v14, s[28:31], s73 offen offset:0 nt lds
v_mfma_f32_16x16x32_bf16 v[84:87], a[136:139], a[20:23], v[84:87]
v_max3_f32 v40, v62, v63, v72
v_max3_f32 v40, v40, v73, v74
v_max3_f32 v37, v37, v38, v65
ds_read_b64_tr_b16 a[102:103], v23 offset:4096
ds_read_b64_tr_b16 a[104:105], v24 offset:0
v_mfma_f32_16x16x32_bf16 v[88:91], a[140:143], a[12:15], v[88:91]
v_max3_f32 v39, v39, v40, v59
v_max3_f32 v37, v37, v61, v75
v_max_f32 v37, v37, v39
v_cmp_lt_f32 vcc, 0x41000000, v37
s_cbranch_vccnz L_rare_m0
L_cont_m0:
ds_read_b64_tr_b16 a[106:107], v24 offset:4096
v_mfma_f32_16x16x32_bf16 v[92:95], a[140:143], a[16:19], v[92:95]
v_exp_f32 v52, v52
v_exp_f32 v53, v53
v_mfma_f32_16x16x32_bf16 v[96:99], a[140:143], a[20:23], v[96:99]
v_exp_f32 v54, v54
s_waitcnt vmcnt(4)
buffer_load_dwordx4 v15, s[28:31], s73 offen offset:1024 nt lds
s_waitcnt lgkmcnt(8)
v_mfma_f32_16x16x32_bf16 v[76:79], a[144:147], a[24:27], v[76:79]
ds_read_b64_tr_b16 a[108:109], v25 offset:0
ds_read_b64_tr_b16 a[110:111], v25 offset:4096
v_exp_f32 v55, v55
v_mfma_f32_16x16x32_bf16 v[80:83], a[144:147], a[28:31], v[80:83]
ds_read_b64_tr_b16 a[112:113], v26 offset:0
v_exp_f32 v64, v64
v_exp_f32 v65, v65
v_mfma_f32_16x16x32_bf16 v[84:87], a[144:147], a[32:35], v[84:87]
ds_read_b64_tr_b16 a[114:115], v26 offset:4096
v_exp_f32 v66, v66
v_mfma_f32_16x16x32_bf16 v[88:91], a[148:151], a[24:27], v[88:91]
ds_read_b64_tr_b16 a[116:117], v27 offset:0
v_exp_f32 v67, v67
v_mfma_f32_16x16x32_bf16 v[92:95], a[148:151], a[28:31], v[92:95]
ds_read_b64_tr_b16 a[118:119], v27 offset:4096
v_cvt_pk_bf16_f32 v100, v52, v53
v_cvt_pk_bf16_f32 v101, v54, v55
s_waitcnt vmcnt(4)
buffer_load_dwordx4 v14, s[28:31], s73 offen offset:2048 nt lds
v_mfma_f32_16x16x32_bf16 v[96:99], a[148:151], a[32:35], v[96:99]
v_cvt_pk_bf16_f32 v102, v64, v65
s_waitcnt lgkmcnt(12)
v_mfma_f32_16x16x32_bf16 v[76:79], a[152:155], a[36:39], v[76:79]
s_waitcnt lgkmcnt(8)
v_cvt_pk_bf16_f32 v103, v66, v67
v_mfma_f32_16x16x32_bf16 v[80:83], a[152:155], a[40:43], v[80:83]
ds_read_b64_tr_b16 a[120:121], v28 offset:0
v_exp_f32 v56, v56
v_mfma_f32_16x16x32_bf16 v[84:87], a[152:155], a[44:47], v[84:87]
ds_read_b64_tr_b16 a[122:123], v28 offset:4096
v_exp_f32 v57, v57
v_mfma_f32_16x16x32_bf16 v[88:91], a[156:159], a[36:39], v[88:91]
ds_read_b64_tr_b16 a[124:125], v29 offset:0
v_exp_f32 v58, v58
s_waitcnt vmcnt(4)
buffer_load_dwordx4 v15, s[28:31], s73 offen offset:3072 nt lds
s_add_u32 s73, s73, 8192
v_mfma_f32_16x16x32_bf16 v[92:95], a[156:159], a[40:43], v[92:95]
ds_read_b64_tr_b16 a[126:127], v29 offset:4096
v_exp_f32 v59, v59
v_mfma_f32_16x16x32_bf16 v[96:99], a[156:159], a[44:47], v[96:99]
v_exp_f32 v68, v68
v_mfma_f32_16x16x32_bf16 a[48:51], a[60:63], v[100:103], a[48:51]
v_exp_f32 v69, v69
s_waitcnt lgkmcnt(8)
v_mfma_f32_16x16x32_bf16 v[152:155], a[96:99], v[100:103], v[152:155]
v_exp_f32 v70, v70
v_mfma_f32_16x16x32_bf16 v[164:167], a[100:103], v[100:103], v[164:167]
v_exp_f32 v71, v71
s_waitcnt vmcnt(4)
s_add_u32 m0, s74, s48
s_nop 0
buffer_load_dwordx4 v10, s[24:27], s44 offen offset:0 nt lds
v_mfma_f32_16x16x32_bf16 v[176:179], a[104:107], v[100:103], v[176:179]
v_cvt_pk_bf16_f32 v104, v56, v57
v_mfma_f32_16x16x32_bf16 v[188:191], a[108:111], v[100:103], v[188:191]
v_cvt_pk_bf16_f32 v105, v58, v59
s_waitcnt lgkmcnt(0)
v_mfma_f32_16x16x32_bf16 v[200:203], a[112:115], v[100:103], v[200:203]
v_cvt_pk_bf16_f32 v106, v68, v69
v_mfma_f32_16x16x32_bf16 v[212:215], a[116:119], v[100:103], v[212:215]
v_cvt_pk_bf16_f32 v107, v70, v71
v_mfma_f32_16x16x32_bf16 v[224:227], a[120:123], v[100:103], v[224:227]
v_exp_f32 v60, v60
v_exp_f32 v61, v61
s_waitcnt vmcnt(4)
buffer_load_dwordx4 v11, s[24:27], s44 offen offset:1024 nt lds
v_mfma_f32_16x16x32_bf16 v[236:239], a[124:127], v[100:103], v[236:239]
v_exp_f32 v62, v62
v_mfma_f32_16x16x32_bf16 a[52:55], a[60:63], v[104:107], a[52:55]
v_exp_f32 v63, v63
ds_read_b128 a[64:67], v18 offset:0
v_mfma_f32_16x16x32_bf16 v[156:159], a[96:99], v[104:107], v[156:159]
v_exp_f32 v72, v72
ds_read_b128 a[68:71], v18 offset:4096
v_mfma_f32_16x16x32_bf16 v[168:171], a[100:103], v[104:107], v[168:171]
v_exp_f32 v73, v73
v_mfma_f32_16x16x32_bf16 v[180:183], a[104:107], v[104:107], v[180:183]
v_exp_f32 v74, v74
v_exp_f32 v75, v75
ds_read_b128 a[72:75], v19 offset:0
s_waitcnt vmcnt(4)
buffer_load_dwordx4 v12, s[24:27], s44 offen offset:2048 nt lds
v_mfma_f32_16x16x32_bf16 v[192:195], a[108:111], v[104:107], v[192:195]
v_cvt_pk_bf16_f32 v108, v60, v61
ds_read_b128 a[76:79], v19 offset:4096
v_mfma_f32_16x16x32_bf16 v[204:207], a[112:115], v[104:107], v[204:207]
v_cvt_pk_bf16_f32 v109, v62, v63
v_mfma_f32_16x16x32_bf16 v[216:219], a[116:119], v[104:107], v[216:219]
v_cvt_pk_bf16_f32 v110, v72, v73
ds_read_b128 a[80:83], v20 offset:0
v_mfma_f32_16x16x32_bf16 v[228:231], a[120:123], v[104:107], v[228:231]
v_cvt_pk_bf16_f32 v111, v74, v75
ds_read_b128 a[84:87], v20 offset:4096
v_mfma_f32_16x16x32_bf16 v[240:243], a[124:127], v[104:107], v[240:243]
s_waitcnt vmcnt(4)
buffer_load_dwordx4 v13, s[24:27], s44 offen offset:3072 nt lds
s_add_u32 s44, s44, 8192
v_mfma_f32_16x16x32_bf16 a[56:59], a[60:63], v[108:111], a[56:59]
ds_read_b128 a[88:91], v21 offset:0
v_mfma_f32_16x16x32_bf16 v[160:163], a[96:99], v[108:111], v[160:163]
ds_read_b128 a[92:95], v21 offset:4096
v_mfma_f32_16x16x32_bf16 v[172:175], a[100:103], v[108:111], v[172:175]
v_mfma_f32_16x16x32_bf16 v[184:187], a[104:107], v[108:111], v[184:187]
s_mov_b32 s46, s45
s_add_u32 s45, s45, 32768
s_cmp_eq_u32 s45, 163840
s_cselect_b32 s45, 0, s45
s_sub_u32 s57, s45, s46
s_mov_b32 s3, s68
s_add_u32 s68, s68, 32768
s_cmp_eq_u32 s68, 163840
s_cselect_b32 s68, 0, s68
s_sub_u32 s47, s68, s3
v_mfma_f32_16x16x32_bf16 v[196:199], a[108:111], v[108:111], v[196:199]
v_add_u32 v18, s47, v18
v_add_u32 v19, s47, v19
v_add_u32 v20, s47, v20
v_mfma_f32_16x16x32_bf16 v[208:211], a[112:115], v[108:111], v[208:211]
v_add_u32 v21, s47, v21
v_add_u32 v22, s57, v22
v_mfma_f32_16x16x32_bf16 v[220:223], a[116:119], v[108:111], v[220:223]
v_add_u32 v23, s57, v23
v_add_u32 v24, s57, v24
v_add_u32 v25, s57, v25
v_mfma_f32_16x16x32_bf16 v[232:235], a[120:123], v[108:111], v[232:235]
v_add_u32 v26, s57, v26
v_add_u32 v27, s57, v27
v_mfma_f32_16x16x32_bf16 v[244:247], a[124:127], v[108:111], v[244:247]
v_add_u32 v28, s57, v28
v_add_u32 v29, s57, v29
v_fma_f32 v76, v76, s54, -v34
v_fma_f32 v77, v77, s54, -v34
v_fma_f32 v78, v78, s54, -v34
v_fma_f32 v79, v79, s54, -v34
v_fma_f32 v88, v88, s54, -v34
v_fma_f32 v89, v89, s54, -v34
v_fma_f32 v90, v90, s54, -v34
v_fma_f32 v91, v91, s54, -v34
s_waitcnt lgkmcnt(6)
v_mfma_f32_16x16x32_bf16 v[52:55], a[64:67], a[0:3], 0
v_fma_f32 v80, v80, s54, -v35
v_fma_f32 v81, v81, s54, -v35
v_fma_f32 v82, v82, s54, -v35
v_mfma_f32_16x16x32_bf16 v[56:59], a[64:67], a[4:7], 0
v_fma_f32 v83, v83, s54, -v35
v_fma_f32 v92, v92, s54, -v35
v_fma_f32 v93, v93, s54, -v35
v_mfma_f32_16x16x32_bf16 v[60:63], a[64:67], a[8:11], 0
v_fma_f32 v94, v94, s54, -v35
v_fma_f32 v95, v95, s54, -v35
v_mfma_f32_16x16x32_bf16 v[64:67], a[68:71], a[0:3], 0
v_fma_f32 v84, v84, s54, -v36
v_fma_f32 v85, v85, s54, -v36
v_fma_f32 v86, v86, s54, -v36
v_mfma_f32_16x16x32_bf16 v[68:71], a[68:71], a[4:7], 0
v_fma_f32 v87, v87, s54, -v36
v_fma_f32 v96, v96, s54, -v36
v_fma_f32 v97, v97, s54, -v36
v_mfma_f32_16x16x32_bf16 v[72:75], a[68:71], a[8:11], 0
v_fma_f32 v98, v98, s54, -v36
v_fma_f32 v99, v99, s54, -v36
s_waitcnt vmcnt(4)
s_barrier
s_waitcnt lgkmcnt(4)
v_mfma_f32_16x16x32_bf16 v[52:55], a[72:75], a[12:15], v[52:55]
v_max3_f32 v37, v76, v77, v78
v_max3_f32 v37, v37, v79, v88
v_max3_f32 v38, v90, v91, v80
ds_read_b64_tr_b16 a[96:97], v22 offset:0
ds_read_b64_tr_b16 a[98:99], v22 offset:4096
v_mfma_f32_16x16x32_bf16 v[56:59], a[72:75], a[16:19], v[56:59]
v_max3_f32 v38, v38, v81, v82
v_max3_f32 v39, v92, v93, v94
v_max3_f32 v39, v39, v95, v84
ds_read_b64_tr_b16 a[100:101], v23 offset:0
s_waitcnt vmcnt(4)
s_add_u32 s74, s45, 131072
s_cmp_ge_u32 s74, 163840
s_cselect_b32 s3, 163840, 0
s_sub_u32 s74, s74, s3
s_add_u32 s75, s45, 32768
s_cmp_ge_u32 s75, 163840
s_cselect_b32 s3, 163840, 0
s_sub_u32 s75, s75, s3
s_add_u32 m0, s75, s48
s_add_u32 m0, m0, 16384
s_nop 0
buffer_load_dwordx4 v14, s[28:31], s73 offen offset:0 nt lds
v_mfma_f32_16x16x32_bf16 v[60:63], a[72:75], a[20:23], v[60:63]
v_max3_f32 v40, v86, v87, v96
v_max3_f32 v40, v40, v97, v98
v_max3_f32 v37, v37, v38, v89
ds_read_b64_tr_b16 a[102:103], v23 offset:4096
ds_read_b64_tr_b16 a[104:105], v24 offset:0
v_mfma_f32_16x16x32_bf16 v[64:67], a[76:79], a[12:15], v[64:67]
v_max3_f32 v39, v39, v40, v83
v_max3_f32 v37, v37, v85, v99
v_max_f32 v37, v37, v39
v_cmp_lt_f32 vcc, 0x41000000, v37
s_cbranch_vccnz L_rare_m1
L_cont_m1:
ds_read_b64_tr_b16 a[106:107], v24 offset:4096
v_mfma_f32_16x16x32_bf16 v[68:71], a[76:79], a[16:19], v[68:71]
v_exp_f32 v76, v76
v_exp_f32 v77, v77
v_mfma_f32_16x16x32_bf16 v[72:75], a[76:79], a[20:23], v[72:75]
v_exp_f32 v78, v78
s_waitcnt vmcnt(4)
buffer_load_dwordx4 v15, s[28:31], s73 offen offset:1024 nt lds
s_waitcnt lgkmcnt(8)
v_mfma_f32_16x16x32_bf16 v[52:55], a[80:83], a[24:27], v[52:55]
ds_read_b64_tr_b16 a[108:109], v25 offset:0
ds_read_b64_tr_b16 a[110:111], v25 offset:4096
v_exp_f32 v79, v79
v_mfma_f32_16x16x32_bf16 v[56:59], a[80:83], a[28:31], v[56:59]
ds_read_b64_tr_b16 a[112:113], v26 offset:0
v_exp_f32 v88, v88
v_exp_f32 v89, v89
v_mfma_f32_16x16x32_bf16 v[60:63], a[80:83], a[32:35], v[60:63]
ds_read_b64_tr_b16 a[114:115], v26 offset:4096
v_exp_f32 v90, v90
v_mfma_f32_16x16x32_bf16 v[64:67], a[84:87], a[24:27], v[64:67]
ds_read_b64_tr_b16 a[116:117], v27 offset:0
v_exp_f32 v91, v91
v_mfma_f32_16x16x32_bf16 v[68:71], a[84:87], a[28:31], v[68:71]
ds_read_b64_tr_b16 a[118:119], v27 offset:4096
v_cvt_pk_bf16_f32 v100, v76, v77
v_cvt_pk_bf16_f32 v101, v78, v79
s_waitcnt vmcnt(4)
buffer_load_dwordx4 v14, s[28:31], s73 offen offset:2048 nt lds
v_mfma_f32_16x16x32_bf16 v[72:75], a[84:87], a[32:35], v[72:75]
v_cvt_pk_bf16_f32 v102, v88, v89
s_waitcnt lgkmcnt(12)
v_mfma_f32_16x16x32_bf16 v[52:55], a[88:91], a[36:39], v[52:55]
s_waitcnt lgkmcnt(8)
v_cvt_pk_bf16_f32 v103, v90, v91
v_mfma_f32_16x16x32_bf16 v[56:59], a[88:91], a[40:43], v[56:59]
ds_read_b64_tr_b16 a[120:121], v28 offset:0
v_exp_f32 v80, v80
v_mfma_f32_16x16x32_bf16 v[60:63], a[88:91], a[44:47], v[60:63]
ds_read_b64_tr_b16 a[122:123], v28 offset:4096
v_exp_f32 v81, v81
v_mfma_f32_16x16x32_bf16 v[64:67], a[92:95], a[36:39], v[64:67]
ds_read_b64_tr_b16 a[124:125], v29 offset:0
v_exp_f32 v82, v82
s_waitcnt vmcnt(4)
buffer_load_dwordx4 v15, s[28:31], s73 offen offset:3072 nt lds
s_add_u32 s73, s73, 8192
v_mfma_f32_16x16x32_bf16 v[68:71], a[92:95], a[40:43], v[68:71]
ds_read_b64_tr_b16 a[126:127], v29 offset:4096
v_exp_f32 v83, v83
v_mfma_f32_16x16x32_bf16 v[72:75], a[92:95], a[44:47], v[72:75]
v_exp_f32 v92, v92
v_mfma_f32_16x16x32_bf16 a[48:51], a[60:63], v[100:103], a[48:51]
v_exp_f32 v93, v93
s_waitcnt lgkmcnt(8)
v_mfma_f32_16x16x32_bf16 v[152:155], a[96:99], v[100:103], v[152:155]
v_exp_f32 v94, v94
v_mfma_f32_16x16x32_bf16 v[164:167], a[100:103], v[100:103], v[164:167]
v_exp_f32 v95, v95
s_waitcnt vmcnt(4)
s_add_u32 m0, s74, s48
s_nop 0
buffer_load_dwordx4 v10, s[24:27], s44 offen offset:0 nt lds
v_mfma_f32_16x16x32_bf16 v[176:179], a[104:107], v[100:103], v[176:179]
v_cvt_pk_bf16_f32 v104, v80, v81
v_mfma_f32_16x16x32_bf16 v[188:191], a[108:111], v[100:103], v[188:191]
v_cvt_pk_bf16_f32 v105, v82, v83
s_waitcnt lgkmcnt(0)
v_mfma_f32_16x16x32_bf16 v[200:203], a[112:115], v[100:103], v[200:203]
v_cvt_pk_bf16_f32 v106, v92, v93
v_mfma_f32_16x16x32_bf16 v[212:215], a[116:119], v[100:103], v[212:215]
v_cvt_pk_bf16_f32 v107, v94, v95
v_mfma_f32_16x16x32_bf16 v[224:227], a[120:123], v[100:103], v[224:227]
v_exp_f32 v84, v84
v_exp_f32 v85, v85
s_waitcnt vmcnt(4)
buffer_load_dwordx4 v11, s[24:27], s44 offen offset:1024 nt lds
v_mfma_f32_16x16x32_bf16 v[236:239], a[124:127], v[100:103], v[236:239]
v_exp_f32 v86, v86
v_mfma_f32_16x16x32_bf16 a[52:55], a[60:63], v[104:107], a[52:55]
v_exp_f32 v87, v87
ds_read_b128 a[128:131], v18 offset:0
v_mfma_f32_16x16x32_bf16 v[156:159], a[96:99], v[104:107], v[156:159]
v_exp_f32 v96, v96
ds_read_b128 a[132:135], v18 offset:4096
v_mfma_f32_16x16x32_bf16 v[168:171], a[100:103], v[104:107], v[168:171]
v_exp_f32 v97, v97
v_mfma_f32_16x16x32_bf16 v[180:183], a[104:107], v[104:107], v[180:183]
v_exp_f32 v98, v98
v_exp_f32 v99, v99
ds_read_b128 a[136:139], v19 offset:0
s_waitcnt vmcnt(4)
buffer_load_dwordx4 v12, s[24:27], s44 offen offset:2048 nt lds
v_mfma_f32_16x16x32_bf16 v[192:195], a[108:111], v[104:107], v[192:195]
v_cvt_pk_bf16_f32 v108, v84, v85
ds_read_b128 a[140:143], v19 offset:4096
v_mfma_f32_16x16x32_bf16 v[204:207], a[112:115], v[104:107], v[204:207]
v_cvt_pk_bf16_f32 v109, v86, v87
v_mfma_f32_16x16x32_bf16 v[216:219], a[116:119], v[104:107], v[216:219]
v_cvt_pk_bf16_f32 v110, v96, v97
ds_read_b128 a[144:147], v20 offset:0
v_mfma_f32_16x16x32_bf16 v[228:231], a[120:123], v[104:107], v[228:231]
v_cvt_pk_bf16_f32 v111, v98, v99
ds_read_b128 a[148:151], v20 offset:4096
v_mfma_f32_16x16x32_bf16 v[240:243], a[124:127], v[104:107], v[240:243]
s_waitcnt vmcnt(4)
buffer_load_dwordx4 v13, s[24:27], s44 offen offset:3072 nt lds
s_add_u32 s44, s44, 8192
v_mfma_f32_16x16x32_bf16 a[56:59], a[60:63], v[108:111], a[56:59]
ds_read_b128 a[152:155], v21 offset:0
v_mfma_f32_16x16x32_bf16 v[160:163], a[96:99], v[108:111], v[160:163]
ds_read_b128 a[156:159], v21 offset:4096
v_mfma_f32_16x16x32_bf16 v[172:175], a[100:103], v[108:111], v[172:175]
v_mfma_f32_16x16x32_bf16 v[184:187], a[104:107], v[108:111], v[184:187]
s_mov_b32 s46, s45
s_add_u32 s45, s45, 32768
s_cmp_eq_u32 s45, 163840
s_cselect_b32 s45, 0, s45
s_sub_u32 s57, s45, s46
s_mov_b32 s3, s68
s_add_u32 s68, s68, 32768
s_cmp_eq_u32 s68, 163840
s_cselect_b32 s68, 0, s68
s_sub_u32 s47, s68, s3
v_mfma_f32_16x16x32_bf16 v[196:199], a[108:111], v[108:111], v[196:199]
v_add_u32 v18, s47, v18
v_add_u32 v19, s47, v19
v_add_u32 v20, s47, v20
v_mfma_f32_16x16x32_bf16 v[208:211], a[112:115], v[108:111], v[208:211]
v_add_u32 v21, s47, v21
v_add_u32 v22, s57, v22
v_mfma_f32_16x16x32_bf16 v[220:223], a[116:119], v[108:111], v[220:223]
v_add_u32 v23, s57, v23
v_add_u32 v24, s57, v24
v_add_u32 v25, s57, v25
v_mfma_f32_16x16x32_bf16 v[232:235], a[120:123], v[108:111], v[232:235]
v_add_u32 v26, s57, v26
v_add_u32 v27, s57, v27
v_mfma_f32_16x16x32_bf16 v[244:247], a[124:127], v[108:111], v[244:247]
v_add_u32 v28, s57, v28
v_add_u32 v29, s57, v29
s_add_u32 s49, s49, 2
s_cmp_lt_u32 s49, 28
s_cbranch_scc1 L_loop
s_and_b32 s64, s58, 3
s_and_b32 s71, s42, 7
s_cmp_ge_u32 s71, 6
s_cselect_b32 s3, 6, 0
s_sub_u32 s71, s71, s3
s_cmp_ge_u32 s71, 3
s_cselect_b32 s3, 3, 0
s_sub_u32 s71, s71, s3
v_fma_f32 v52, v52, s54, -v34
v_fma_f32 v53, v53, s54, -v34
v_fma_f32 v54, v54, s54, -v34
v_fma_f32 v55, v55, s54, -v34
v_fma_f32 v64, v64, s54, -v34
v_fma_f32 v65, v65, s54, -v34
v_fma_f32 v66, v66, s54, -v34
v_fma_f32 v67, v67, s54, -v34
s_waitcnt lgkmcnt(6)
v_mfma_f32_16x16x32_bf16 v[76:79], a[128:131], a[0:3], 0
v_fma_f32 v56, v56, s54, -v35
v_fma_f32 v57, v57, s54, -v35
v_fma_f32 v58, v58, s54, -v35
v_mfma_f32_16x16x32_bf16 v[80:83], a[128:131], a[4:7], 0
v_fma_f32 v59, v59, s54, -v35
v_fma_f32 v68, v68, s54, -v35
v_fma_f32 v69, v69, s54, -v35
v_mfma_f32_16x16x32_bf16 v[84:87], a[128:131], a[8:11], 0
v_fma_f32 v70, v70, s54, -v35
v_fma_f32 v71, v71, s54, -v35
v_mfma_f32_16x16x32_bf16 v[88:91], a[132:135], a[0:3], 0
v_fma_f32 v60, v60, s54, -v36
v_fma_f32 v61, v61, s54, -v36
v_fma_f32 v62, v62, s54, -v36
v_mfma_f32_16x16x32_bf16 v[92:95], a[132:135], a[4:7], 0
v_fma_f32 v63, v63, s54, -v36
v_fma_f32 v72, v72, s54, -v36
v_fma_f32 v73, v73, s54, -v36
v_mfma_f32_16x16x32_bf16 v[96:99], a[132:135], a[8:11], 0
v_fma_f32 v74, v74, s54, -v36
v_fma_f32 v75, v75, s54, -v36
s_waitcnt vmcnt(4)
s_barrier
s_waitcnt lgkmcnt(4)
v_mfma_f32_16x16x32_bf16 v[76:79], a[136:139], a[12:15], v[76:79]
v_max3_f32 v37, v52, v53, v54
v_max3_f32 v37, v37, v55, v64
v_max3_f32 v38, v66, v67, v56
ds_read_b64_tr_b16 a[96:97], v22 offset:0
ds_read_b64_tr_b16 a[98:99], v22 offset:4096
v_mfma_f32_16x16x32_bf16 v[80:83], a[136:139], a[16:19], v[80:83]
v_max3_f32 v38, v38, v57, v58
v_max3_f32 v39, v68, v69, v70
v_max3_f32 v39, v39, v71, v60
ds_read_b64_tr_b16 a[100:101], v23 offset:0
s_add_u32 s74, s45, 131072
s_cmp_ge_u32 s74, 163840
s_cselect_b32 s3, 163840, 0
s_sub_u32 s74, s74, s3
s_add_u32 s75, s45, 32768
s_cmp_ge_u32 s75, 163840
s_cselect_b32 s3, 163840, 0
s_sub_u32 s75, s75, s3
s_add_u32 m0, s75, s48
s_add_u32 m0, m0, 16384
s_nop 0
buffer_load_dwordx4 v14, s[28:31], s73 offen offset:0 nt lds
v_mfma_f32_16x16x32_bf16 v[84:87], a[136:139], a[20:23], v[84:87]
v_max3_f32 v40, v62, v63, v72
v_max3_f32 v40, v40, v73, v74
v_max3_f32 v37, v37, v38, v65
ds_read_b64_tr_b16 a[102:103], v23 offset:4096
ds_read_b64_tr_b16 a[104:105], v24 offset:0
v_mfma_f32_16x16x32_bf16 v[88:91], a[140:143], a[12:15], v[88:91]
v_max3_f32 v39, v39, v40, v59
v_max3_f32 v37, v37, v61, v75
v_max_f32 v37, v37, v39
v_cmp_lt_f32 vcc, 0x41000000, v37
s_cbranch_vccnz L_rare_t0
L_cont_t0:
ds_read_b64_tr_b16 a[106:107], v24 offset:4096
v_mfma_f32_16x16x32_bf16 v[92:95], a[140:143], a[16:19], v[92:95]
v_exp_f32 v52, v52
v_exp_f32 v53, v53
buffer_load_dwordx4 v15, s[28:31], s73 offen offset:1024 nt lds
v_mfma_f32_16x16x32_bf16 v[96:99], a[140:143], a[20:23], v[96:99]
v_exp_f32 v54, v54
s_waitcnt lgkmcnt(8)
v_mfma_f32_16x16x32_bf16 v[76:79], a[144:147], a[24:27], v[76:79]
ds_read_b64_tr_b16 a[108:109], v25 offset:0
ds_read_b64_tr_b16 a[110:111], v25 offset:4096
v_exp_f32 v55, v55
v_mfma_f32_16x16x32_bf16 v[80:83], a[144:147], a[28:31], v[80:83]
ds_read_b64_tr_b16 a[112:113], v26 offset:0
v_exp_f32 v64, v64
v_exp_f32 v65, v65
buffer_load_dwordx4 v14, s[28:31], s73 offen offset:2048 nt lds
v_mfma_f32_16x16x32_bf16 v[84:87], a[144:147], a[32:35], v[84:87]
ds_read_b64_tr_b16 a[114:115], v26 offset:4096
v_exp_f32 v66, v66
v_mfma_f32_16x16x32_bf16 v[88:91], a[148:151], a[24:27], v[88:91]
ds_read_b64_tr_b16 a[116:117], v27 offset:0
v_exp_f32 v67, v67
v_mfma_f32_16x16x32_bf16 v[92:95], a[148:151], a[28:31], v[92:95]
ds_read_b64_tr_b16 a[118:119], v27 offset:4096
v_cvt_pk_bf16_f32 v100, v52, v53
v_cvt_pk_bf16_f32 v101, v54, v55
buffer_load_dwordx4 v15, s[28:31], s73 offen offset:3072 nt lds
s_add_u32 s73, s73, 8192
v_mfma_f32_16x16x32_bf16 v[96:99], a[148:151], a[32:35], v[96:99]
v_cvt_pk_bf16_f32 v102, v64, v65
s_waitcnt lgkmcnt(12)
v_mfma_f32_16x16x32_bf16 v[76:79], a[152:155], a[36:39], v[76:79]
s_waitcnt lgkmcnt(8)
v_cvt_pk_bf16_f32 v103, v66, v67
v_mfma_f32_16x16x32_bf16 v[80:83], a[152:155], a[40:43], v[80:83]
ds_read_b64_tr_b16 a[120:121], v28 offset:0
v_exp_f32 v56, v56
v_mfma_f32_16x16x32_bf16 v[84:87], a[152:155], a[44:47], v[84:87]
ds_read_b64_tr_b16 a[122:123], v28 offset:4096
v_exp_f32 v57, v57
s_mov_b32 s56, s64
s_and_b32 s3, s58, 12
s_add_u32 s56, s56, s3
s_lshl_b32 s56, s56, 1
s_add_u32 s56, s56, 0
s_lshl_b32 s69, s56, 17
s_lshl_b32 s3, s40, 15
s_add_u32 s69, s69, s3
s_lshl_b32 s3, s64, 8
s_add_u32 s69, s69, s3
s_add_u32 m0, s59, 65536
s_add_u32 s55, s69, 0
buffer_load_dwordx4 v30, s[4:7], s55 offen lds
v_mfma_f32_16x16x32_bf16 v[88:91], a[156:159], a[36:39], v[88:91]
ds_read_b64_tr_b16 a[124:125], v29 offset:0
v_exp_f32 v58, v58
v_mfma_f32_16x16x32_bf16 v[92:95], a[156:159], a[40:43], v[92:95]
ds_read_b64_tr_b16 a[126:127], v29 offset:4096
v_exp_f32 v59, v59
v_mfma_f32_16x16x32_bf16 v[96:99], a[156:159], a[44:47], v[96:99]
v_exp_f32 v68, v68
s_add_u32 m0, s59, 66560
s_add_u32 s55, s69, 4096
buffer_load_dwordx4 v31, s[4:7], s55 offen lds
v_mfma_f32_16x16x32_bf16 a[48:51], a[60:63], v[100:103], a[48:51]
v_exp_f32 v69, v69
s_waitcnt lgkmcnt(8)
v_mfma_f32_16x16x32_bf16 v[152:155], a[96:99], v[100:103], v[152:155]
v_exp_f32 v70, v70
v_mfma_f32_16x16x32_bf16 v[164:167], a[100:103], v[100:103], v[164:167]
v_exp_f32 v71, v71
s_add_u32 m0, s59, 67584
s_add_u32 s55, s69, 8192
buffer_load_dwordx4 v30, s[4:7], s55 offen lds
v_mfma_f32_16x16x32_bf16 v[176:179], a[104:107], v[100:103], v[176:179]
v_cvt_pk_bf16_f32 v104, v56, v57
v_mfma_f32_16x16x32_bf16 v[188:191], a[108:111], v[100:103], v[188:191]
v_cvt_pk_bf16_f32 v105, v58, v59
s_waitcnt lgkmcnt(0)
v_mfma_f32_16x16x32_bf16 v[200:203], a[112:115], v[100:103], v[200:203]
v_cvt_pk_bf16_f32 v106, v68, v69
s_add_u32 m0, s59, 68608
s_add_u32 s55, s69, 12288
buffer_load_dwordx4 v31, s[4:7], s55 offen lds
v_mfma_f32_16x16x32_bf16 v[212:215], a[116:119], v[100:103], v[212:215]
v_cvt_pk_bf16_f32 v107, v70, v71
v_mfma_f32_16x16x32_bf16 v[224:227], a[120:123], v[100:103], v[224:227]
v_exp_f32 v60, v60
v_exp_f32 v61, v61
v_mfma_f32_16x16x32_bf16 v[236:239], a[124:127], v[100:103], v[236:239]
v_exp_f32 v62, v62
v_mfma_f32_16x16x32_bf16 a[52:55], a[60:63], v[104:107], a[52:55]
v_exp_f32 v63, v63
ds_read_b128 a[64:67], v18 offset:0
s_add_u32 m0, s59, 69632
s_add_u32 s55, s69, 16384
buffer_load_dwordx4 v30, s[4:7], s55 offen lds
v_mfma_f32_16x16x32_bf16 v[156:159], a[96:99], v[104:107], v[156:159]
v_exp_f32 v72, v72
ds_read_b128 a[68:71], v18 offset:4096
v_mfma_f32_16x16x32_bf16 v[168:171], a[100:103], v[104:107], v[168:171]
v_exp_f32 v73, v73
v_mfma_f32_16x16x32_bf16 v[180:183], a[104:107], v[104:107], v[180:183]
v_exp_f32 v74, v74
v_exp_f32 v75, v75
ds_read_b128 a[72:75], v19 offset:0
s_add_u32 m0, s59, 70656
s_add_u32 s55, s69, 20480
buffer_load_dwordx4 v31, s[4:7], s55 offen lds
v_mfma_f32_16x16x32_bf16 v[192:195], a[108:111], v[104:107], v[192:195]
v_cvt_pk_bf16_f32 v108, v60, v61
ds_read_b128 a[76:79], v19 offset:4096
v_mfma_f32_16x16x32_bf16 v[204:207], a[112:115], v[104:107], v[204:207]
v_cvt_pk_bf16_f32 v109, v62, v63
v_mfma_f32_16x16x32_bf16 v[216:219], a[116:119], v[104:107], v[216:219]
v_cvt_pk_bf16_f32 v110, v72, v73
ds_read_b128 a[80:83], v20 offset:0
s_add_u32 m0, s59, 71680
s_add_u32 s55, s69, 24576
buffer_load_dwordx4 v30, s[4:7], s55 offen lds
v_mfma_f32_16x16x32_bf16 v[228:231], a[120:123], v[104:107], v[228:231]
v_cvt_pk_bf16_f32 v111, v74, v75
ds_read_b128 a[84:87], v20 offset:4096
v_mfma_f32_16x16x32_bf16 v[240:243], a[124:127], v[104:107], v[240:243]
v_mfma_f32_16x16x32_bf16 a[56:59], a[60:63], v[108:111], a[56:59]
ds_read_b128 a[88:91], v21 offset:0
s_add_u32 m0, s59, 72704
s_add_u32 s55, s69, 28672
buffer_load_dwordx4 v31, s[4:7], s55 offen lds
v_mfma_f32_16x16x32_bf16 v[160:163], a[96:99], v[108:111], v[160:163]
ds_read_b128 a[92:95], v21 offset:4096
v_mfma_f32_16x16x32_bf16 v[172:175], a[100:103], v[108:111], v[172:175]
v_mfma_f32_16x16x32_bf16 v[184:187], a[104:107], v[108:111], v[184:187]
s_mov_b32 s46, s45
s_add_u32 s45, s45, 32768
s_cmp_eq_u32 s45, 163840
s_cselect_b32 s45, 0, s45
s_sub_u32 s57, s45, s46
s_mov_b32 s3, s68
s_add_u32 s68, s68, 32768
s_cmp_eq_u32 s68, 163840
s_cselect_b32 s68, 0, s68
s_sub_u32 s47, s68, s3
v_mfma_f32_16x16x32_bf16 v[196:199], a[108:111], v[108:111], v[196:199]
v_add_u32 v18, s47, v18
v_add_u32 v19, s47, v19
v_add_u32 v20, s47, v20
v_mfma_f32_16x16x32_bf16 v[208:211], a[112:115], v[108:111], v[208:211]
v_add_u32 v21, s47, v21
v_add_u32 v22, s57, v22
v_mfma_f32_16x16x32_bf16 v[220:223], a[116:119], v[108:111], v[220:223]
v_add_u32 v23, s57, v23
v_add_u32 v24, s57, v24
v_add_u32 v25, s57, v25
v_mfma_f32_16x16x32_bf16 v[232:235], a[120:123], v[108:111], v[232:235]
v_add_u32 v26, s57, v26
v_add_u32 v27, s57, v27
v_mfma_f32_16x16x32_bf16 v[244:247], a[124:127], v[108:111], v[244:247]
v_add_u32 v28, s57, v28
v_add_u32 v29, s57, v29
v_fma_f32 v76, v76, s54, -v34
v_fma_f32 v77, v77, s54, -v34
v_fma_f32 v78, v78, s54, -v34
v_fma_f32 v79, v79, s54, -v34
v_fma_f32 v88, v88, s54, -v34
v_fma_f32 v89, v89, s54, -v34
v_fma_f32 v90, v90, s54, -v34
v_fma_f32 v91, v91, s54, -v34
s_waitcnt lgkmcnt(6)
v_mfma_f32_16x16x32_bf16 v[52:55], a[64:67], a[0:3], 0
v_fma_f32 v80, v80, s54, -v35
v_fma_f32 v81, v81, s54, -v35
v_fma_f32 v82, v82, s54, -v35
v_mfma_f32_16x16x32_bf16 v[56:59], a[64:67], a[4:7], 0
v_fma_f32 v83, v83, s54, -v35
v_fma_f32 v92, v92, s54, -v35
v_fma_f32 v93, v93, s54, -v35
v_mfma_f32_16x16x32_bf16 v[60:63], a[64:67], a[8:11], 0
v_fma_f32 v94, v94, s54, -v35
v_fma_f32 v95, v95, s54, -v35
v_mfma_f32_16x16x32_bf16 v[64:67], a[68:71], a[0:3], 0
v_fma_f32 v84, v84, s54, -v36
v_fma_f32 v85, v85, s54, -v36
v_fma_f32 v86, v86, s54, -v36
v_mfma_f32_16x16x32_bf16 v[68:71], a[68:71], a[4:7], 0
v_fma_f32 v87, v87, s54, -v36
v_fma_f32 v96, v96, s54, -v36
v_fma_f32 v97, v97, s54, -v36
v_mfma_f32_16x16x32_bf16 v[72:75], a[68:71], a[8:11], 0
v_fma_f32 v98, v98, s54, -v36
v_fma_f32 v99, v99, s54, -v36
s_waitcnt vmcnt(8)
s_barrier
s_waitcnt lgkmcnt(4)
v_mfma_f32_16x16x32_bf16 v[52:55], a[72:75], a[12:15], v[52:55]
v_max3_f32 v37, v76, v77, v78
v_max3_f32 v37, v37, v79, v88
v_max3_f32 v38, v90, v91, v80
ds_read_b64_tr_b16 a[96:97], v22 offset:0
ds_read_b64_tr_b16 a[98:99], v22 offset:4096
v_mfma_f32_16x16x32_bf16 v[56:59], a[72:75], a[16:19], v[56:59]
v_max3_f32 v38, v38, v81, v82
v_max3_f32 v39, v92, v93, v94
v_max3_f32 v39, v39, v95, v84
ds_read_b64_tr_b16 a[100:101], v23 offset:0
s_add_u32 s74, s45, 131072
s_cmp_ge_u32 s74, 163840
s_cselect_b32 s3, 163840, 0
s_sub_u32 s74, s74, s3
s_add_u32 s75, s45, 32768
s_cmp_ge_u32 s75, 163840
s_cselect_b32 s3, 163840, 0
s_sub_u32 s75, s75, s3
s_add_u32 m0, s75, s48
s_add_u32 m0, m0, 16384
s_nop 0
buffer_load_dwordx4 v14, s[28:31], s73 offen offset:0 nt lds
v_mfma_f32_16x16x32_bf16 v[60:63], a[72:75], a[20:23], v[60:63]
v_max3_f32 v40, v86, v87, v96
v_max3_f32 v40, v40, v97, v98
v_max3_f32 v37, v37, v38, v89
ds_read_b64_tr_b16 a[102:103], v23 offset:4096
ds_read_b64_tr_b16 a[104:105], v24 offset:0
v_mfma_f32_16x16x32_bf16 v[64:67], a[76:79], a[12:15], v[64:67]
v_max3_f32 v39, v39, v40, v83
v_max3_f32 v37, v37, v85, v99
v_max_f32 v37, v37, v39
v_cmp_lt_f32 vcc, 0x41000000, v37
s_cbranch_vccnz L_rare_t1
L_cont_t1:
ds_read_b64_tr_b16 a[106:107], v24 offset:4096
v_mfma_f32_16x16x32_bf16 v[68:71], a[76:79], a[16:19], v[68:71]
v_exp_f32 v76, v76
v_exp_f32 v77, v77
buffer_load_dwordx4 v15, s[28:31], s73 offen offset:1024 nt lds
v_mfma_f32_16x16x32_bf16 v[72:75], a[76:79], a[20:23], v[72:75]
v_exp_f32 v78, v78
s_waitcnt lgkmcnt(8)
v_mfma_f32_16x16x32_bf16 v[52:55], a[80:83], a[24:27], v[52:55]
ds_read_b64_tr_b16 a[108:109], v25 offset:0
ds_read_b64_tr_b16 a[110:111], v25 offset:4096
v_exp_f32 v79, v79
v_mfma_f32_16x16x32_bf16 v[56:59], a[80:83], a[28:31], v[56:59]
ds_read_b64_tr_b16 a[112:113], v26 offset:0
v_exp_f32 v88, v88
v_exp_f32 v89, v89
buffer_load_dwordx4 v14, s[28:31], s73 offen offset:2048 nt lds
v_mfma_f32_16x16x32_bf16 v[60:63], a[80:83], a[32:35], v[60:63]
ds_read_b64_tr_b16 a[114:115], v26 offset:4096
v_exp_f32 v90, v90
v_mfma_f32_16x16x32_bf16 v[64:67], a[84:87], a[24:27], v[64:67]
ds_read_b64_tr_b16 a[116:117], v27 offset:0
v_exp_f32 v91, v91
v_mfma_f32_16x16x32_bf16 v[68:71], a[84:87], a[28:31], v[68:71]
ds_read_b64_tr_b16 a[118:119], v27 offset:4096
v_cvt_pk_bf16_f32 v100, v76, v77
v_cvt_pk_bf16_f32 v101, v78, v79
buffer_load_dwordx4 v15, s[28:31], s73 offen offset:3072 nt lds
s_add_u32 s73, s73, 8192
v_mfma_f32_16x16x32_bf16 v[72:75], a[84:87], a[32:35], v[72:75]
v_cvt_pk_bf16_f32 v102, v88, v89
s_waitcnt lgkmcnt(12)
v_mfma_f32_16x16x32_bf16 v[52:55], a[88:91], a[36:39], v[52:55]
s_waitcnt lgkmcnt(8)
v_cvt_pk_bf16_f32 v103, v90, v91
v_mfma_f32_16x16x32_bf16 v[56:59], a[88:91], a[40:43], v[56:59]
ds_read_b64_tr_b16 a[120:121], v28 offset:0
v_exp_f32 v80, v80
v_mfma_f32_16x16x32_bf16 v[60:63], a[88:91], a[44:47], v[60:63]
ds_read_b64_tr_b16 a[122:123], v28 offset:4096
v_exp_f32 v81, v81
s_mov_b32 s56, s64
s_and_b32 s3, s58, 12
s_add_u32 s56, s56, s3
s_lshl_b32 s56, s56, 1
s_add_u32 s56, s56, 1
s_lshl_b32 s69, s56, 17
s_lshl_b32 s3, s40, 15
s_add_u32 s69, s69, s3
s_lshl_b32 s3, s64, 8
s_add_u32 s69, s69, s3
s_add_u32 m0, s59, 98304
s_add_u32 s55, s69, 0
buffer_load_dwordx4 v30, s[4:7], s55 offen lds
v_mfma_f32_16x16x32_bf16 v[64:67], a[92:95], a[36:39], v[64:67]
ds_read_b64_tr_b16 a[124:125], v29 offset:0
v_exp_f32 v82, v82
v_mfma_f32_16x16x32_bf16 v[68:71], a[92:95], a[40:43], v[68:71]
ds_read_b64_tr_b16 a[126:127], v29 offset:4096
v_exp_f32 v83, v83
v_mfma_f32_16x16x32_bf16 v[72:75], a[92:95], a[44:47], v[72:75]
v_exp_f32 v92, v92
s_add_u32 m0, s59, 99328
s_add_u32 s55, s69, 4096
buffer_load_dwordx4 v31, s[4:7], s55 offen lds
v_mfma_f32_16x16x32_bf16 a[48:51], a[60:63], v[100:103], a[48:51]
v_exp_f32 v93, v93
s_waitcnt lgkmcnt(8)
v_mfma_f32_16x16x32_bf16 v[152:155], a[96:99], v[100:103], v[152:155]
v_exp_f32 v94, v94
v_mfma_f32_16x16x32_bf16 v[164:167], a[100:103], v[100:103], v[164:167]
v_exp_f32 v95, v95
s_add_u32 m0, s59, 100352
s_add_u32 s55, s69, 8192
buffer_load_dwordx4 v30, s[4:7], s55 offen lds
v_mfma_f32_16x16x32_bf16 v[176:179], a[104:107], v[100:103], v[176:179]
v_cvt_pk_bf16_f32 v104, v80, v81
v_mfma_f32_16x16x32_bf16 v[188:191], a[108:111], v[100:103], v[188:191]
v_cvt_pk_bf16_f32 v105, v82, v83
s_waitcnt lgkmcnt(0)
v_mfma_f32_16x16x32_bf16 v[200:203], a[112:115], v[100:103], v[200:203]
v_cvt_pk_bf16_f32 v106, v92, v93
s_add_u32 m0, s59, 101376
s_add_u32 s55, s69, 12288
buffer_load_dwordx4 v31, s[4:7], s55 offen lds
v_mfma_f32_16x16x32_bf16 v[212:215], a[116:119], v[100:103], v[212:215]
v_cvt_pk_bf16_f32 v107, v94, v95
v_mfma_f32_16x16x32_bf16 v[224:227], a[120:123], v[100:103], v[224:227]
v_exp_f32 v84, v84
v_exp_f32 v85, v85
v_mfma_f32_16x16x32_bf16 v[236:239], a[124:127], v[100:103], v[236:239]
v_exp_f32 v86, v86
v_mfma_f32_16x16x32_bf16 a[52:55], a[60:63], v[104:107], a[52:55]
v_exp_f32 v87, v87
ds_read_b128 a[128:131], v18 offset:0
s_add_u32 m0, s59, 102400
s_add_u32 s55, s69, 16384
buffer_load_dwordx4 v30, s[4:7], s55 offen lds
v_mfma_f32_16x16x32_bf16 v[156:159], a[96:99], v[104:107], v[156:159]
v_exp_f32 v96, v96
ds_read_b128 a[132:135], v18 offset:4096
v_mfma_f32_16x16x32_bf16 v[168:171], a[100:103], v[104:107], v[168:171]
v_exp_f32 v97, v97
v_mfma_f32_16x16x32_bf16 v[180:183], a[104:107], v[104:107], v[180:183]
v_exp_f32 v98, v98
v_exp_f32 v99, v99
ds_read_b128 a[136:139], v19 offset:0
s_add_u32 m0, s59, 103424
s_add_u32 s55, s69, 20480
buffer_load_dwordx4 v31, s[4:7], s55 offen lds
v_mfma_f32_16x16x32_bf16 v[192:195], a[108:111], v[104:107], v[192:195]
v_cvt_pk_bf16_f32 v108, v84, v85
ds_read_b128 a[140:143], v19 offset:4096
v_mfma_f32_16x16x32_bf16 v[204:207], a[112:115], v[104:107], v[204:207]
v_cvt_pk_bf16_f32 v109, v86, v87
v_mfma_f32_16x16x32_bf16 v[216:219], a[116:119], v[104:107], v[216:219]
v_cvt_pk_bf16_f32 v110, v96, v97
ds_read_b128 a[144:147], v20 offset:0
s_add_u32 m0, s59, 104448
s_add_u32 s55, s69, 24576
buffer_load_dwordx4 v30, s[4:7], s55 offen lds
v_mfma_f32_16x16x32_bf16 v[228:231], a[120:123], v[104:107], v[228:231]
v_cvt_pk_bf16_f32 v111, v98, v99
ds_read_b128 a[148:151], v20 offset:4096
v_mfma_f32_16x16x32_bf16 v[240:243], a[124:127], v[104:107], v[240:243]
v_mfma_f32_16x16x32_bf16 a[56:59], a[60:63], v[108:111], a[56:59]
ds_read_b128 a[152:155], v21 offset:0
s_add_u32 m0, s59, 105472
s_add_u32 s55, s69, 28672
buffer_load_dwordx4 v31, s[4:7], s55 offen lds
v_mfma_f32_16x16x32_bf16 v[160:163], a[96:99], v[108:111], v[160:163]
ds_read_b128 a[156:159], v21 offset:4096
v_mfma_f32_16x16x32_bf16 v[172:175], a[100:103], v[108:111], v[172:175]
v_mfma_f32_16x16x32_bf16 v[184:187], a[104:107], v[108:111], v[184:187]
s_mov_b32 s46, s45
s_add_u32 s45, s45, 32768
s_cmp_eq_u32 s45, 163840
s_cselect_b32 s45, 0, s45
s_sub_u32 s57, s45, s46
s_mov_b32 s3, s68
s_add_u32 s68, s68, 32768
s_cmp_eq_u32 s68, 163840
s_cselect_b32 s68, 0, s68
s_sub_u32 s47, s68, s3
v_mfma_f32_16x16x32_bf16 v[196:199], a[108:111], v[108:111], v[196:199]
v_add_u32 v18, s47, v18
v_add_u32 v19, s47, v19
v_add_u32 v20, s47, v20
v_mfma_f32_16x16x32_bf16 v[208:211], a[112:115], v[108:111], v[208:211]
v_add_u32 v21, s47, v21
v_add_u32 v22, s57, v22
v_mfma_f32_16x16x32_bf16 v[220:223], a[116:119], v[108:111], v[220:223]
v_add_u32 v23, s57, v23
v_add_u32 v24, s57, v24
v_add_u32 v25, s57, v25
v_mfma_f32_16x16x32_bf16 v[232:235], a[120:123], v[108:111], v[232:235]
v_add_u32 v26, s57, v26
v_add_u32 v27, s57, v27
v_mfma_f32_16x16x32_bf16 v[244:247], a[124:127], v[108:111], v[244:247]
v_add_u32 v28, s57, v28
v_add_u32 v29, s57, v29
v_fma_f32 v52, v52, s54, -v34
v_fma_f32 v53, v53, s54, -v34
v_fma_f32 v54, v54, s54, -v34
v_fma_f32 v55, v55, s54, -v34
v_fma_f32 v64, v64, s54, -v34
v_fma_f32 v65, v65, s54, -v34
v_fma_f32 v66, v66, s54, -v34
v_fma_f32 v67, v67, s54, -v34
s_waitcnt lgkmcnt(6)
v_mfma_f32_16x16x32_bf16 v[76:79], a[128:131], a[0:3], 0
v_fma_f32 v56, v56, s54, -v35
v_fma_f32 v57, v57, s54, -v35
v_fma_f32 v58, v58, s54, -v35
v_mfma_f32_16x16x32_bf16 v[80:83], a[128:131], a[4:7], 0
v_fma_f32 v59, v59, s54, -v35
v_fma_f32 v68, v68, s54, -v35
v_fma_f32 v69, v69, s54, -v35
v_mfma_f32_16x16x32_bf16 v[84:87], a[128:131], a[8:11], 0
v_fma_f32 v70, v70, s54, -v35
v_fma_f32 v71, v71, s54, -v35
v_mfma_f32_16x16x32_bf16 v[88:91], a[132:135], a[0:3], 0
v_fma_f32 v60, v60, s54, -v36
v_fma_f32 v61, v61, s54, -v36
v_fma_f32 v62, v62, s54, -v36
v_mfma_f32_16x16x32_bf16 v[92:95], a[132:135], a[4:7], 0
v_fma_f32 v63, v63, s54, -v36
v_fma_f32 v72, v72, s54, -v36
v_fma_f32 v73, v73, s54, -v36
v_mfma_f32_16x16x32_bf16 v[96:99], a[132:135], a[8:11], 0
v_fma_f32 v74, v74, s54, -v36
v_fma_f32 v75, v75, s54, -v36
s_waitcnt vmcnt(8)
s_barrier
s_waitcnt lgkmcnt(4)
v_mfma_f32_16x16x32_bf16 v[76:79], a[136:139], a[12:15], v[76:79]
v_max3_f32 v37, v52, v53, v54
v_max3_f32 v37, v37, v55, v64
v_max3_f32 v38, v66, v67, v56
ds_read_b64_tr_b16 a[96:97], v22 offset:0
ds_read_b64_tr_b16 a[98:99], v22 offset:4096
v_mfma_f32_16x16x32_bf16 v[80:83], a[136:139], a[16:19], v[80:83]
v_max3_f32 v38, v38, v57, v58
v_max3_f32 v39, v68, v69, v70
v_max3_f32 v39, v39, v71, v60
ds_read_b64_tr_b16 a[100:101], v23 offset:0
s_add_u32 s74, s45, 131072
s_cmp_ge_u32 s74, 163840
s_cselect_b32 s3, 163840, 0
s_sub_u32 s74, s74, s3
s_add_u32 s75, s45, 32768
s_cmp_ge_u32 s75, 163840
s_cselect_b32 s3, 163840, 0
s_sub_u32 s75, s75, s3
s_add_u32 m0, s75, s48
s_add_u32 m0, m0, 16384
s_nop 0
buffer_load_dwordx4 v14, s[28:31], s73 offen offset:0 nt lds
v_mfma_f32_16x16x32_bf16 v[84:87], a[136:139], a[20:23], v[84:87]
v_max3_f32 v40, v62, v63, v72
v_max3_f32 v40, v40, v73, v74
v_max3_f32 v37, v37, v38, v65
ds_read_b64_tr_b16 a[102:103], v23 offset:4096
ds_read_b64_tr_b16 a[104:105], v24 offset:0
v_mfma_f32_16x16x32_bf16 v[88:91], a[140:143], a[12:15], v[88:91]
v_max3_f32 v39, v39, v40, v59
v_max3_f32 v37, v37, v61, v75
v_max_f32 v37, v37, v39
v_cmp_lt_f32 vcc, 0x41000000, v37
s_cbranch_vccnz L_rare_t2
L_cont_t2:
ds_read_b64_tr_b16 a[106:107], v24 offset:4096
v_mfma_f32_16x16x32_bf16 v[92:95], a[140:143], a[16:19], v[92:95]
v_exp_f32 v52, v52
v_exp_f32 v53, v53
buffer_load_dwordx4 v15, s[28:31], s73 offen offset:1024 nt lds
v_mfma_f32_16x16x32_bf16 v[96:99], a[140:143], a[20:23], v[96:99]
v_exp_f32 v54, v54
s_waitcnt lgkmcnt(8)
v_mfma_f32_16x16x32_bf16 v[76:79], a[144:147], a[24:27], v[76:79]
ds_read_b64_tr_b16 a[108:109], v25 offset:0
ds_read_b64_tr_b16 a[110:111], v25 offset:4096
v_exp_f32 v55, v55
v_mfma_f32_16x16x32_bf16 v[80:83], a[144:147], a[28:31], v[80:83]
ds_read_b64_tr_b16 a[112:113], v26 offset:0
v_exp_f32 v64, v64
v_exp_f32 v65, v65
buffer_load_dwordx4 v14, s[28:31], s73 offen offset:2048 nt lds
v_mfma_f32_16x16x32_bf16 v[84:87], a[144:147], a[32:35], v[84:87]
ds_read_b64_tr_b16 a[114:115], v26 offset:4096
v_exp_f32 v66, v66
v_mfma_f32_16x16x32_bf16 v[88:91], a[148:151], a[24:27], v[88:91]
ds_read_b64_tr_b16 a[116:117], v27 offset:0
v_exp_f32 v67, v67
v_mfma_f32_16x16x32_bf16 v[92:95], a[148:151], a[28:31], v[92:95]
ds_read_b64_tr_b16 a[118:119], v27 offset:4096
v_cvt_pk_bf16_f32 v100, v52, v53
v_cvt_pk_bf16_f32 v101, v54, v55
buffer_load_dwordx4 v15, s[28:31], s73 offen offset:3072 nt lds
s_add_u32 s73, s73, 8192
v_mfma_f32_16x16x32_bf16 v[96:99], a[148:151], a[32:35], v[96:99]
v_cvt_pk_bf16_f32 v102, v64, v65
s_waitcnt lgkmcnt(12)
v_mfma_f32_16x16x32_bf16 v[76:79], a[152:155], a[36:39], v[76:79]
s_waitcnt lgkmcnt(8)
v_cvt_pk_bf16_f32 v103, v66, v67
v_mfma_f32_16x16x32_bf16 v[80:83], a[152:155], a[40:43], v[80:83]
ds_read_b64_tr_b16 a[120:121], v28 offset:0
v_exp_f32 v56, v56
v_mfma_f32_16x16x32_bf16 v[84:87], a[152:155], a[44:47], v[84:87]
ds_read_b64_tr_b16 a[122:123], v28 offset:4096
v_exp_f32 v57, v57
s_add_u32 s56, s71, 0
s_cmp_ge_u32 s56, 3
s_cselect_b32 s3, 3, 0
s_sub_u32 s56, s56, s3
s_add_u32 s56, s56, s64
s_add_u32 s56, s56, 1
s_and_b32 s56, s56, 3
s_and_b32 s3, s58, 12
s_add_u32 s56, s56, s3
s_lshl_b32 s56, s56, 1
s_add_u32 s56, s56, 0
s_lshl_b32 s69, s56, 17
s_lshl_b32 s3, s40, 15
s_add_u32 s69, s69, s3
s_lshl_b32 s3, s64, 8
s_add_u32 s69, s69, s3
s_add_u32 m0, s59, 131072
s_add_u32 s55, s69, 0
buffer_load_dwordx4 v30, s[4:7], s55 offen lds
v_mfma_f32_16x16x32_bf16 v[88:91], a[156:159], a[36:39], v[88:91]
ds_read_b64_tr_b16 a[124:125], v29 offset:0
v_exp_f32 v58, v58
v_mfma_f32_16x16x32_bf16 v[92:95], a[156:159], a[40:43], v[92:95]
ds_read_b64_tr_b16 a[126:127], v29 offset:4096
v_exp_f32 v59, v59
v_mfma_f32_16x16x32_bf16 v[96:99], a[156:159], a[44:47], v[96:99]
v_exp_f32 v68, v68
s_add_u32 m0, s59, 132096
s_add_u32 s55, s69, 4096
buffer_load_dwordx4 v31, s[4:7], s55 offen lds
v_mfma_f32_16x16x32_bf16 a[48:51], a[60:63], v[100:103], a[48:51]
v_exp_f32 v69, v69
s_waitcnt lgkmcnt(8)
v_mfma_f32_16x16x32_bf16 v[152:155], a[96:99], v[100:103], v[152:155]
v_exp_f32 v70, v70
v_mfma_f32_16x16x32_bf16 v[164:167], a[100:103], v[100:103], v[164:167]
v_exp_f32 v71, v71
s_add_u32 m0, s59, 133120
s_add_u32 s55, s69, 8192
buffer_load_dwordx4 v30, s[4:7], s55 offen lds
v_mfma_f32_16x16x32_bf16 v[176:179], a[104:107], v[100:103], v[176:179]
v_cvt_pk_bf16_f32 v104, v56, v57
v_mfma_f32_16x16x32_bf16 v[188:191], a[108:111], v[100:103], v[188:191]
v_cvt_pk_bf16_f32 v105, v58, v59
s_waitcnt lgkmcnt(0)
v_mfma_f32_16x16x32_bf16 v[200:203], a[112:115], v[100:103], v[200:203]
v_cvt_pk_bf16_f32 v106, v68, v69
s_add_u32 m0, s59, 134144
s_add_u32 s55, s69, 12288
buffer_load_dwordx4 v31, s[4:7], s55 offen lds
v_mfma_f32_16x16x32_bf16 v[212:215], a[116:119], v[100:103], v[212:215]
v_cvt_pk_bf16_f32 v107, v70, v71
v_mfma_f32_16x16x32_bf16 v[224:227], a[120:123], v[100:103], v[224:227]
v_exp_f32 v60, v60
v_exp_f32 v61, v61
v_mfma_f32_16x16x32_bf16 v[236:239], a[124:127], v[100:103], v[236:239]
v_exp_f32 v62, v62
v_mfma_f32_16x16x32_bf16 a[52:55], a[60:63], v[104:107], a[52:55]
v_exp_f32 v63, v63
s_add_u32 m0, s59, 135168
s_add_u32 s55, s69, 16384
buffer_load_dwordx4 v30, s[4:7], s55 offen lds
v_mfma_f32_16x16x32_bf16 v[156:159], a[96:99], v[104:107], v[156:159]
v_exp_f32 v72, v72
v_mfma_f32_16x16x32_bf16 v[168:171], a[100:103], v[104:107], v[168:171]
v_exp_f32 v73, v73
v_mfma_f32_16x16x32_bf16 v[180:183], a[104:107], v[104:107], v[180:183]
v_exp_f32 v74, v74
v_exp_f32 v75, v75
s_add_u32 m0, s59, 136192
s_add_u32 s55, s69, 20480
buffer_load_dwordx4 v31, s[4:7], s55 offen lds
v_mfma_f32_16x16x32_bf16 v[192:195], a[108:111], v[104:107], v[192:195]
v_cvt_pk_bf16_f32 v108, v60, v61
v_mfma_f32_16x16x32_bf16 v[204:207], a[112:115], v[104:107], v[204:207]
v_cvt_pk_bf16_f32 v109, v62, v63
v_mfma_f32_16x16x32_bf16 v[216:219], a[116:119], v[104:107], v[216:219]
v_cvt_pk_bf16_f32 v110, v72, v73
s_add_u32 m0, s59, 137216
s_add_u32 s55, s69, 24576
buffer_load_dwordx4 v30, s[4:7], s55 offen lds
v_mfma_f32_16x16x32_bf16 v[228:231], a[120:123], v[104:107], v[228:231]
v_cvt_pk_bf16_f32 v111, v74, v75
v_mfma_f32_16x16x32_bf16 v[240:243], a[124:127], v[104:107], v[240:243]
s_nop 0
v_mfma_f32_16x16x32_bf16 a[56:59], a[60:63], v[108:111], a[56:59]
s_add_u32 m0, s59, 138240
s_add_u32 s55, s69, 28672
buffer_load_dwordx4 v31, s[4:7], s55 offen lds
v_mfma_f32_16x16x32_bf16 v[160:163], a[96:99], v[108:111], v[160:163]
v_mfma_f32_16x16x32_bf16 v[172:175], a[100:103], v[108:111], v[172:175]
v_mfma_f32_16x16x32_bf16 v[184:187], a[104:107], v[108:111], v[184:187]
s_mov_b32 s46, s45
s_add_u32 s45, s45, 32768
s_cmp_eq_u32 s45, 163840
s_cselect_b32 s45, 0, s45
s_sub_u32 s57, s45, s46
s_mov_b32 s3, s68
s_add_u32 s68, s68, 32768
s_cmp_eq_u32 s68, 163840
s_cselect_b32 s68, 0, s68
s_sub_u32 s47, s68, s3
v_mfma_f32_16x16x32_bf16 v[196:199], a[108:111], v[108:111], v[196:199]
v_add_u32 v18, s47, v18
v_add_u32 v19, s47, v19
v_add_u32 v20, s47, v20
v_mfma_f32_16x16x32_bf16 v[208:211], a[112:115], v[108:111], v[208:211]
v_add_u32 v21, s47, v21
v_add_u32 v22, s57, v22
v_mfma_f32_16x16x32_bf16 v[220:223], a[116:119], v[108:111], v[220:223]
v_add_u32 v23, s57, v23
v_add_u32 v24, s57, v24
v_add_u32 v25, s57, v25
v_mfma_f32_16x16x32_bf16 v[232:235], a[120:123], v[108:111], v[232:235]
v_add_u32 v26, s57, v26
v_add_u32 v27, s57, v27
v_mfma_f32_16x16x32_bf16 v[244:247], a[124:127], v[108:111], v[244:247]
v_add_u32 v28, s57, v28
v_add_u32 v29, s57, v29
s_waitcnt vmcnt(8)
s_barrier
ds_read_b64_tr_b16 a[96:97], v22 offset:0
ds_read_b64_tr_b16 a[98:99], v22 offset:4096
ds_read_b64_tr_b16 a[100:101], v23 offset:0
ds_read_b64_tr_b16 a[102:103], v23 offset:4096
ds_read_b64_tr_b16 a[104:105], v24 offset:0
ds_read_b64_tr_b16 a[106:107], v24 offset:4096
ds_read_b64_tr_b16 a[108:109], v25 offset:0
ds_read_b64_tr_b16 a[110:111], v25 offset:4096
ds_read_b64_tr_b16 a[112:113], v26 offset:0
ds_read_b64_tr_b16 a[114:115], v26 offset:4096
ds_read_b64_tr_b16 a[116:117], v27 offset:0
ds_read_b64_tr_b16 a[118:119], v27 offset:4096
ds_read_b64_tr_b16 a[120:121], v28 offset:0
ds_read_b64_tr_b16 a[122:123], v28 offset:4096
v_fma_f32 v76, v76, s54, -v34
v_fma_f32 v77, v77, s54, -v34
v_fma_f32 v78, v78, s54, -v34
v_fma_f32 v79, v79, s54, -v34
v_fma_f32 v88, v88, s54, -v34
v_fma_f32 v89, v89, s54, -v34
v_fma_f32 v90, v90, s54, -v34
v_fma_f32 v91, v91, s54, -v34
v_fma_f32 v80, v80, s54, -v35
v_fma_f32 v81, v81, s54, -v35
v_fma_f32 v82, v82, s54, -v35
v_fma_f32 v83, v83, s54, -v35
v_fma_f32 v92, v92, s54, -v35
v_fma_f32 v93, v93, s54, -v35
v_fma_f32 v94, v94, s54, -v35
v_fma_f32 v95, v95, s54, -v35
v_fma_f32 v84, v84, s54, -v36
v_fma_f32 v85, v85, s54, -v36
v_fma_f32 v86, v86, s54, -v36
v_fma_f32 v87, v87, s54, -v36
v_fma_f32 v96, v96, s54, -v36
v_fma_f32 v97, v97, s54, -v36
v_fma_f32 v98, v98, s54, -v36
v_fma_f32 v99, v99, s54, -v36
v_max3_f32 v37, v76, v77, v78
v_max3_f32 v37, v37, v79, v88
v_max3_f32 v38, v90, v91, v80
v_max3_f32 v38, v38, v81, v82
v_max3_f32 v39, v92, v93, v94
v_max3_f32 v39, v39, v95, v84
v_max3_f32 v40, v86, v87, v96
v_max3_f32 v40, v40, v97, v98
v_max3_f32 v37, v37, v38, v89
v_max3_f32 v39, v39, v40, v83
v_max3_f32 v37, v37, v85, v99
v_max_f32 v37, v37, v39
v_cmp_lt_f32 vcc, 0x41000000, v37
s_cbranch_vccnz L_rare_t3
L_cont_t3:
s_waitcnt lgkmcnt(6)
ds_read_b64_tr_b16 a[124:125], v29 offset:0
ds_read_b64_tr_b16 a[126:127], v29 offset:4096
v_exp_f32 v76, v76
v_exp_f32 v77, v77
v_exp_f32 v78, v78
v_exp_f32 v79, v79
v_exp_f32 v88, v88
v_exp_f32 v89, v89
v_exp_f32 v90, v90
v_exp_f32 v91, v91
v_cvt_pk_bf16_f32 v100, v76, v77
v_cvt_pk_bf16_f32 v101, v78, v79
v_cvt_pk_bf16_f32 v102, v88, v89
v_cvt_pk_bf16_f32 v103, v90, v91
s_nop 1
v_mfma_f32_16x16x32_bf16 a[48:51], a[60:63], v[100:103], a[48:51]
v_exp_f32 v80, v80
v_exp_f32 v81, v81
v_mfma_f32_16x16x32_bf16 v[152:155], a[96:99], v[100:103], v[152:155]
v_exp_f32 v82, v82
v_mfma_f32_16x16x32_bf16 v[164:167], a[100:103], v[100:103], v[164:167]
v_exp_f32 v83, v83
v_exp_f32 v92, v92
v_mfma_f32_16x16x32_bf16 v[176:179], a[104:107], v[100:103], v[176:179]
v_exp_f32 v93, v93
v_mfma_f32_16x16x32_bf16 v[188:191], a[108:111], v[100:103], v[188:191]
v_exp_f32 v94, v94
v_exp_f32 v95, v95
s_waitcnt lgkmcnt(0)
v_mfma_f32_16x16x32_bf16 v[200:203], a[112:115], v[100:103], v[200:203]
v_cvt_pk_bf16_f32 v104, v80, v81
v_mfma_f32_16x16x32_bf16 v[212:215], a[116:119], v[100:103], v[212:215]
v_cvt_pk_bf16_f32 v105, v82, v83
v_cvt_pk_bf16_f32 v106, v92, v93
v_mfma_f32_16x16x32_bf16 v[224:227], a[120:123], v[100:103], v[224:227]
v_cvt_pk_bf16_f32 v107, v94, v95
v_mfma_f32_16x16x32_bf16 v[236:239], a[124:127], v[100:103], v[236:239]
s_nop 0
v_mfma_f32_16x16x32_bf16 a[52:55], a[60:63], v[104:107], a[52:55]
v_exp_f32 v84, v84
v_exp_f32 v85, v85
v_mfma_f32_16x16x32_bf16 v[156:159], a[96:99], v[104:107], v[156:159]
v_exp_f32 v86, v86
v_mfma_f32_16x16x32_bf16 v[168:171], a[100:103], v[104:107], v[168:171]
v_exp_f32 v87, v87
v_exp_f32 v96, v96
v_mfma_f32_16x16x32_bf16 v[180:183], a[104:107], v[104:107], v[180:183]
v_exp_f32 v97, v97
v_mfma_f32_16x16x32_bf16 v[192:195], a[108:111], v[104:107], v[192:195]
v_exp_f32 v98, v98
v_exp_f32 v99, v99
v_mfma_f32_16x16x32_bf16 v[204:207], a[112:115], v[104:107], v[204:207]
v_cvt_pk_bf16_f32 v108, v84, v85
v_mfma_f32_16x16x32_bf16 v[216:219], a[116:119], v[104:107], v[216:219]
v_cvt_pk_bf16_f32 v109, v86, v87
v_cvt_pk_bf16_f32 v110, v96, v97
v_mfma_f32_16x16x32_bf16 v[228:231], a[120:123], v[104:107], v[228:231]
v_cvt_pk_bf16_f32 v111, v98, v99
v_mfma_f32_16x16x32_bf16 v[240:243], a[124:127], v[104:107], v[240:243]
s_nop 0
v_mfma_f32_16x16x32_bf16 a[56:59], a[60:63], v[108:111], a[56:59]
v_mov_b32 v4, 0
buffer_load_dwordx2 v[2:3], v4, s[12:15], 0 offen sc1
v_mfma_f32_16x16x32_bf16 v[160:163], a[96:99], v[108:111], v[160:163]
v_mfma_f32_16x16x32_bf16 v[172:175], a[100:103], v[108:111], v[172:175]
v_mfma_f32_16x16x32_bf16 v[184:187], a[104:107], v[108:111], v[184:187]
v_mfma_f32_16x16x32_bf16 v[196:199], a[108:111], v[108:111], v[196:199]
v_mfma_f32_16x16x32_bf16 v[208:211], a[112:115], v[108:111], v[208:211]
v_mfma_f32_16x16x32_bf16 v[220:223], a[116:119], v[108:111], v[220:223]
v_mfma_f32_16x16x32_bf16 v[232:235], a[120:123], v[108:111], v[232:235]
v_mfma_f32_16x16x32_bf16 v[244:247], a[124:127], v[108:111], v[244:247]
v_accvgpr_read_b32 v43, a48
v_accvgpr_read_b32 v44, a52
v_accvgpr_read_b32 v45, a56
v_rcp_f32 v43, v43
v_rcp_f32 v44, v44
v_rcp_f32 v45, v45
s_lshl_b32 s65, s42, 5
s_add_u32 s65, s65, s41
s_add_u32 s65, s65, s51
s_mul_i32 s65, s65, 6
s_mul_i32 s3, s43, 3
s_add_u32 s65, s65, s3
s_lshl_b32 s65, s65, 12
s_add_u32 s65, s65, 469762048
s_mul_i32 s3, s40, 12288
v_add_u32 v4, s3, v32
v_mul_f32 v152, v43, v152
v_mul_f32 v153, v43, v153
v_mul_f32 v154, v43, v154
v_mul_f32 v155, v43, v155
v_cvt_pk_bf16_f32 v52, v152, v153
v_cvt_pk_bf16_f32 v53, v154, v155
v_mul_f32 v164, v43, v164
v_mul_f32 v165, v43, v165
v_mul_f32 v166, v43, v166
v_mul_f32 v167, v43, v167
v_cvt_pk_bf16_f32 v54, v164, v165
v_cvt_pk_bf16_f32 v55, v166, v167
s_add_u32 s55, s65, 0
buffer_store_dwordx4 v[52:55], v32, s[36:39], s55 offen offset:0 sc1
ds_write_b128 v4, v[52:55] offset:0
v_mul_f32 v176, v43, v176
v_mul_f32 v177, v43, v177
v_mul_f32 v178, v43, v178
v_mul_f32 v179, v43, v179
v_cvt_pk_bf16_f32 v64, v176, v177
v_cvt_pk_bf16_f32 v65, v178, v179
v_mul_f32 v188, v43, v188
v_mul_f32 v189, v43, v189
v_mul_f32 v190, v43, v190
v_mul_f32 v191, v43, v191
v_cvt_pk_bf16_f32 v66, v188, v189
v_cvt_pk_bf16_f32 v67, v190, v191
s_add_u32 s55, s65, 0
buffer_store_dwordx4 v[64:67], v32, s[36:39], s55 offen offset:1024 sc1
ds_write_b128 v4, v[64:67] offset:3072
v_mul_f32 v200, v43, v200
v_mul_f32 v201, v43, v201
v_mul_f32 v202, v43, v202
v_mul_f32 v203, v43, v203
v_cvt_pk_bf16_f32 v76, v200, v201
v_cvt_pk_bf16_f32 v77, v202, v203
v_mul_f32 v212, v43, v212
v_mul_f32 v213, v43, v213
v_mul_f32 v214, v43, v214
v_mul_f32 v215, v43, v215
v_cvt_pk_bf16_f32 v78, v212, v213
v_cvt_pk_bf16_f32 v79, v214, v215
s_add_u32 s55, s65, 0
buffer_store_dwordx4 v[76:79], v32, s[36:39], s55 offen offset:2048 sc1
ds_write_b128 v4, v[76:79] offset:6144
v_mul_f32 v224, v43, v224
v_mul_f32 v225, v43, v225
v_mul_f32 v226, v43, v226
v_mul_f32 v227, v43, v227
v_cvt_pk_bf16_f32 v88, v224, v225
v_cvt_pk_bf16_f32 v89, v226, v227
v_mul_f32 v236, v43, v236
v_mul_f32 v237, v43, v237
v_mul_f32 v238, v43, v238
v_mul_f32 v239, v43, v239
v_cvt_pk_bf16_f32 v90, v236, v237
v_cvt_pk_bf16_f32 v91, v238, v239
s_add_u32 s55, s65, 0
buffer_store_dwordx4 v[88:91], v32, s[36:39], s55 offen offset:3072 sc1
ds_write_b128 v4, v[88:91] offset:9216
v_mul_f32 v156, v44, v156
v_mul_f32 v157, v44, v157
v_mul_f32 v158, v44, v158
v_mul_f32 v159, v44, v159
v_cvt_pk_bf16_f32 v56, v156, v157
v_cvt_pk_bf16_f32 v57, v158, v159
v_mul_f32 v168, v44, v168
v_mul_f32 v169, v44, v169
v_mul_f32 v170, v44, v170
v_mul_f32 v171, v44, v171
v_cvt_pk_bf16_f32 v58, v168, v169
v_cvt_pk_bf16_f32 v59, v170, v171
s_add_u32 s55, s65, 4096
buffer_store_dwordx4 v[56:59], v32, s[36:39], s55 offen offset:0 sc1
ds_write_b128 v4, v[56:59] offset:1024
v_mul_f32 v180, v44, v180
v_mul_f32 v181, v44, v181
v_mul_f32 v182, v44, v182
v_mul_f32 v183, v44, v183
v_cvt_pk_bf16_f32 v68, v180, v181
v_cvt_pk_bf16_f32 v69, v182, v183
v_mul_f32 v192, v44, v192
v_mul_f32 v193, v44, v193
v_mul_f32 v194, v44, v194
v_mul_f32 v195, v44, v195
v_cvt_pk_bf16_f32 v70, v192, v193
v_cvt_pk_bf16_f32 v71, v194, v195
s_add_u32 s55, s65, 4096
buffer_store_dwordx4 v[68:71], v32, s[36:39], s55 offen offset:1024 sc1
ds_write_b128 v4, v[68:71] offset:4096
v_mul_f32 v204, v44, v204
v_mul_f32 v205, v44, v205
v_mul_f32 v206, v44, v206
v_mul_f32 v207, v44, v207
v_cvt_pk_bf16_f32 v80, v204, v205
v_cvt_pk_bf16_f32 v81, v206, v207
v_mul_f32 v216, v44, v216
v_mul_f32 v217, v44, v217
v_mul_f32 v218, v44, v218
v_mul_f32 v219, v44, v219
v_cvt_pk_bf16_f32 v82, v216, v217
v_cvt_pk_bf16_f32 v83, v218, v219
s_add_u32 s55, s65, 4096
buffer_store_dwordx4 v[80:83], v32, s[36:39], s55 offen offset:2048 sc1
ds_write_b128 v4, v[80:83] offset:7168
v_mul_f32 v228, v44, v228
v_mul_f32 v229, v44, v229
v_mul_f32 v230, v44, v230
v_mul_f32 v231, v44, v231
v_cvt_pk_bf16_f32 v92, v228, v229
v_cvt_pk_bf16_f32 v93, v230, v231
v_mul_f32 v240, v44, v240
v_mul_f32 v241, v44, v241
v_mul_f32 v242, v44, v242
v_mul_f32 v243, v44, v243
v_cvt_pk_bf16_f32 v94, v240, v241
v_cvt_pk_bf16_f32 v95, v242, v243
s_add_u32 s55, s65, 4096
buffer_store_dwordx4 v[92:95], v32, s[36:39], s55 offen offset:3072 sc1
ds_write_b128 v4, v[92:95] offset:10240
v_mul_f32 v160, v45, v160
v_mul_f32 v161, v45, v161
v_mul_f32 v162, v45, v162
v_mul_f32 v163, v45, v163
v_cvt_pk_bf16_f32 v60, v160, v161
v_cvt_pk_bf16_f32 v61, v162, v163
v_mul_f32 v172, v45, v172
v_mul_f32 v173, v45, v173
v_mul_f32 v174, v45, v174
v_mul_f32 v175, v45, v175
v_cvt_pk_bf16_f32 v62, v172, v173
v_cvt_pk_bf16_f32 v63, v174, v175
s_add_u32 s55, s65, 8192
buffer_store_dwordx4 v[60:63], v32, s[36:39], s55 offen offset:0 sc1
ds_write_b128 v4, v[60:63] offset:2048
v_mul_f32 v184, v45, v184
v_mul_f32 v185, v45, v185
v_mul_f32 v186, v45, v186
v_mul_f32 v187, v45, v187
v_cvt_pk_bf16_f32 v72, v184, v185
v_cvt_pk_bf16_f32 v73, v186, v187
v_mul_f32 v196, v45, v196
v_mul_f32 v197, v45, v197
v_mul_f32 v198, v45, v198
v_mul_f32 v199, v45, v199
v_cvt_pk_bf16_f32 v74, v196, v197
v_cvt_pk_bf16_f32 v75, v198, v199
s_add_u32 s55, s65, 8192
buffer_store_dwordx4 v[72:75], v32, s[36:39], s55 offen offset:1024 sc1
ds_write_b128 v4, v[72:75] offset:5120
v_mul_f32 v208, v45, v208
v_mul_f32 v209, v45, v209
v_mul_f32 v210, v45, v210
v_mul_f32 v211, v45, v211
v_cvt_pk_bf16_f32 v84, v208, v209
v_cvt_pk_bf16_f32 v85, v210, v211
v_mul_f32 v220, v45, v220
v_mul_f32 v221, v45, v221
v_mul_f32 v222, v45, v222
v_mul_f32 v223, v45, v223
v_cvt_pk_bf16_f32 v86, v220, v221
v_cvt_pk_bf16_f32 v87, v222, v223
s_add_u32 s55, s65, 8192
buffer_store_dwordx4 v[84:87], v32, s[36:39], s55 offen offset:2048 sc1
ds_write_b128 v4, v[84:87] offset:8192
v_mul_f32 v232, v45, v232
v_mul_f32 v233, v45, v233
v_mul_f32 v234, v45, v234
v_mul_f32 v235, v45, v235
v_cvt_pk_bf16_f32 v96, v232, v233
v_cvt_pk_bf16_f32 v97, v234, v235
v_mul_f32 v244, v45, v244
v_mul_f32 v245, v45, v245
v_mul_f32 v246, v45, v246
v_mul_f32 v247, v45, v247
v_cvt_pk_bf16_f32 v98, v244, v245
v_cvt_pk_bf16_f32 v99, v246, v247
s_add_u32 s55, s65, 8192
buffer_store_dwordx4 v[96:99], v32, s[36:39], s55 offen offset:3072 sc1
ds_write_b128 v4, v[96:99] offset:11264
s_waitcnt lgkmcnt(0)
s_barrier
s_mul_i32 s3, s43, 12288
v_add_u32 v4, s3, v32
ds_read_b128 v[152:155], v4 offset:0
ds_read_b128 v[156:159], v4 offset:1024
ds_read_b128 v[160:163], v4 offset:2048
ds_read_b128 v[164:167], v4 offset:3072
ds_read_b128 v[168:171], v4 offset:4096
ds_read_b128 v[172:175], v4 offset:5120
ds_read_b128 v[176:179], v4 offset:6144
ds_read_b128 v[180:183], v4 offset:7168
ds_read_b128 v[184:187], v4 offset:8192
ds_read_b128 v[188:191], v4 offset:9216
ds_read_b128 v[192:195], v4 offset:10240
ds_read_b128 v[196:199], v4 offset:11264
s_waitcnt lgkmcnt(0)
ds_read_b128 v[200:203], v4 offset:24576
ds_read_b128 v[204:207], v4 offset:25600
ds_read_b128 v[208:211], v4 offset:26624
ds_read_b128 v[212:215], v4 offset:27648
ds_read_b128 v[216:219], v4 offset:28672
ds_read_b128 v[220:223], v4 offset:29696
ds_read_b128 v[224:227], v4 offset:30720
ds_read_b128 v[228:231], v4 offset:31744
ds_read_b128 v[232:235], v4 offset:32768
ds_read_b128 v[236:239], v4 offset:33792
ds_read_b128 v[240:243], v4 offset:34816
ds_read_b128 v[244:247], v4 offset:35840
s_lshl_b32 s3, s51, 7
v_xor_b32 v34, s3, v0
v_xor_b32 v35, 32, v34
v_xor_b32 v36, 64, v34
v_xor_b32 v37, 96, v34
v_add_u32 v38, 65536, v34
v_add_u32 v39, 65536, v35
v_add_u32 v40, 65536, v36
v_add_u32 v41, 65536, v37
v_add_u32 v42, 131072, v34
v_add_u32 v43, 131072, v35
v_add_u32 v44, 131072, v36
v_add_u32 v45, 131072, v37
s_mul_i32 s3, s43, 12288
v_add_u32 v46, s3, v32
s_waitcnt lgkmcnt(0)
s_barrier
ds_read_b64_tr_b16 a[64:65], v38 offset:0
ds_read_b64_tr_b16 a[66:67], v38 offset:4096
ds_read_b64_tr_b16 a[68:69], v39 offset:0
ds_read_b64_tr_b16 a[70:71], v39 offset:4096
ds_read_b64_tr_b16 a[72:73], v40 offset:0
ds_read_b64_tr_b16 a[74:75], v40 offset:4096
ds_read_b64_tr_b16 a[76:77], v41 offset:0
ds_read_b64_tr_b16 a[78:79], v41 offset:4096
s_waitcnt lgkmcnt(0)
v_mfma_f32_16x16x32_bf16 v[52:55], a[64:67], v[152:155], 0
v_mfma_f32_16x16x32_bf16 v[56:59], a[64:67], v[156:159], 0
ds_read_b64_tr_b16 a[80:81], v38 offset:8192
v_mfma_f32_16x16x32_bf16 v[60:63], a[64:67], v[160:163], 0
ds_read_b64_tr_b16 a[82:83], v38 offset:12288
v_mfma_f32_16x16x32_bf16 v[64:67], a[68:71], v[152:155], 0
ds_read_b64_tr_b16 a[84:85], v39 offset:8192
v_mfma_f32_16x16x32_bf16 v[68:71], a[68:71], v[156:159], 0
ds_read_b64_tr_b16 a[86:87], v39 offset:12288
v_mfma_f32_16x16x32_bf16 v[72:75], a[68:71], v[160:163], 0
ds_read_b64_tr_b16 a[88:89], v40 offset:8192
v_mfma_f32_16x16x32_bf16 v[76:79], a[72:75], v[152:155], 0
ds_read_b64_tr_b16 a[90:91], v40 offset:12288
v_mfma_f32_16x16x32_bf16 v[80:83], a[72:75], v[156:159], 0
ds_read_b64_tr_b16 a[92:93], v41 offset:8192
v_mfma_f32_16x16x32_bf16 v[84:87], a[72:75], v[160:163], 0
ds_read_b64_tr_b16 a[94:95], v41 offset:12288
v_mfma_f32_16x16x32_bf16 v[88:91], a[76:79], v[152:155], 0
v_mfma_f32_16x16x32_bf16 v[92:95], a[76:79], v[156:159], 0
v_mfma_f32_16x16x32_bf16 v[96:99], a[76:79], v[160:163], 0
s_waitcnt lgkmcnt(0)
v_mfma_f32_16x16x32_bf16 v[52:55], a[80:83], v[164:167], v[52:55]
v_mfma_f32_16x16x32_bf16 v[56:59], a[80:83], v[168:171], v[56:59]
ds_read_b64_tr_b16 a[64:65], v38 offset:16384
v_mfma_f32_16x16x32_bf16 v[60:63], a[80:83], v[172:175], v[60:63]
ds_read_b64_tr_b16 a[66:67], v38 offset:20480
v_mfma_f32_16x16x32_bf16 v[64:67], a[84:87], v[164:167], v[64:67]
ds_read_b64_tr_b16 a[68:69], v39 offset:16384
v_mfma_f32_16x16x32_bf16 v[68:71], a[84:87], v[168:171], v[68:71]
ds_read_b64_tr_b16 a[70:71], v39 offset:20480
v_mfma_f32_16x16x32_bf16 v[72:75], a[84:87], v[172:175], v[72:75]
ds_read_b64_tr_b16 a[72:73], v40 offset:16384
v_mfma_f32_16x16x32_bf16 v[76:79], a[88:91], v[164:167], v[76:79]
ds_read_b64_tr_b16 a[74:75], v40 offset:20480
v_mfma_f32_16x16x32_bf16 v[80:83], a[88:91], v[168:171], v[80:83]
ds_read_b64_tr_b16 a[76:77], v41 offset:16384
v_mfma_f32_16x16x32_bf16 v[84:87], a[88:91], v[172:175], v[84:87]
ds_read_b64_tr_b16 a[78:79], v41 offset:20480
v_mfma_f32_16x16x32_bf16 v[88:91], a[92:95], v[164:167], v[88:91]
v_mfma_f32_16x16x32_bf16 v[92:95], a[92:95], v[168:171], v[92:95]
v_mfma_f32_16x16x32_bf16 v[96:99], a[92:95], v[172:175], v[96:99]
s_waitcnt lgkmcnt(0)
v_mfma_f32_16x16x32_bf16 v[52:55], a[64:67], v[176:179], v[52:55]
v_mfma_f32_16x16x32_bf16 v[56:59], a[64:67], v[180:183], v[56:59]
ds_read_b64_tr_b16 a[80:81], v38 offset:24576
v_mfma_f32_16x16x32_bf16 v[60:63], a[64:67], v[184:187], v[60:63]
ds_read_b64_tr_b16 a[82:83], v38 offset:28672
v_mfma_f32_16x16x32_bf16 v[64:67], a[68:71], v[176:179], v[64:67]
ds_read_b64_tr_b16 a[84:85], v39 offset:24576
v_mfma_f32_16x16x32_bf16 v[68:71], a[68:71], v[180:183], v[68:71]
ds_read_b64_tr_b16 a[86:87], v39 offset:28672
v_mfma_f32_16x16x32_bf16 v[72:75], a[68:71], v[184:187], v[72:75]
ds_read_b64_tr_b16 a[88:89], v40 offset:24576
v_mfma_f32_16x16x32_bf16 v[76:79], a[72:75], v[176:179], v[76:79]
ds_read_b64_tr_b16 a[90:91], v40 offset:28672
v_mfma_f32_16x16x32_bf16 v[80:83], a[72:75], v[180:183], v[80:83]
ds_read_b64_tr_b16 a[92:93], v41 offset:24576
v_mfma_f32_16x16x32_bf16 v[84:87], a[72:75], v[184:187], v[84:87]
ds_read_b64_tr_b16 a[94:95], v41 offset:28672
v_mfma_f32_16x16x32_bf16 v[88:91], a[76:79], v[176:179], v[88:91]
v_mfma_f32_16x16x32_bf16 v[92:95], a[76:79], v[180:183], v[92:95]
v_mfma_f32_16x16x32_bf16 v[96:99], a[76:79], v[184:187], v[96:99]
s_waitcnt lgkmcnt(0)
s_barrier
v_mfma_f32_16x16x32_bf16 v[52:55], a[80:83], v[188:191], v[52:55]
v_mfma_f32_16x16x32_bf16 v[56:59], a[80:83], v[192:195], v[56:59]
ds_read_b64_tr_b16 a[64:65], v38 offset:32768
v_mfma_f32_16x16x32_bf16 v[60:63], a[80:83], v[196:199], v[60:63]
ds_read_b64_tr_b16 a[66:67], v38 offset:36864
v_mfma_f32_16x16x32_bf16 v[64:67], a[84:87], v[188:191], v[64:67]
ds_read_b64_tr_b16 a[68:69], v39 offset:32768
v_mfma_f32_16x16x32_bf16 v[68:71], a[84:87], v[192:195], v[68:71]
ds_read_b64_tr_b16 a[70:71], v39 offset:36864
v_mfma_f32_16x16x32_bf16 v[72:75], a[84:87], v[196:199], v[72:75]
ds_read_b64_tr_b16 a[72:73], v40 offset:32768
v_mfma_f32_16x16x32_bf16 v[76:79], a[88:91], v[188:191], v[76:79]
ds_read_b64_tr_b16 a[74:75], v40 offset:36864
v_mfma_f32_16x16x32_bf16 v[80:83], a[88:91], v[192:195], v[80:83]
ds_read_b64_tr_b16 a[76:77], v41 offset:32768
v_mfma_f32_16x16x32_bf16 v[84:87], a[88:91], v[196:199], v[84:87]
ds_read_b64_tr_b16 a[78:79], v41 offset:36864
v_mfma_f32_16x16x32_bf16 v[88:91], a[92:95], v[188:191], v[88:91]
v_mfma_f32_16x16x32_bf16 v[92:95], a[92:95], v[192:195], v[92:95]
v_mfma_f32_16x16x32_bf16 v[96:99], a[92:95], v[196:199], v[96:99]
s_waitcnt lgkmcnt(0)
v_mfma_f32_16x16x32_bf16 v[52:55], a[64:67], v[200:203], v[52:55]
v_mfma_f32_16x16x32_bf16 v[56:59], a[64:67], v[204:207], v[56:59]
ds_read_b64_tr_b16 a[80:81], v38 offset:40960
s_add_u32 s56, s71, 0
s_cmp_ge_u32 s56, 3
s_cselect_b32 s3, 3, 0
s_sub_u32 s56, s56, s3
s_add_u32 s56, s56, s64
s_add_u32 s56, s56, 1
s_and_b32 s56, s56, 3
s_and_b32 s3, s58, 12
s_add_u32 s56, s56, s3
s_lshl_b32 s56, s56, 1
s_add_u32 s56, s56, 1
s_lshl_b32 s69, s56, 17
s_lshl_b32 s3, s40, 15
s_add_u32 s69, s69, s3
s_lshl_b32 s3, s64, 8
s_add_u32 s69, s69, s3
s_add_u32 m0, s59, 65536
s_add_u32 s55, s69, 0
buffer_load_dwordx4 v30, s[4:7], s55 offen lds
v_mfma_f32_16x16x32_bf16 v[60:63], a[64:67], v[208:211], v[60:63]
ds_read_b64_tr_b16 a[82:83], v38 offset:45056
v_mfma_f32_16x16x32_bf16 v[64:67], a[68:71], v[200:203], v[64:67]
ds_read_b64_tr_b16 a[84:85], v39 offset:40960
v_mfma_f32_16x16x32_bf16 v[68:71], a[68:71], v[204:207], v[68:71]
ds_read_b64_tr_b16 a[86:87], v39 offset:45056
v_mfma_f32_16x16x32_bf16 v[72:75], a[68:71], v[208:211], v[72:75]
ds_read_b64_tr_b16 a[88:89], v40 offset:40960
s_add_u32 m0, s59, 66560
s_add_u32 s55, s69, 4096
buffer_load_dwordx4 v31, s[4:7], s55 offen lds
v_mfma_f32_16x16x32_bf16 v[76:79], a[72:75], v[200:203], v[76:79]
ds_read_b64_tr_b16 a[90:91], v40 offset:45056
v_mfma_f32_16x16x32_bf16 v[80:83], a[72:75], v[204:207], v[80:83]
ds_read_b64_tr_b16 a[92:93], v41 offset:40960
v_mfma_f32_16x16x32_bf16 v[84:87], a[72:75], v[208:211], v[84:87]
ds_read_b64_tr_b16 a[94:95], v41 offset:45056
v_mfma_f32_16x16x32_bf16 v[88:91], a[76:79], v[200:203], v[88:91]
s_add_u32 m0, s59, 67584
s_add_u32 s55, s69, 8192
buffer_load_dwordx4 v30, s[4:7], s55 offen lds
v_mfma_f32_16x16x32_bf16 v[92:95], a[76:79], v[204:207], v[92:95]
v_mfma_f32_16x16x32_bf16 v[96:99], a[76:79], v[208:211], v[96:99]
s_waitcnt lgkmcnt(0)
v_mfma_f32_16x16x32_bf16 v[52:55], a[80:83], v[212:215], v[52:55]
v_mfma_f32_16x16x32_bf16 v[56:59], a[80:83], v[216:219], v[56:59]
ds_read_b64_tr_b16 a[64:65], v38 offset:49152
s_add_u32 m0, s59, 68608
s_add_u32 s55, s69, 12288
buffer_load_dwordx4 v31, s[4:7], s55 offen lds
v_mfma_f32_16x16x32_bf16 v[60:63], a[80:83], v[220:223], v[60:63]
ds_read_b64_tr_b16 a[66:67], v38 offset:53248
v_mfma_f32_16x16x32_bf16 v[64:67], a[84:87], v[212:215], v[64:67]
ds_read_b64_tr_b16 a[68:69], v39 offset:49152
v_mfma_f32_16x16x32_bf16 v[68:71], a[84:87], v[216:219], v[68:71]
ds_read_b64_tr_b16 a[70:71], v39 offset:53248
v_mfma_f32_16x16x32_bf16 v[72:75], a[84:87], v[220:223], v[72:75]
ds_read_b64_tr_b16 a[72:73], v40 offset:49152
s_add_u32 m0, s59, 69632
s_add_u32 s55, s69, 16384
buffer_load_dwordx4 v30, s[4:7], s55 offen lds
v_mfma_f32_16x16x32_bf16 v[76:79], a[88:91], v[212:215], v[76:79]
ds_read_b64_tr_b16 a[74:75], v40 offset:53248
v_mfma_f32_16x16x32_bf16 v[80:83], a[88:91], v[216:219], v[80:83]
ds_read_b64_tr_b16 a[76:77], v41 offset:49152
v_mfma_f32_16x16x32_bf16 v[84:87], a[88:91], v[220:223], v[84:87]
ds_read_b64_tr_b16 a[78:79], v41 offset:53248
v_mfma_f32_16x16x32_bf16 v[88:91], a[92:95], v[212:215], v[88:91]
s_add_u32 m0, s59, 70656
s_add_u32 s55, s69, 20480
buffer_load_dwordx4 v31, s[4:7], s55 offen lds
v_mfma_f32_16x16x32_bf16 v[92:95], a[92:95], v[216:219], v[92:95]
v_mfma_f32_16x16x32_bf16 v[96:99], a[92:95], v[220:223], v[96:99]
s_waitcnt lgkmcnt(0)
v_mfma_f32_16x16x32_bf16 v[52:55], a[64:67], v[224:227], v[52:55]
v_mfma_f32_16x16x32_bf16 v[56:59], a[64:67], v[228:231], v[56:59]
ds_read_b64_tr_b16 a[80:81], v38 offset:57344
s_add_u32 m0, s59, 71680
s_add_u32 s55, s69, 24576
buffer_load_dwordx4 v30, s[4:7], s55 offen lds
v_mfma_f32_16x16x32_bf16 v[60:63], a[64:67], v[232:235], v[60:63]
ds_read_b64_tr_b16 a[82:83], v38 offset:61440
v_mfma_f32_16x16x32_bf16 v[64:67], a[68:71], v[224:227], v[64:67]
ds_read_b64_tr_b16 a[84:85], v39 offset:57344
v_mfma_f32_16x16x32_bf16 v[68:71], a[68:71], v[228:231], v[68:71]
ds_read_b64_tr_b16 a[86:87], v39 offset:61440
v_mfma_f32_16x16x32_bf16 v[72:75], a[68:71], v[232:235], v[72:75]
ds_read_b64_tr_b16 a[88:89], v40 offset:57344
s_add_u32 m0, s59, 72704
s_add_u32 s55, s69, 28672
buffer_load_dwordx4 v31, s[4:7], s55 offen lds
v_mfma_f32_16x16x32_bf16 v[76:79], a[72:75], v[224:227], v[76:79]
ds_read_b64_tr_b16 a[90:91], v40 offset:61440
v_mfma_f32_16x16x32_bf16 v[80:83], a[72:75], v[228:231], v[80:83]
ds_read_b64_tr_b16 a[92:93], v41 offset:57344
v_mfma_f32_16x16x32_bf16 v[84:87], a[72:75], v[232:235], v[84:87]
ds_read_b64_tr_b16 a[94:95], v41 offset:61440
v_mfma_f32_16x16x32_bf16 v[88:91], a[76:79], v[224:227], v[88:91]
v_mfma_f32_16x16x32_bf16 v[92:95], a[76:79], v[228:231], v[92:95]
v_mfma_f32_16x16x32_bf16 v[96:99], a[76:79], v[232:235], v[96:99]
s_waitcnt lgkmcnt(0)
v_mfma_f32_16x16x32_bf16 v[52:55], a[80:83], v[236:239], v[52:55]
v_mfma_f32_16x16x32_bf16 v[56:59], a[80:83], v[240:243], v[56:59]
v_mfma_f32_16x16x32_bf16 v[60:63], a[80:83], v[244:247], v[60:63]
v_mfma_f32_16x16x32_bf16 v[64:67], a[84:87], v[236:239], v[64:67]
v_mfma_f32_16x16x32_bf16 v[68:71], a[84:87], v[240:243], v[68:71]
v_mfma_f32_16x16x32_bf16 v[72:75], a[84:87], v[244:247], v[72:75]
v_mfma_f32_16x16x32_bf16 v[76:79], a[88:91], v[236:239], v[76:79]
v_mfma_f32_16x16x32_bf16 v[80:83], a[88:91], v[240:243], v[80:83]
v_mfma_f32_16x16x32_bf16 v[84:87], a[88:91], v[244:247], v[84:87]
v_mfma_f32_16x16x32_bf16 v[88:91], a[92:95], v[236:239], v[88:91]
v_mfma_f32_16x16x32_bf16 v[92:95], a[92:95], v[240:243], v[92:95]
v_mfma_f32_16x16x32_bf16 v[96:99], a[92:95], v[244:247], v[96:99]
s_waitcnt vmcnt(8)
s_barrier
s_cmp_eq_u32 s40, 0
s_cbranch_scc0 L_pskip_A
s_mov_b32 s49, 0
L_nonce_A:
s_add_u32 s49, s49, 1
s_cmp_gt_u32 s49, 0x40000
s_cbranch_scc1 L_pskip_A
v_or_b32 v4, v2, v3
v_cmp_eq_u32 vcc, 0, v4
s_cbranch_vccz L_nok_A
s_sleep 2
v_mov_b32 v4, 0
buffer_load_dwordx2 v[2:3], v4, s[12:15], 0 offen sc1
s_waitcnt vmcnt(0)
s_branch L_nonce_A
L_nok_A:
s_lshl_b32 s55, s42, 7
s_lshl_b32 s3, s58, 3
s_add_u32 s55, s55, s3
s_add_u32 s55, s55, 494927872
v_mov_b32 v4, 0
buffer_store_dwordx2 v[2:3], v4, s[36:39], s55 offen sc1
L_pskip_A:
v_and_b32 v47, 3, v1
v_lshlrev_b32 v47, 3, v47
s_cmp_eq_u32 s40, 0
s_cbranch_scc0 L_ep_A
s_lshl_b32 s55, s42, 7
s_and_b32 s3, s58, 12
s_lshl_b32 s3, s3, 3
s_add_u32 s55, s55, s3
s_add_u32 s55, s55, 494927872
buffer_load_dwordx2 v[50:51], v47, s[36:39], s55 offen sc1
L_ep_A:
s_add_u32 s56, s71, 1
s_cmp_ge_u32 s56, 3
s_cselect_b32 s3, 3, 0
s_sub_u32 s56, s56, s3
s_add_u32 s56, s56, s64
s_add_u32 s56, s56, 1
s_and_b32 s56, s56, 3
s_and_b32 s3, s58, 12
s_add_u32 s56, s56, s3
s_lshl_b32 s56, s56, 1
s_add_u32 s56, s56, 0
s_lshl_b32 s69, s56, 17
s_lshl_b32 s3, s40, 15
s_add_u32 s69, s69, s3
s_lshl_b32 s3, s64, 8
s_add_u32 s69, s69, s3
s_add_u32 m0, s59, 98304
s_add_u32 s55, s69, 0
buffer_load_dwordx4 v30, s[4:7], s55 offen lds
s_add_u32 m0, s59, 99328
s_add_u32 s55, s69, 4096
buffer_load_dwordx4 v31, s[4:7], s55 offen lds
s_add_u32 m0, s59, 100352
s_add_u32 s55, s69, 8192
buffer_load_dwordx4 v30, s[4:7], s55 offen lds
s_add_u32 m0, s59, 101376
s_add_u32 s55, s69, 12288
buffer_load_dwordx4 v31, s[4:7], s55 offen lds
s_add_u32 m0, s59, 102400
s_add_u32 s55, s69, 16384
buffer_load_dwordx4 v30, s[4:7], s55 offen lds
s_add_u32 m0, s59, 103424
s_add_u32 s55, s69, 20480
buffer_load_dwordx4 v31, s[4:7], s55 offen lds
s_add_u32 m0, s59, 104448
s_add_u32 s55, s69, 24576
buffer_load_dwordx4 v30, s[4:7], s55 offen lds
s_add_u32 m0, s59, 105472
s_add_u32 s55, s69, 28672
buffer_load_dwordx4 v31, s[4:7], s55 offen lds
ds_read_b64_tr_b16 a[128:129], v42 offset:0
ds_read_b64_tr_b16 a[130:131], v42 offset:4096
ds_read_b64_tr_b16 a[132:133], v43 offset:0
ds_read_b64_tr_b16 a[134:135], v43 offset:4096
ds_read_b64_tr_b16 a[136:137], v44 offset:0
ds_read_b64_tr_b16 a[138:139], v44 offset:4096
ds_read_b64_tr_b16 a[140:141], v45 offset:0
ds_read_b64_tr_b16 a[142:143], v45 offset:4096
ds_read_b64_tr_b16 a[144:145], v42 offset:8192
ds_read_b64_tr_b16 a[146:147], v42 offset:12288
ds_read_b64_tr_b16 a[148:149], v43 offset:8192
ds_read_b64_tr_b16 a[150:151], v43 offset:12288
ds_read_b64_tr_b16 a[152:153], v44 offset:8192
ds_read_b64_tr_b16 a[154:155], v44 offset:12288
s_waitcnt lgkmcnt(6)
ds_read_b64_tr_b16 a[156:157], v45 offset:8192
ds_read_b64_tr_b16 a[158:159], v45 offset:12288
ds_read_b64_tr_b16 a[160:161], v42 offset:16384
ds_read_b64_tr_b16 a[162:163], v42 offset:20480
ds_read_b64_tr_b16 a[164:165], v43 offset:16384
ds_read_b64_tr_b16 a[166:167], v43 offset:20480
ds_read_b64_tr_b16 a[168:169], v44 offset:16384
ds_read_b64_tr_b16 a[170:171], v44 offset:20480
s_waitcnt lgkmcnt(6)
ds_read_b64_tr_b16 a[172:173], v45 offset:16384
ds_read_b64_tr_b16 a[174:175], v45 offset:20480
ds_read_b64_tr_b16 a[176:177], v42 offset:24576
ds_read_b64_tr_b16 a[178:179], v42 offset:28672
ds_read_b64_tr_b16 a[180:181], v43 offset:24576
ds_read_b64_tr_b16 a[182:183], v43 offset:28672
ds_read_b64_tr_b16 a[184:185], v44 offset:24576
ds_read_b64_tr_b16 a[186:187], v44 offset:28672
s_waitcnt lgkmcnt(6)
ds_read_b64_tr_b16 a[188:189], v45 offset:24576
ds_read_b64_tr_b16 a[190:191], v45 offset:28672
s_waitcnt vmcnt(8)
s_waitcnt lgkmcnt(0)
s_barrier
s_add_u32 s56, s71, 1
s_cmp_ge_u32 s56, 3
s_cselect_b32 s3, 3, 0
s_sub_u32 s56, s56, s3
s_add_u32 s56, s56, s64
s_add_u32 s56, s56, 1
s_and_b32 s56, s56, 3
s_and_b32 s3, s58, 12
s_add_u32 s56, s56, s3
s_lshl_b32 s56, s56, 1
s_add_u32 s56, s56, 1
s_lshl_b32 s69, s56, 17
s_lshl_b32 s3, s40, 15
s_add_u32 s69, s69, s3
s_lshl_b32 s3, s64, 8
s_add_u32 s69, s69, s3
s_add_u32 m0, s59, 131072
s_add_u32 s55, s69, 0
buffer_load_dwordx4 v30, s[4:7], s55 offen lds
s_add_u32 m0, s59, 132096
s_add_u32 s55, s69, 4096
buffer_load_dwordx4 v31, s[4:7], s55 offen lds
s_add_u32 m0, s59, 133120
s_add_u32 s55, s69, 8192
buffer_load_dwordx4 v30, s[4:7], s55 offen lds
s_add_u32 m0, s59, 134144
s_add_u32 s55, s69, 12288
buffer_load_dwordx4 v31, s[4:7], s55 offen lds
s_add_u32 m0, s59, 135168
s_add_u32 s55, s69, 16384
buffer_load_dwordx4 v30, s[4:7], s55 offen lds
s_add_u32 m0, s59, 136192
s_add_u32 s55, s69, 20480
buffer_load_dwordx4 v31, s[4:7], s55 offen lds
s_add_u32 m0, s59, 137216
s_add_u32 s55, s69, 24576
buffer_load_dwordx4 v30, s[4:7], s55 offen lds
s_add_u32 m0, s59, 138240
s_add_u32 s55, s69, 28672
buffer_load_dwordx4 v31, s[4:7], s55 offen lds
s_cmp_eq_u32 s40, 0
s_cbranch_scc0 L_skip_A
s_lshl_b32 s3, s64, 3
v_xor_b32 v50, v50, v2
v_xor_b32 v51, v51, v3
v_or_b32 v50, v50, v51
v_cmp_ne_u32 vcc, s3, v47
s_nop 1
v_cndmask_b32 v50, 0, v50, vcc
v_cmp_ne_u32 vcc, 0, v50
s_cbranch_vccz L_skip_A
s_mov_b32 s49, 0
s_lshl_b32 s55, s42, 7
s_and_b32 s3, s58, 12
s_lshl_b32 s3, s3, 3
s_add_u32 s55, s55, s3
s_add_u32 s55, s55, 494927872
v_and_b32 v5, 3, v1
v_lshlrev_b32 v5, 3, v5
buffer_load_dwordx2 v[6:7], v5, s[36:39], s55 offen sc1
L_poll_A:
s_add_u32 s49, s49, 1
s_cmp_gt_u32 s49, 0x40000
s_cbranch_scc1 L_pdone_A
buffer_load_dwordx2 v[48:49], v5, s[36:39], s55 offen sc1
s_waitcnt vmcnt(1)
v_xor_b32 v6, v6, v2
v_xor_b32 v7, v7, v3
v_or_b32 v6, v6, v7
v_cmp_ne_u32 vcc, 0, v6
s_cbranch_vccz L_pdone_A
buffer_load_dwordx2 v[6:7], v5, s[36:39], s55 offen sc1
s_waitcnt vmcnt(1)
v_xor_b32 v48, v48, v2
v_xor_b32 v49, v49, v3
v_or_b32 v48, v48, v49
v_cmp_ne_u32 vcc, 0, v48
s_cbranch_vccnz L_poll_A
L_pdone_A:
s_waitcnt vmcnt(0)
L_skip_A:
s_barrier
s_add_u32 s56, s71, 0
s_cmp_ge_u32 s56, 3
s_cselect_b32 s3, 3, 0
s_sub_u32 s56, s56, s3
s_add_u32 s56, s56, s64
s_add_u32 s56, s56, 1
s_and_b32 s56, s56, 3
s_and_b32 s3, s58, 12
s_add_u32 s56, s56, s3
s_lshl_b32 s56, s56, 1
s_add_u32 s56, s56, 0
s_lshl_b32 s3, s42, 5
s_add_u32 s56, s56, s3
s_mul_i32 s72, s56, 24576
s_mul_i32 s3, s40, 6144
s_add_u32 s72, s72, s3
s_add_u32 s72, s72, 469762048
s_mul_i32 s70, s40, 6144
s_add_u32 m0, s70, 0
s_add_u32 s55, s72, 0
buffer_load_dwordx4 v32, s[36:39], s55 offen sc1 lds
s_add_u32 m0, s70, 1024
s_add_u32 s55, s72, 1024
buffer_load_dwordx4 v32, s[36:39], s55 offen sc1 lds
s_add_u32 m0, s70, 2048
s_add_u32 s55, s72, 2048
buffer_load_dwordx4 v32, s[36:39], s55 offen sc1 lds
s_add_u32 m0, s70, 3072
s_add_u32 s55, s72, 3072
buffer_load_dwordx4 v32, s[36:39], s55 offen sc1 lds
s_add_u32 m0, s70, 4096
s_add_u32 s55, s72, 4096
buffer_load_dwordx4 v32, s[36:39], s55 offen sc1 lds
s_add_u32 m0, s70, 5120
s_add_u32 s55, s72, 5120
buffer_load_dwordx4 v32, s[36:39], s55 offen sc1 lds
ds_read_b64_tr_b16 a[192:193], v38 offset:0
ds_read_b64_tr_b16 a[194:195], v38 offset:4096
ds_read_b64_tr_b16 a[196:197], v39 offset:0
ds_read_b64_tr_b16 a[198:199], v39 offset:4096
ds_read_b64_tr_b16 a[200:201], v40 offset:0
ds_read_b64_tr_b16 a[202:203], v40 offset:4096
ds_read_b64_tr_b16 a[204:205], v41 offset:0
ds_read_b64_tr_b16 a[206:207], v41 offset:4096
ds_read_b64_tr_b16 a[208:209], v38 offset:8192
ds_read_b64_tr_b16 a[210:211], v38 offset:12288
ds_read_b64_tr_b16 a[212:213], v39 offset:8192
ds_read_b64_tr_b16 a[214:215], v39 offset:12288
ds_read_b64_tr_b16 a[216:217], v40 offset:8192
ds_read_b64_tr_b16 a[218:219], v40 offset:12288
s_waitcnt lgkmcnt(6)
ds_read_b64_tr_b16 a[220:221], v41 offset:8192
ds_read_b64_tr_b16 a[222:223], v41 offset:12288
ds_read_b64_tr_b16 a[224:225], v38 offset:16384
ds_read_b64_tr_b16 a[226:227], v38 offset:20480
ds_read_b64_tr_b16 a[228:229], v39 offset:16384
ds_read_b64_tr_b16 a[230:231], v39 offset:20480
ds_read_b64_tr_b16 a[232:233], v40 offset:16384
ds_read_b64_tr_b16 a[234:235], v40 offset:20480
s_waitcnt lgkmcnt(6)
ds_read_b64_tr_b16 a[236:237], v41 offset:16384
ds_read_b64_tr_b16 a[238:239], v41 offset:20480
ds_read_b64_tr_b16 a[240:241], v38 offset:24576
ds_read_b64_tr_b16 a[242:243], v38 offset:28672
ds_read_b64_tr_b16 a[244:245], v39 offset:24576
ds_read_b64_tr_b16 a[246:247], v39 offset:28672
ds_read_b64_tr_b16 a[248:249], v40 offset:24576
ds_read_b64_tr_b16 a[250:251], v40 offset:28672
s_waitcnt lgkmcnt(6)
ds_read_b64_tr_b16 a[252:253], v41 offset:24576
ds_read_b64_tr_b16 a[254:255], v41 offset:28672
s_waitcnt lgkmcnt(0)
s_add_u32 s56, s71, 0
s_cmp_ge_u32 s56, 3
s_cselect_b32 s3, 3, 0
s_sub_u32 s56, s56, s3
s_add_u32 s56, s56, s64
s_add_u32 s56, s56, 1
s_and_b32 s56, s56, 3
s_and_b32 s3, s58, 12
s_add_u32 s56, s56, s3
s_lshl_b32 s56, s56, 1
s_add_u32 s56, s56, 1
s_lshl_b32 s3, s42, 5
s_add_u32 s56, s56, s3
s_mul_i32 s72, s56, 24576
s_mul_i32 s3, s40, 6144
s_add_u32 s72, s72, s3
s_add_u32 s72, s72, 469762048
s_mul_i32 s70, s40, 6144
s_add_u32 m0, s70, 24576
s_add_u32 s55, s72, 0
buffer_load_dwordx4 v32, s[36:39], s55 offen sc1 lds
s_add_u32 m0, s70, 25600
s_add_u32 s55, s72, 1024
buffer_load_dwordx4 v32, s[36:39], s55 offen sc1 lds
s_add_u32 m0, s70, 26624
s_add_u32 s55, s72, 2048
buffer_load_dwordx4 v32, s[36:39], s55 offen sc1 lds
s_add_u32 m0, s70, 27648
s_add_u32 s55, s72, 3072
buffer_load_dwordx4 v32, s[36:39], s55 offen sc1 lds
s_add_u32 m0, s70, 28672
s_add_u32 s55, s72, 4096
buffer_load_dwordx4 v32, s[36:39], s55 offen sc1 lds
s_add_u32 m0, s70, 29696
s_add_u32 s55, s72, 5120
buffer_load_dwordx4 v32, s[36:39], s55 offen sc1 lds
s_waitcnt vmcnt(6)
s_barrier
ds_read_b128 v[100:103], v46 offset:0
ds_read_b128 v[104:107], v46 offset:4096
ds_read_b128 v[108:111], v46 offset:8192
s_waitcnt lgkmcnt(0)
v_mfma_f32_16x16x32_bf16 v[52:55], a[128:131], v[100:103], v[52:55]
s_add_u32 s56, s71, 2
s_cmp_ge_u32 s56, 3
s_cselect_b32 s3, 3, 0
s_sub_u32 s56, s56, s3
s_add_u32 s56, s56, s64
s_add_u32 s56, s56, 1
s_and_b32 s56, s56, 3
s_and_b32 s3, s58, 12
s_add_u32 s56, s56, s3
s_lshl_b32 s56, s56, 1
s_add_u32 s56, s56, 0
s_lshl_b32 s69, s56, 17
s_lshl_b32 s3, s40, 15
s_add_u32 s69, s69, s3
s_lshl_b32 s3, s64, 8
s_add_u32 s69, s69, s3
s_add_u32 m0, s59, 65536
s_add_u32 s55, s69, 0
buffer_load_dwordx4 v30, s[4:7], s55 offen lds
v_mfma_f32_16x16x32_bf16 v[56:59], a[128:131], v[104:107], v[56:59]
ds_read_b128 v[112:115], v46 offset:1024
v_mfma_f32_16x16x32_bf16 v[60:63], a[128:131], v[108:111], v[60:63]
v_mfma_f32_16x16x32_bf16 v[64:67], a[132:135], v[100:103], v[64:67]
s_add_u32 m0, s59, 66560
s_add_u32 s55, s69, 4096
buffer_load_dwordx4 v31, s[4:7], s55 offen lds
v_mfma_f32_16x16x32_bf16 v[68:71], a[132:135], v[104:107], v[68:71]
ds_read_b128 v[116:119], v46 offset:5120
v_mfma_f32_16x16x32_bf16 v[72:75], a[132:135], v[108:111], v[72:75]
v_mfma_f32_16x16x32_bf16 v[76:79], a[136:139], v[100:103], v[76:79]
s_add_u32 m0, s59, 67584
s_add_u32 s55, s69, 8192
buffer_load_dwordx4 v30, s[4:7], s55 offen lds
v_mfma_f32_16x16x32_bf16 v[80:83], a[136:139], v[104:107], v[80:83]
ds_read_b128 v[120:123], v46 offset:9216
v_mfma_f32_16x16x32_bf16 v[84:87], a[136:139], v[108:111], v[84:87]
v_mfma_f32_16x16x32_bf16 v[88:91], a[140:143], v[100:103], v[88:91]
s_add_u32 m0, s59, 68608
s_add_u32 s55, s69, 12288
buffer_load_dwordx4 v31, s[4:7], s55 offen lds
v_mfma_f32_16x16x32_bf16 v[92:95], a[140:143], v[104:107], v[92:95]
v_mfma_f32_16x16x32_bf16 v[96:99], a[140:143], v[108:111], v[96:99]
s_waitcnt lgkmcnt(0)
v_mfma_f32_16x16x32_bf16 v[52:55], a[144:147], v[112:115], v[52:55]
s_add_u32 m0, s59, 69632
s_add_u32 s55, s69, 16384
buffer_load_dwordx4 v30, s[4:7], s55 offen lds
v_mfma_f32_16x16x32_bf16 v[56:59], a[144:147], v[116:119], v[56:59]
ds_read_b128 v[100:103], v46 offset:2048
v_mfma_f32_16x16x32_bf16 v[60:63], a[144:147], v[120:123], v[60:63]
v_mfma_f32_16x16x32_bf16 v[64:67], a[148:151], v[112:115], v[64:67]
s_add_u32 m0, s59, 70656
s_add_u32 s55, s69, 20480
buffer_load_dwordx4 v31, s[4:7], s55 offen lds
v_mfma_f32_16x16x32_bf16 v[68:71], a[148:151], v[116:119], v[68:71]
ds_read_b128 v[104:107], v46 offset:6144
v_mfma_f32_16x16x32_bf16 v[72:75], a[148:151], v[120:123], v[72:75]
v_mfma_f32_16x16x32_bf16 v[76:79], a[152:155], v[112:115], v[76:79]
s_add_u32 m0, s59, 71680
s_add_u32 s55, s69, 24576
buffer_load_dwordx4 v30, s[4:7], s55 offen lds
v_mfma_f32_16x16x32_bf16 v[80:83], a[152:155], v[116:119], v[80:83]
ds_read_b128 v[108:111], v46 offset:10240
v_mfma_f32_16x16x32_bf16 v[84:87], a[152:155], v[120:123], v[84:87]
v_mfma_f32_16x16x32_bf16 v[88:91], a[156:159], v[112:115], v[88:91]
s_add_u32 m0, s59, 72704
s_add_u32 s55, s69, 28672
buffer_load_dwordx4 v31, s[4:7], s55 offen lds
v_mfma_f32_16x16x32_bf16 v[92:95], a[156:159], v[116:119], v[92:95]
v_mfma_f32_16x16x32_bf16 v[96:99], a[156:159], v[120:123], v[96:99]
s_waitcnt lgkmcnt(0)
v_mfma_f32_16x16x32_bf16 v[52:55], a[160:163], v[100:103], v[52:55]
v_mfma_f32_16x16x32_bf16 v[56:59], a[160:163], v[104:107], v[56:59]
ds_read_b128 v[112:115], v46 offset:3072
v_mfma_f32_16x16x32_bf16 v[60:63], a[160:163], v[108:111], v[60:63]
v_mfma_f32_16x16x32_bf16 v[64:67], a[164:167], v[100:103], v[64:67]
v_mfma_f32_16x16x32_bf16 v[68:71], a[164:167], v[104:107], v[68:71]
ds_read_b128 v[116:119], v46 offset:7168
v_mfma_f32_16x16x32_bf16 v[72:75], a[164:167], v[108:111], v[72:75]
v_mfma_f32_16x16x32_bf16 v[76:79], a[168:171], v[100:103], v[76:79]
v_mfma_f32_16x16x32_bf16 v[80:83], a[168:171], v[104:107], v[80:83]
ds_read_b128 v[120:123], v46 offset:11264
v_mfma_f32_16x16x32_bf16 v[84:87], a[168:171], v[108:111], v[84:87]
v_mfma_f32_16x16x32_bf16 v[88:91], a[172:175], v[100:103], v[88:91]
v_mfma_f32_16x16x32_bf16 v[92:95], a[172:175], v[104:107], v[92:95]
v_mfma_f32_16x16x32_bf16 v[96:99], a[172:175], v[108:111], v[96:99]
s_waitcnt lgkmcnt(0)
s_waitcnt vmcnt(8)
s_barrier
v_mfma_f32_16x16x32_bf16 v[52:55], a[176:179], v[112:115], v[52:55]
v_mfma_f32_16x16x32_bf16 v[56:59], a[176:179], v[116:119], v[56:59]
ds_read_b128 v[100:103], v46 offset:24576
s_add_u32 s56, s71, 1
s_cmp_ge_u32 s56, 3
s_cselect_b32 s3, 3, 0
s_sub_u32 s56, s56, s3
s_add_u32 s56, s56, s64
s_add_u32 s56, s56, 1
s_and_b32 s56, s56, 3
s_and_b32 s3, s58, 12
s_add_u32 s56, s56, s3
s_lshl_b32 s56, s56, 1
s_add_u32 s56, s56, 0
s_lshl_b32 s3, s42, 5
s_add_u32 s56, s56, s3
s_mul_i32 s72, s56, 24576
s_mul_i32 s3, s40, 6144
s_add_u32 s72, s72, s3
s_add_u32 s72, s72, 469762048
s_mul_i32 s70, s40, 6144
s_add_u32 m0, s70, 0
s_add_u32 s55, s72, 0
buffer_load_dwordx4 v32, s[36:39], s55 offen sc1 lds
v_mfma_f32_16x16x32_bf16 v[60:63], a[176:179], v[120:123], v[60:63]
s_add_u32 m0, s70, 1024
s_add_u32 s55, s72, 1024
buffer_load_dwordx4 v32, s[36:39], s55 offen sc1 lds
v_mfma_f32_16x16x32_bf16 v[64:67], a[180:183], v[112:115], v[64:67]
v_mfma_f32_16x16x32_bf16 v[68:71], a[180:183], v[116:119], v[68:71]
ds_read_b128 v[104:107], v46 offset:28672
s_add_u32 m0, s70, 2048
s_add_u32 s55, s72, 2048
buffer_load_dwordx4 v32, s[36:39], s55 offen sc1 lds
v_mfma_f32_16x16x32_bf16 v[72:75], a[180:183], v[120:123], v[72:75]
v_mfma_f32_16x16x32_bf16 v[76:79], a[184:187], v[112:115], v[76:79]
s_add_u32 m0, s70, 3072
s_add_u32 s55, s72, 3072
buffer_load_dwordx4 v32, s[36:39], s55 offen sc1 lds
v_mfma_f32_16x16x32_bf16 v[80:83], a[184:187], v[116:119], v[80:83]
ds_read_b128 v[108:111], v46 offset:32768
v_mfma_f32_16x16x32_bf16 v[84:87], a[184:187], v[120:123], v[84:87]
s_add_u32 m0, s70, 4096
s_add_u32 s55, s72, 4096
buffer_load_dwordx4 v32, s[36:39], s55 offen sc1 lds
v_mfma_f32_16x16x32_bf16 v[88:91], a[188:191], v[112:115], v[88:91]
v_mfma_f32_16x16x32_bf16 v[92:95], a[188:191], v[116:119], v[92:95]
s_add_u32 m0, s70, 5120
s_add_u32 s55, s72, 5120
buffer_load_dwordx4 v32, s[36:39], s55 offen sc1 lds
v_mfma_f32_16x16x32_bf16 v[96:99], a[188:191], v[120:123], v[96:99]
s_waitcnt lgkmcnt(0)
v_mfma_f32_16x16x32_bf16 v[52:55], a[192:195], v[100:103], v[52:55]
v_mfma_f32_16x16x32_bf16 v[56:59], a[192:195], v[104:107], v[56:59]
ds_read_b128 v[112:115], v46 offset:25600
v_mfma_f32_16x16x32_bf16 v[60:63], a[192:195], v[108:111], v[60:63]
v_mfma_f32_16x16x32_bf16 v[64:67], a[196:199], v[100:103], v[64:67]
v_mfma_f32_16x16x32_bf16 v[68:71], a[196:199], v[104:107], v[68:71]
ds_read_b128 v[116:119], v46 offset:29696
v_mfma_f32_16x16x32_bf16 v[72:75], a[196:199], v[108:111], v[72:75]
v_mfma_f32_16x16x32_bf16 v[76:79], a[200:203], v[100:103], v[76:79]
v_mfma_f32_16x16x32_bf16 v[80:83], a[200:203], v[104:107], v[80:83]
ds_read_b128 v[120:123], v46 offset:33792
v_mfma_f32_16x16x32_bf16 v[84:87], a[200:203], v[108:111], v[84:87]
v_mfma_f32_16x16x32_bf16 v[88:91], a[204:207], v[100:103], v[88:91]
v_mfma_f32_16x16x32_bf16 v[92:95], a[204:207], v[104:107], v[92:95]
v_mfma_f32_16x16x32_bf16 v[96:99], a[204:207], v[108:111], v[96:99]
s_waitcnt lgkmcnt(0)
v_mfma_f32_16x16x32_bf16 v[52:55], a[208:211], v[112:115], v[52:55]
v_mfma_f32_16x16x32_bf16 v[56:59], a[208:211], v[116:119], v[56:59]
ds_read_b128 v[100:103], v46 offset:26624
v_mfma_f32_16x16x32_bf16 v[60:63], a[208:211], v[120:123], v[60:63]
v_mfma_f32_16x16x32_bf16 v[64:67], a[212:215], v[112:115], v[64:67]
v_mfma_f32_16x16x32_bf16 v[68:71], a[212:215], v[116:119], v[68:71]
ds_read_b128 v[104:107], v46 offset:30720
v_mfma_f32_16x16x32_bf16 v[72:75], a[212:215], v[120:123], v[72:75]
v_mfma_f32_16x16x32_bf16 v[76:79], a[216:219], v[112:115], v[76:79]
v_mfma_f32_16x16x32_bf16 v[80:83], a[216:219], v[116:119], v[80:83]
ds_read_b128 v[108:111], v46 offset:34816
v_mfma_f32_16x16x32_bf16 v[84:87], a[216:219], v[120:123], v[84:87]
v_mfma_f32_16x16x32_bf16 v[88:91], a[220:223], v[112:115], v[88:91]
v_mfma_f32_16x16x32_bf16 v[92:95], a[220:223], v[116:119], v[92:95]
v_mfma_f32_16x16x32_bf16 v[96:99], a[220:223], v[120:123], v[96:99]
s_waitcnt lgkmcnt(0)
v_mfma_f32_16x16x32_bf16 v[52:55], a[224:227], v[100:103], v[52:55]
v_mfma_f32_16x16x32_bf16 v[56:59], a[224:227], v[104:107], v[56:59]
ds_read_b128 v[112:115], v46 offset:27648
v_mfma_f32_16x16x32_bf16 v[60:63], a[224:227], v[108:111], v[60:63]
v_mfma_f32_16x16x32_bf16 v[64:67], a[228:231], v[100:103], v[64:67]
v_mfma_f32_16x16x32_bf16 v[68:71], a[228:231], v[104:107], v[68:71]
ds_read_b128 v[116:119], v46 offset:31744
v_mfma_f32_16x16x32_bf16 v[72:75], a[228:231], v[108:111], v[72:75]
v_mfma_f32_16x16x32_bf16 v[76:79], a[232:235], v[100:103], v[76:79]
v_mfma_f32_16x16x32_bf16 v[80:83], a[232:235], v[104:107], v[80:83]
ds_read_b128 v[120:123], v46 offset:35840
v_mfma_f32_16x16x32_bf16 v[84:87], a[232:235], v[108:111], v[84:87]
v_mfma_f32_16x16x32_bf16 v[88:91], a[236:239], v[100:103], v[88:91]
v_mfma_f32_16x16x32_bf16 v[92:95], a[236:239], v[104:107], v[92:95]
v_mfma_f32_16x16x32_bf16 v[96:99], a[236:239], v[108:111], v[96:99]
s_waitcnt lgkmcnt(0)
s_waitcnt vmcnt(0)
s_barrier
v_mfma_f32_16x16x32_bf16 v[52:55], a[240:243], v[112:115], v[52:55]
v_mfma_f32_16x16x32_bf16 v[56:59], a[240:243], v[116:119], v[56:59]
ds_read_b128 v[100:103], v46 offset:0
ds_read_b128 v[104:107], v46 offset:4096
s_add_u32 s56, s71, 1
s_cmp_ge_u32 s56, 3
s_cselect_b32 s3, 3, 0
s_sub_u32 s56, s56, s3
s_add_u32 s56, s56, s64
s_add_u32 s56, s56, 1
s_and_b32 s56, s56, 3
s_and_b32 s3, s58, 12
s_add_u32 s56, s56, s3
s_lshl_b32 s56, s56, 1
s_add_u32 s56, s56, 1
s_lshl_b32 s3, s42, 5
s_add_u32 s56, s56, s3
s_mul_i32 s72, s56, 24576
s_mul_i32 s3, s40, 6144
s_add_u32 s72, s72, s3
s_add_u32 s72, s72, 469762048
s_mul_i32 s70, s40, 6144
s_add_u32 m0, s70, 24576
s_add_u32 s55, s72, 0
buffer_load_dwordx4 v32, s[36:39], s55 offen sc1 lds
v_mfma_f32_16x16x32_bf16 v[60:63], a[240:243], v[120:123], v[60:63]
ds_read_b128 v[108:111], v46 offset:8192
s_add_u32 m0, s70, 25600
s_add_u32 s55, s72, 1024
buffer_load_dwordx4 v32, s[36:39], s55 offen sc1 lds
v_mfma_f32_16x16x32_bf16 v[64:67], a[244:247], v[112:115], v[64:67]
ds_read_b64_tr_b16 a[64:65], v38 offset:32768
v_mfma_f32_16x16x32_bf16 v[68:71], a[244:247], v[116:119], v[68:71]
ds_read_b64_tr_b16 a[66:67], v38 offset:36864
s_add_u32 m0, s70, 26624
s_add_u32 s55, s72, 2048
buffer_load_dwordx4 v32, s[36:39], s55 offen sc1 lds
v_mfma_f32_16x16x32_bf16 v[72:75], a[244:247], v[120:123], v[72:75]
ds_read_b64_tr_b16 a[68:69], v39 offset:32768
v_mfma_f32_16x16x32_bf16 v[76:79], a[248:251], v[112:115], v[76:79]
ds_read_b64_tr_b16 a[70:71], v39 offset:36864
s_add_u32 m0, s70, 27648
s_add_u32 s55, s72, 3072
buffer_load_dwordx4 v32, s[36:39], s55 offen sc1 lds
v_mfma_f32_16x16x32_bf16 v[80:83], a[248:251], v[116:119], v[80:83]
ds_read_b64_tr_b16 a[72:73], v40 offset:32768
v_mfma_f32_16x16x32_bf16 v[84:87], a[248:251], v[120:123], v[84:87]
ds_read_b64_tr_b16 a[74:75], v40 offset:36864
s_add_u32 m0, s70, 28672
s_add_u32 s55, s72, 4096
buffer_load_dwordx4 v32, s[36:39], s55 offen sc1 lds
v_mfma_f32_16x16x32_bf16 v[88:91], a[252:255], v[112:115], v[88:91]
ds_read_b64_tr_b16 a[76:77], v41 offset:32768
v_mfma_f32_16x16x32_bf16 v[92:95], a[252:255], v[116:119], v[92:95]
ds_read_b64_tr_b16 a[78:79], v41 offset:36864
s_add_u32 m0, s70, 29696
s_add_u32 s55, s72, 5120
buffer_load_dwordx4 v32, s[36:39], s55 offen sc1 lds
v_mfma_f32_16x16x32_bf16 v[96:99], a[252:255], v[120:123], v[96:99]
s_waitcnt lgkmcnt(0)
v_mfma_f32_16x16x32_bf16 v[52:55], a[64:67], v[100:103], v[52:55]
v_mfma_f32_16x16x32_bf16 v[56:59], a[64:67], v[104:107], v[56:59]
ds_read_b128 v[112:115], v46 offset:1024
ds_read_b128 v[116:119], v46 offset:5120
v_mfma_f32_16x16x32_bf16 v[60:63], a[64:67], v[108:111], v[60:63]
ds_read_b128 v[120:123], v46 offset:9216
v_mfma_f32_16x16x32_bf16 v[64:67], a[68:71], v[100:103], v[64:67]
ds_read_b64_tr_b16 a[80:81], v38 offset:40960
v_mfma_f32_16x16x32_bf16 v[68:71], a[68:71], v[104:107], v[68:71]
ds_read_b64_tr_b16 a[82:83], v38 offset:45056
v_mfma_f32_16x16x32_bf16 v[72:75], a[68:71], v[108:111], v[72:75]
ds_read_b64_tr_b16 a[84:85], v39 offset:40960
ds_read_b64_tr_b16 a[86:87], v39 offset:45056
v_mfma_f32_16x16x32_bf16 v[76:79], a[72:75], v[100:103], v[76:79]
ds_read_b64_tr_b16 a[88:89], v40 offset:40960
v_mfma_f32_16x16x32_bf16 v[80:83], a[72:75], v[104:107], v[80:83]
ds_read_b64_tr_b16 a[90:91], v40 offset:45056
v_mfma_f32_16x16x32_bf16 v[84:87], a[72:75], v[108:111], v[84:87]
ds_read_b64_tr_b16 a[92:93], v41 offset:40960
v_mfma_f32_16x16x32_bf16 v[88:91], a[76:79], v[100:103], v[88:91]
ds_read_b64_tr_b16 a[94:95], v41 offset:45056
v_mfma_f32_16x16x32_bf16 v[92:95], a[76:79], v[104:107], v[92:95]
v_mfma_f32_16x16x32_bf16 v[96:99], a[76:79], v[108:111], v[96:99]
s_waitcnt lgkmcnt(0)
v_mfma_f32_16x16x32_bf16 v[52:55], a[80:83], v[112:115], v[52:55]
v_mfma_f32_16x16x32_bf16 v[56:59], a[80:83], v[116:119], v[56:59]
ds_read_b128 v[100:103], v46 offset:2048
ds_read_b128 v[104:107], v46 offset:6144
v_mfma_f32_16x16x32_bf16 v[60:63], a[80:83], v[120:123], v[60:63]
ds_read_b128 v[108:111], v46 offset:10240
v_mfma_f32_16x16x32_bf16 v[64:67], a[84:87], v[112:115], v[64:67]
ds_read_b64_tr_b16 a[64:65], v38 offset:49152
v_mfma_f32_16x16x32_bf16 v[68:71], a[84:87], v[116:119], v[68:71]
ds_read_b64_tr_b16 a[66:67], v38 offset:53248
v_mfma_f32_16x16x32_bf16 v[72:75], a[84:87], v[120:123], v[72:75]
ds_read_b64_tr_b16 a[68:69], v39 offset:49152
ds_read_b64_tr_b16 a[70:71], v39 offset:53248
v_mfma_f32_16x16x32_bf16 v[76:79], a[88:91], v[112:115], v[76:79]
ds_read_b64_tr_b16 a[72:73], v40 offset:49152
v_mfma_f32_16x16x32_bf16 v[80:83], a[88:91], v[116:119], v[80:83]
ds_read_b64_tr_b16 a[74:75], v40 offset:53248
v_mfma_f32_16x16x32_bf16 v[84:87], a[88:91], v[120:123], v[84:87]
ds_read_b64_tr_b16 a[76:77], v41 offset:49152
v_mfma_f32_16x16x32_bf16 v[88:91], a[92:95], v[112:115], v[88:91]
ds_read_b64_tr_b16 a[78:79], v41 offset:53248
v_mfma_f32_16x16x32_bf16 v[92:95], a[92:95], v[116:119], v[92:95]
v_mfma_f32_16x16x32_bf16 v[96:99], a[92:95], v[120:123], v[96:99]
s_waitcnt lgkmcnt(0)
v_mfma_f32_16x16x32_bf16 v[52:55], a[64:67], v[100:103], v[52:55]
v_mfma_f32_16x16x32_bf16 v[56:59], a[64:67], v[104:107], v[56:59]
ds_read_b128 v[112:115], v46 offset:3072
ds_read_b128 v[116:119], v46 offset:7168
v_mfma_f32_16x16x32_bf16 v[60:63], a[64:67], v[108:111], v[60:63]
ds_read_b128 v[120:123], v46 offset:11264
v_mfma_f32_16x16x32_bf16 v[64:67], a[68:71], v[100:103], v[64:67]
ds_read_b64_tr_b16 a[80:81], v38 offset:57344
v_mfma_f32_16x16x32_bf16 v[68:71], a[68:71], v[104:107], v[68:71]
ds_read_b64_tr_b16 a[82:83], v38 offset:61440
v_mfma_f32_16x16x32_bf16 v[72:75], a[68:71], v[108:111], v[72:75]
ds_read_b64_tr_b16 a[84:85], v39 offset:57344
ds_read_b64_tr_b16 a[86:87], v39 offset:61440
v_mfma_f32_16x16x32_bf16 v[76:79], a[72:75], v[100:103], v[76:79]
ds_read_b64_tr_b16 a[88:89], v40 offset:57344
v_mfma_f32_16x16x32_bf16 v[80:83], a[72:75], v[104:107], v[80:83]
ds_read_b64_tr_b16 a[90:91], v40 offset:61440
v_mfma_f32_16x16x32_bf16 v[84:87], a[72:75], v[108:111], v[84:87]
ds_read_b64_tr_b16 a[92:93], v41 offset:57344
v_mfma_f32_16x16x32_bf16 v[88:91], a[76:79], v[100:103], v[88:91]
ds_read_b64_tr_b16 a[94:95], v41 offset:61440
v_mfma_f32_16x16x32_bf16 v[92:95], a[76:79], v[104:107], v[92:95]
v_mfma_f32_16x16x32_bf16 v[96:99], a[76:79], v[108:111], v[96:99]
s_waitcnt lgkmcnt(0)
s_waitcnt vmcnt(0)
s_barrier
v_mfma_f32_16x16x32_bf16 v[52:55], a[80:83], v[112:115], v[52:55]
v_mfma_f32_16x16x32_bf16 v[56:59], a[80:83], v[116:119], v[56:59]
ds_read_b128 v[100:103], v46 offset:24576
ds_read_b128 v[104:107], v46 offset:28672
s_add_u32 s56, s71, 2
s_cmp_ge_u32 s56, 3
s_cselect_b32 s3, 3, 0
s_sub_u32 s56, s56, s3
s_add_u32 s56, s56, s64
s_add_u32 s56, s56, 1
s_and_b32 s56, s56, 3
s_and_b32 s3, s58, 12
s_add_u32 s56, s56, s3
s_lshl_b32 s56, s56, 1
s_add_u32 s56, s56, 0
s_lshl_b32 s3, s42, 5
s_add_u32 s56, s56, s3
s_mul_i32 s72, s56, 24576
s_mul_i32 s3, s40, 6144
s_add_u32 s72, s72, s3
s_add_u32 s72, s72, 469762048
s_mul_i32 s70, s40, 6144
s_add_u32 m0, s70, 0
s_add_u32 s55, s72, 0
buffer_load_dwordx4 v32, s[36:39], s55 offen sc1 lds
v_mfma_f32_16x16x32_bf16 v[60:63], a[80:83], v[120:123], v[60:63]
ds_read_b128 v[108:111], v46 offset:32768
s_add_u32 m0, s70, 1024
s_add_u32 s55, s72, 1024
buffer_load_dwordx4 v32, s[36:39], s55 offen sc1 lds
v_mfma_f32_16x16x32_bf16 v[64:67], a[84:87], v[112:115], v[64:67]
ds_read_b64_tr_b16 a[64:65], v42 offset:0
v_mfma_f32_16x16x32_bf16 v[68:71], a[84:87], v[116:119], v[68:71]
ds_read_b64_tr_b16 a[66:67], v42 offset:4096
s_add_u32 m0, s70, 2048
s_add_u32 s55, s72, 2048
buffer_load_dwordx4 v32, s[36:39], s55 offen sc1 lds
v_mfma_f32_16x16x32_bf16 v[72:75], a[84:87], v[120:123], v[72:75]
ds_read_b64_tr_b16 a[68:69], v43 offset:0
v_mfma_f32_16x16x32_bf16 v[76:79], a[88:91], v[112:115], v[76:79]
ds_read_b64_tr_b16 a[70:71], v43 offset:4096
s_add_u32 m0, s70, 3072
s_add_u32 s55, s72, 3072
buffer_load_dwordx4 v32, s[36:39], s55 offen sc1 lds
v_mfma_f32_16x16x32_bf16 v[80:83], a[88:91], v[116:119], v[80:83]
ds_read_b64_tr_b16 a[72:73], v44 offset:0
v_mfma_f32_16x16x32_bf16 v[84:87], a[88:91], v[120:123], v[84:87]
ds_read_b64_tr_b16 a[74:75], v44 offset:4096
s_add_u32 m0, s70, 4096
s_add_u32 s55, s72, 4096
buffer_load_dwordx4 v32, s[36:39], s55 offen sc1 lds
v_mfma_f32_16x16x32_bf16 v[88:91], a[92:95], v[112:115], v[88:91]
ds_read_b64_tr_b16 a[76:77], v45 offset:0
v_mfma_f32_16x16x32_bf16 v[92:95], a[92:95], v[116:119], v[92:95]
ds_read_b64_tr_b16 a[78:79], v45 offset:4096
s_add_u32 m0, s70, 5120
s_add_u32 s55, s72, 5120
buffer_load_dwordx4 v32, s[36:39], s55 offen sc1 lds
v_mfma_f32_16x16x32_bf16 v[96:99], a[92:95], v[120:123], v[96:99]
s_waitcnt lgkmcnt(0)
v_mfma_f32_16x16x32_bf16 v[52:55], a[64:67], v[100:103], v[52:55]
s_add_u32 s56, s71, 2
s_cmp_ge_u32 s56, 3
s_cselect_b32 s3, 3, 0
s_sub_u32 s56, s56, s3
s_add_u32 s56, s56, s64
s_add_u32 s56, s56, 1
s_and_b32 s56, s56, 3
s_and_b32 s3, s58, 12
s_add_u32 s56, s56, s3
s_lshl_b32 s56, s56, 1
s_add_u32 s56, s56, 1
s_lshl_b32 s69, s56, 17
s_lshl_b32 s3, s40, 15
s_add_u32 s69, s69, s3
s_lshl_b32 s3, s64, 8
s_add_u32 s69, s69, s3
s_add_u32 m0, s59, 98304
s_add_u32 s55, s69, 0
buffer_load_dwordx4 v30, s[4:7], s55 offen lds
v_mfma_f32_16x16x32_bf16 v[56:59], a[64:67], v[104:107], v[56:59]
ds_read_b128 v[112:115], v46 offset:25600
ds_read_b128 v[116:119], v46 offset:29696
v_mfma_f32_16x16x32_bf16 v[60:63], a[64:67], v[108:111], v[60:63]
ds_read_b128 v[120:123], v46 offset:33792
v_mfma_f32_16x16x32_bf16 v[64:67], a[68:71], v[100:103], v[64:67]
ds_read_b64_tr_b16 a[80:81], v42 offset:8192
s_add_u32 m0, s59, 99328
s_add_u32 s55, s69, 4096
buffer_load_dwordx4 v31, s[4:7], s55 offen lds
v_mfma_f32_16x16x32_bf16 v[68:71], a[68:71], v[104:107], v[68:71]
ds_read_b64_tr_b16 a[82:83], v42 offset:12288
v_mfma_f32_16x16x32_bf16 v[72:75], a[68:71], v[108:111], v[72:75]
ds_read_b64_tr_b16 a[84:85], v43 offset:8192
ds_read_b64_tr_b16 a[86:87], v43 offset:12288
v_mfma_f32_16x16x32_bf16 v[76:79], a[72:75], v[100:103], v[76:79]
ds_read_b64_tr_b16 a[88:89], v44 offset:8192
s_add_u32 m0, s59, 100352
s_add_u32 s55, s69, 8192
buffer_load_dwordx4 v30, s[4:7], s55 offen lds
v_mfma_f32_16x16x32_bf16 v[80:83], a[72:75], v[104:107], v[80:83]
ds_read_b64_tr_b16 a[90:91], v44 offset:12288
v_mfma_f32_16x16x32_bf16 v[84:87], a[72:75], v[108:111], v[84:87]
ds_read_b64_tr_b16 a[92:93], v45 offset:8192
v_mfma_f32_16x16x32_bf16 v[88:91], a[76:79], v[100:103], v[88:91]
ds_read_b64_tr_b16 a[94:95], v45 offset:12288
s_add_u32 m0, s59, 101376
s_add_u32 s55, s69, 12288
buffer_load_dwordx4 v31, s[4:7], s55 offen lds
v_mfma_f32_16x16x32_bf16 v[92:95], a[76:79], v[104:107], v[92:95]
v_mfma_f32_16x16x32_bf16 v[96:99], a[76:79], v[108:111], v[96:99]
s_waitcnt lgkmcnt(0)
v_mfma_f32_16x16x32_bf16 v[52:55], a[80:83], v[112:115], v[52:55]
s_add_u32 m0, s59, 102400
s_add_u32 s55, s69, 16384
buffer_load_dwordx4 v30, s[4:7], s55 offen lds
v_mfma_f32_16x16x32_bf16 v[56:59], a[80:83], v[116:119], v[56:59]
ds_read_b128 v[100:103], v46 offset:26624
ds_read_b128 v[104:107], v46 offset:30720
v_mfma_f32_16x16x32_bf16 v[60:63], a[80:83], v[120:123], v[60:63]
ds_read_b128 v[108:111], v46 offset:34816
v_mfma_f32_16x16x32_bf16 v[64:67], a[84:87], v[112:115], v[64:67]
ds_read_b64_tr_b16 a[64:65], v42 offset:16384
s_add_u32 m0, s59, 103424
s_add_u32 s55, s69, 20480
buffer_load_dwordx4 v31, s[4:7], s55 offen lds
v_mfma_f32_16x16x32_bf16 v[68:71], a[84:87], v[116:119], v[68:71]
ds_read_b64_tr_b16 a[66:67], v42 offset:20480
v_mfma_f32_16x16x32_bf16 v[72:75], a[84:87], v[120:123], v[72:75]
ds_read_b64_tr_b16 a[68:69], v43 offset:16384
ds_read_b64_tr_b16 a[70:71], v43 offset:20480
v_mfma_f32_16x16x32_bf16 v[76:79], a[88:91], v[112:115], v[76:79]
ds_read_b64_tr_b16 a[72:73], v44 offset:16384
s_add_u32 m0, s59, 104448
s_add_u32 s55, s69, 24576
buffer_load_dwordx4 v30, s[4:7], s55 offen lds
v_mfma_f32_16x16x32_bf16 v[80:83], a[88:91], v[116:119], v[80:83]
ds_read_b64_tr_b16 a[74:75], v44 offset:20480
v_mfma_f32_16x16x32_bf16 v[84:87], a[88:91], v[120:123], v[84:87]
ds_read_b64_tr_b16 a[76:77], v45 offset:16384
v_mfma_f32_16x16x32_bf16 v[88:91], a[92:95], v[112:115], v[88:91]
ds_read_b64_tr_b16 a[78:79], v45 offset:20480
s_add_u32 m0, s59, 105472
s_add_u32 s55, s69, 28672
buffer_load_dwordx4 v31, s[4:7], s55 offen lds
v_mfma_f32_16x16x32_bf16 v[92:95], a[92:95], v[116:119], v[92:95]
v_mfma_f32_16x16x32_bf16 v[96:99], a[92:95], v[120:123], v[96:99]
s_waitcnt lgkmcnt(0)
v_mfma_f32_16x16x32_bf16 v[52:55], a[64:67], v[100:103], v[52:55]
v_mfma_f32_16x16x32_bf16 v[56:59], a[64:67], v[104:107], v[56:59]
ds_read_b128 v[112:115], v46 offset:27648
ds_read_b128 v[116:119], v46 offset:31744
v_mfma_f32_16x16x32_bf16 v[60:63], a[64:67], v[108:111], v[60:63]
ds_read_b128 v[120:123], v46 offset:35840
v_mfma_f32_16x16x32_bf16 v[64:67], a[68:71], v[100:103], v[64:67]
ds_read_b64_tr_b16 a[80:81], v42 offset:24576
v_mfma_f32_16x16x32_bf16 v[68:71], a[68:71], v[104:107], v[68:71]
ds_read_b64_tr_b16 a[82:83], v42 offset:28672
v_mfma_f32_16x16x32_bf16 v[72:75], a[68:71], v[108:111], v[72:75]
ds_read_b64_tr_b16 a[84:85], v43 offset:24576
ds_read_b64_tr_b16 a[86:87], v43 offset:28672
v_mfma_f32_16x16x32_bf16 v[76:79], a[72:75], v[100:103], v[76:79]
ds_read_b64_tr_b16 a[88:89], v44 offset:24576
v_mfma_f32_16x16x32_bf16 v[80:83], a[72:75], v[104:107], v[80:83]
ds_read_b64_tr_b16 a[90:91], v44 offset:28672
v_mfma_f32_16x16x32_bf16 v[84:87], a[72:75], v[108:111], v[84:87]
ds_read_b64_tr_b16 a[92:93], v45 offset:24576
v_mfma_f32_16x16x32_bf16 v[88:91], a[76:79], v[100:103], v[88:91]
ds_read_b64_tr_b16 a[94:95], v45 offset:28672
v_mfma_f32_16x16x32_bf16 v[92:95], a[76:79], v[104:107], v[92:95]
v_mfma_f32_16x16x32_bf16 v[96:99], a[76:79], v[108:111], v[96:99]
s_waitcnt lgkmcnt(0)
s_waitcnt vmcnt(8)
s_barrier
v_mfma_f32_16x16x32_bf16 v[52:55], a[80:83], v[112:115], v[52:55]
v_mfma_f32_16x16x32_bf16 v[56:59], a[80:83], v[116:119], v[56:59]
ds_read_b128 v[100:103], v46 offset:0
ds_read_b128 v[104:107], v46 offset:4096
s_add_u32 s56, s71, 2
s_cmp_ge_u32 s56, 3
s_cselect_b32 s3, 3, 0
s_sub_u32 s56, s56, s3
s_add_u32 s56, s56, s64
s_add_u32 s56, s56, 1
s_and_b32 s56, s56, 3
s_and_b32 s3, s58, 12
s_add_u32 s56, s56, s3
s_lshl_b32 s56, s56, 1
s_add_u32 s56, s56, 1
s_lshl_b32 s3, s42, 5
s_add_u32 s56, s56, s3
s_mul_i32 s72, s56, 24576
s_mul_i32 s3, s40, 6144
s_add_u32 s72, s72, s3
s_add_u32 s72, s72, 469762048
s_mul_i32 s70, s40, 6144
s_add_u32 m0, s70, 24576
s_add_u32 s55, s72, 0
buffer_load_dwordx4 v32, s[36:39], s55 offen sc1 lds
v_mfma_f32_16x16x32_bf16 v[60:63], a[80:83], v[120:123], v[60:63]
ds_read_b128 v[108:111], v46 offset:8192
s_add_u32 m0, s70, 25600
s_add_u32 s55, s72, 1024
buffer_load_dwordx4 v32, s[36:39], s55 offen sc1 lds
v_mfma_f32_16x16x32_bf16 v[64:67], a[84:87], v[112:115], v[64:67]
ds_read_b64_tr_b16 a[64:65], v38 offset:0
v_mfma_f32_16x16x32_bf16 v[68:71], a[84:87], v[116:119], v[68:71]
ds_read_b64_tr_b16 a[66:67], v38 offset:4096
s_add_u32 m0, s70, 26624
s_add_u32 s55, s72, 2048
buffer_load_dwordx4 v32, s[36:39], s55 offen sc1 lds
v_mfma_f32_16x16x32_bf16 v[72:75], a[84:87], v[120:123], v[72:75]
ds_read_b64_tr_b16 a[68:69], v39 offset:0
v_mfma_f32_16x16x32_bf16 v[76:79], a[88:91], v[112:115], v[76:79]
ds_read_b64_tr_b16 a[70:71], v39 offset:4096
s_add_u32 m0, s70, 27648
s_add_u32 s55, s72, 3072
buffer_load_dwordx4 v32, s[36:39], s55 offen sc1 lds
v_mfma_f32_16x16x32_bf16 v[80:83], a[88:91], v[116:119], v[80:83]
ds_read_b64_tr_b16 a[72:73], v40 offset:0
v_mfma_f32_16x16x32_bf16 v[84:87], a[88:91], v[120:123], v[84:87]
ds_read_b64_tr_b16 a[74:75], v40 offset:4096
s_add_u32 m0, s70, 28672
s_add_u32 s55, s72, 4096
buffer_load_dwordx4 v32, s[36:39], s55 offen sc1 lds
v_mfma_f32_16x16x32_bf16 v[88:91], a[92:95], v[112:115], v[88:91]
ds_read_b64_tr_b16 a[76:77], v41 offset:0
v_mfma_f32_16x16x32_bf16 v[92:95], a[92:95], v[116:119], v[92:95]
ds_read_b64_tr_b16 a[78:79], v41 offset:4096
s_add_u32 m0, s70, 29696
s_add_u32 s55, s72, 5120
buffer_load_dwordx4 v32, s[36:39], s55 offen sc1 lds
v_mfma_f32_16x16x32_bf16 v[96:99], a[92:95], v[120:123], v[96:99]
s_waitcnt lgkmcnt(0)
v_mfma_f32_16x16x32_bf16 v[52:55], a[64:67], v[100:103], v[52:55]
v_mfma_f32_16x16x32_bf16 v[56:59], a[64:67], v[104:107], v[56:59]
ds_read_b128 v[112:115], v46 offset:1024
ds_read_b128 v[116:119], v46 offset:5120
v_mfma_f32_16x16x32_bf16 v[60:63], a[64:67], v[108:111], v[60:63]
ds_read_b128 v[120:123], v46 offset:9216
v_mfma_f32_16x16x32_bf16 v[64:67], a[68:71], v[100:103], v[64:67]
ds_read_b64_tr_b16 a[80:81], v38 offset:8192
v_mfma_f32_16x16x32_bf16 v[68:71], a[68:71], v[104:107], v[68:71]
ds_read_b64_tr_b16 a[82:83], v38 offset:12288
v_mfma_f32_16x16x32_bf16 v[72:75], a[68:71], v[108:111], v[72:75]
ds_read_b64_tr_b16 a[84:85], v39 offset:8192
ds_read_b64_tr_b16 a[86:87], v39 offset:12288
v_mfma_f32_16x16x32_bf16 v[76:79], a[72:75], v[100:103], v[76:79]
ds_read_b64_tr_b16 a[88:89], v40 offset:8192
v_mfma_f32_16x16x32_bf16 v[80:83], a[72:75], v[104:107], v[80:83]
ds_read_b64_tr_b16 a[90:91], v40 offset:12288
v_mfma_f32_16x16x32_bf16 v[84:87], a[72:75], v[108:111], v[84:87]
ds_read_b64_tr_b16 a[92:93], v41 offset:8192
v_mfma_f32_16x16x32_bf16 v[88:91], a[76:79], v[100:103], v[88:91]
ds_read_b64_tr_b16 a[94:95], v41 offset:12288
v_mfma_f32_16x16x32_bf16 v[92:95], a[76:79], v[104:107], v[92:95]
v_mfma_f32_16x16x32_bf16 v[96:99], a[76:79], v[108:111], v[96:99]
s_waitcnt lgkmcnt(0)
v_mfma_f32_16x16x32_bf16 v[52:55], a[80:83], v[112:115], v[52:55]
v_mfma_f32_16x16x32_bf16 v[56:59], a[80:83], v[116:119], v[56:59]
ds_read_b128 v[100:103], v46 offset:2048
ds_read_b128 v[104:107], v46 offset:6144
v_mfma_f32_16x16x32_bf16 v[60:63], a[80:83], v[120:123], v[60:63]
ds_read_b128 v[108:111], v46 offset:10240
v_mfma_f32_16x16x32_bf16 v[64:67], a[84:87], v[112:115], v[64:67]
ds_read_b64_tr_b16 a[64:65], v38 offset:16384
v_mfma_f32_16x16x32_bf16 v[68:71], a[84:87], v[116:119], v[68:71]
ds_read_b64_tr_b16 a[66:67], v38 offset:20480
v_mfma_f32_16x16x32_bf16 v[72:75], a[84:87], v[120:123], v[72:75]
ds_read_b64_tr_b16 a[68:69], v39 offset:16384
ds_read_b64_tr_b16 a[70:71], v39 offset:20480
v_mfma_f32_16x16x32_bf16 v[76:79], a[88:91], v[112:115], v[76:79]
ds_read_b64_tr_b16 a[72:73], v40 offset:16384
v_mfma_f32_16x16x32_bf16 v[80:83], a[88:91], v[116:119], v[80:83]
ds_read_b64_tr_b16 a[74:75], v40 offset:20480
v_mfma_f32_16x16x32_bf16 v[84:87], a[88:91], v[120:123], v[84:87]
ds_read_b64_tr_b16 a[76:77], v41 offset:16384
v_mfma_f32_16x16x32_bf16 v[88:91], a[92:95], v[112:115], v[88:91]
ds_read_b64_tr_b16 a[78:79], v41 offset:20480
v_mfma_f32_16x16x32_bf16 v[92:95], a[92:95], v[116:119], v[92:95]
v_mfma_f32_16x16x32_bf16 v[96:99], a[92:95], v[120:123], v[96:99]
s_waitcnt lgkmcnt(0)
v_mfma_f32_16x16x32_bf16 v[52:55], a[64:67], v[100:103], v[52:55]
v_mfma_f32_16x16x32_bf16 v[56:59], a[64:67], v[104:107], v[56:59]
ds_read_b128 v[112:115], v46 offset:3072
ds_read_b128 v[116:119], v46 offset:7168
v_mfma_f32_16x16x32_bf16 v[60:63], a[64:67], v[108:111], v[60:63]
ds_read_b128 v[120:123], v46 offset:11264
v_mfma_f32_16x16x32_bf16 v[64:67], a[68:71], v[100:103], v[64:67]
ds_read_b64_tr_b16 a[80:81], v38 offset:24576
v_mfma_f32_16x16x32_bf16 v[68:71], a[68:71], v[104:107], v[68:71]
ds_read_b64_tr_b16 a[82:83], v38 offset:28672
v_mfma_f32_16x16x32_bf16 v[72:75], a[68:71], v[108:111], v[72:75]
ds_read_b64_tr_b16 a[84:85], v39 offset:24576
ds_read_b64_tr_b16 a[86:87], v39 offset:28672
v_mfma_f32_16x16x32_bf16 v[76:79], a[72:75], v[100:103], v[76:79]
ds_read_b64_tr_b16 a[88:89], v40 offset:24576
v_mfma_f32_16x16x32_bf16 v[80:83], a[72:75], v[104:107], v[80:83]
ds_read_b64_tr_b16 a[90:91], v40 offset:28672
v_mfma_f32_16x16x32_bf16 v[84:87], a[72:75], v[108:111], v[84:87]
ds_read_b64_tr_b16 a[92:93], v41 offset:24576
v_mfma_f32_16x16x32_bf16 v[88:91], a[76:79], v[100:103], v[88:91]
ds_read_b64_tr_b16 a[94:95], v41 offset:28672
v_mfma_f32_16x16x32_bf16 v[92:95], a[76:79], v[104:107], v[92:95]
v_mfma_f32_16x16x32_bf16 v[96:99], a[76:79], v[108:111], v[96:99]
s_waitcnt lgkmcnt(0)
s_waitcnt vmcnt(0)
s_barrier
v_mfma_f32_16x16x32_bf16 v[52:55], a[80:83], v[112:115], v[52:55]
v_mfma_f32_16x16x32_bf16 v[56:59], a[80:83], v[116:119], v[56:59]
ds_read_b128 v[100:103], v46 offset:24576
ds_read_b128 v[104:107], v46 offset:28672
v_mfma_f32_16x16x32_bf16 v[60:63], a[80:83], v[120:123], v[60:63]
ds_read_b128 v[108:111], v46 offset:32768
v_mfma_f32_16x16x32_bf16 v[64:67], a[84:87], v[112:115], v[64:67]
ds_read_b64_tr_b16 a[64:65], v38 offset:32768
v_mfma_f32_16x16x32_bf16 v[68:71], a[84:87], v[116:119], v[68:71]
ds_read_b64_tr_b16 a[66:67], v38 offset:36864
v_mfma_f32_16x16x32_bf16 v[72:75], a[84:87], v[120:123], v[72:75]
ds_read_b64_tr_b16 a[68:69], v39 offset:32768
v_mfma_f32_16x16x32_bf16 v[76:79], a[88:91], v[112:115], v[76:79]
ds_read_b64_tr_b16 a[70:71], v39 offset:36864
v_mfma_f32_16x16x32_bf16 v[80:83], a[88:91], v[116:119], v[80:83]
ds_read_b64_tr_b16 a[72:73], v40 offset:32768
v_mfma_f32_16x16x32_bf16 v[84:87], a[88:91], v[120:123], v[84:87]
ds_read_b64_tr_b16 a[74:75], v40 offset:36864
v_mfma_f32_16x16x32_bf16 v[88:91], a[92:95], v[112:115], v[88:91]
ds_read_b64_tr_b16 a[76:77], v41 offset:32768
v_mfma_f32_16x16x32_bf16 v[92:95], a[92:95], v[116:119], v[92:95]
ds_read_b64_tr_b16 a[78:79], v41 offset:36864
v_mfma_f32_16x16x32_bf16 v[96:99], a[92:95], v[120:123], v[96:99]
s_waitcnt lgkmcnt(0)
v_mfma_f32_16x16x32_bf16 v[52:55], a[64:67], v[100:103], v[52:55]
v_mfma_f32_16x16x32_bf16 v[56:59], a[64:67], v[104:107], v[56:59]
ds_read_b128 v[112:115], v46 offset:25600
ds_read_b128 v[116:119], v46 offset:29696
v_mfma_f32_16x16x32_bf16 v[60:63], a[64:67], v[108:111], v[60:63]
ds_read_b128 v[120:123], v46 offset:33792
v_mfma_f32_16x16x32_bf16 v[64:67], a[68:71], v[100:103], v[64:67]
ds_read_b64_tr_b16 a[80:81], v38 offset:40960
v_mfma_f32_16x16x32_bf16 v[68:71], a[68:71], v[104:107], v[68:71]
ds_read_b64_tr_b16 a[82:83], v38 offset:45056
v_mfma_f32_16x16x32_bf16 v[72:75], a[68:71], v[108:111], v[72:75]
ds_read_b64_tr_b16 a[84:85], v39 offset:40960
ds_read_b64_tr_b16 a[86:87], v39 offset:45056
v_mfma_f32_16x16x32_bf16 v[76:79], a[72:75], v[100:103], v[76:79]
ds_read_b64_tr_b16 a[88:89], v40 offset:40960
v_mfma_f32_16x16x32_bf16 v[80:83], a[72:75], v[104:107], v[80:83]
ds_read_b64_tr_b16 a[90:91], v40 offset:45056
v_mfma_f32_16x16x32_bf16 v[84:87], a[72:75], v[108:111], v[84:87]
ds_read_b64_tr_b16 a[92:93], v41 offset:40960
v_mfma_f32_16x16x32_bf16 v[88:91], a[76:79], v[100:103], v[88:91]
ds_read_b64_tr_b16 a[94:95], v41 offset:45056
v_mfma_f32_16x16x32_bf16 v[92:95], a[76:79], v[104:107], v[92:95]
v_mfma_f32_16x16x32_bf16 v[96:99], a[76:79], v[108:111], v[96:99]
s_waitcnt lgkmcnt(0)
v_mfma_f32_16x16x32_bf16 v[52:55], a[80:83], v[112:115], v[52:55]
v_mfma_f32_16x16x32_bf16 v[56:59], a[80:83], v[116:119], v[56:59]
ds_read_b128 v[100:103], v46 offset:26624
ds_read_b128 v[104:107], v46 offset:30720
v_mfma_f32_16x16x32_bf16 v[60:63], a[80:83], v[120:123], v[60:63]
ds_read_b128 v[108:111], v46 offset:34816
v_mfma_f32_16x16x32_bf16 v[64:67], a[84:87], v[112:115], v[64:67]
ds_read_b64_tr_b16 a[64:65], v38 offset:49152
v_mfma_f32_16x16x32_bf16 v[68:71], a[84:87], v[116:119], v[68:71]
ds_read_b64_tr_b16 a[66:67], v38 offset:53248
v_mfma_f32_16x16x32_bf16 v[72:75], a[84:87], v[120:123], v[72:75]
ds_read_b64_tr_b16 a[68:69], v39 offset:49152
ds_read_b64_tr_b16 a[70:71], v39 offset:53248
v_mfma_f32_16x16x32_bf16 v[76:79], a[88:91], v[112:115], v[76:79]
ds_read_b64_tr_b16 a[72:73], v40 offset:49152
v_mfma_f32_16x16x32_bf16 v[80:83], a[88:91], v[116:119], v[80:83]
ds_read_b64_tr_b16 a[74:75], v40 offset:53248
v_mfma_f32_16x16x32_bf16 v[84:87], a[88:91], v[120:123], v[84:87]
ds_read_b64_tr_b16 a[76:77], v41 offset:49152
v_mfma_f32_16x16x32_bf16 v[88:91], a[92:95], v[112:115], v[88:91]
ds_read_b64_tr_b16 a[78:79], v41 offset:53248
v_mfma_f32_16x16x32_bf16 v[92:95], a[92:95], v[116:119], v[92:95]
v_mfma_f32_16x16x32_bf16 v[96:99], a[92:95], v[120:123], v[96:99]
s_waitcnt lgkmcnt(0)
v_mfma_f32_16x16x32_bf16 v[52:55], a[64:67], v[100:103], v[52:55]
v_mfma_f32_16x16x32_bf16 v[56:59], a[64:67], v[104:107], v[56:59]
ds_read_b128 v[112:115], v46 offset:27648
ds_read_b128 v[116:119], v46 offset:31744
v_mfma_f32_16x16x32_bf16 v[60:63], a[64:67], v[108:111], v[60:63]
ds_read_b128 v[120:123], v46 offset:35840
v_mfma_f32_16x16x32_bf16 v[64:67], a[68:71], v[100:103], v[64:67]
ds_read_b64_tr_b16 a[80:81], v38 offset:57344
v_mfma_f32_16x16x32_bf16 v[68:71], a[68:71], v[104:107], v[68:71]
ds_read_b64_tr_b16 a[82:83], v38 offset:61440
v_mfma_f32_16x16x32_bf16 v[72:75], a[68:71], v[108:111], v[72:75]
ds_read_b64_tr_b16 a[84:85], v39 offset:57344
ds_read_b64_tr_b16 a[86:87], v39 offset:61440
v_mfma_f32_16x16x32_bf16 v[76:79], a[72:75], v[100:103], v[76:79]
ds_read_b64_tr_b16 a[88:89], v40 offset:57344
v_mfma_f32_16x16x32_bf16 v[80:83], a[72:75], v[104:107], v[80:83]
ds_read_b64_tr_b16 a[90:91], v40 offset:61440
v_mfma_f32_16x16x32_bf16 v[84:87], a[72:75], v[108:111], v[84:87]
ds_read_b64_tr_b16 a[92:93], v41 offset:57344
v_mfma_f32_16x16x32_bf16 v[88:91], a[76:79], v[100:103], v[88:91]
ds_read_b64_tr_b16 a[94:95], v41 offset:61440
v_mfma_f32_16x16x32_bf16 v[92:95], a[76:79], v[104:107], v[92:95]
v_mfma_f32_16x16x32_bf16 v[96:99], a[76:79], v[108:111], v[96:99]
s_waitcnt lgkmcnt(0)
v_mfma_f32_16x16x32_bf16 v[52:55], a[80:83], v[112:115], v[52:55]
v_mfma_f32_16x16x32_bf16 v[56:59], a[80:83], v[116:119], v[56:59]
v_mfma_f32_16x16x32_bf16 v[60:63], a[80:83], v[120:123], v[60:63]
v_mfma_f32_16x16x32_bf16 v[64:67], a[84:87], v[112:115], v[64:67]
v_mfma_f32_16x16x32_bf16 v[68:71], a[84:87], v[116:119], v[68:71]
v_mfma_f32_16x16x32_bf16 v[72:75], a[84:87], v[120:123], v[72:75]
v_mfma_f32_16x16x32_bf16 v[76:79], a[88:91], v[112:115], v[76:79]
v_mfma_f32_16x16x32_bf16 v[80:83], a[88:91], v[116:119], v[80:83]
v_mfma_f32_16x16x32_bf16 v[84:87], a[88:91], v[120:123], v[84:87]
v_mfma_f32_16x16x32_bf16 v[88:91], a[92:95], v[112:115], v[88:91]
v_mfma_f32_16x16x32_bf16 v[92:95], a[92:95], v[116:119], v[92:95]
v_mfma_f32_16x16x32_bf16 v[96:99], a[92:95], v[120:123], v[96:99]
s_lshl_b32 s65, s42, 2
s_add_u32 s65, s65, s64
s_lshl_b32 s65, s65, 2
s_lshr_b32 s3, s58, 2
s_add_u32 s65, s65, s3
s_mul_i32 s65, s65, 24
s_mul_i32 s3, s51, 12
s_add_u32 s65, s65, s3
s_mul_i32 s3, s43, 3
s_add_u32 s65, s65, s3
s_lshl_b32 s65, s65, 10
s_add_u32 s65, s65, 486539264
v_cvt_pk_bf16_f32 v100, v52, v53
v_cvt_pk_bf16_f32 v101, v54, v55
v_cvt_pk_bf16_f32 v102, v64, v65
v_cvt_pk_bf16_f32 v103, v66, v67
s_add_u32 s55, s65, 0
buffer_store_dwordx4 v[100:103], v32, s[36:39], s55 offen sc1
v_cvt_pk_bf16_f32 v104, v56, v57
v_cvt_pk_bf16_f32 v105, v58, v59
v_cvt_pk_bf16_f32 v106, v68, v69
v_cvt_pk_bf16_f32 v107, v70, v71
s_add_u32 s55, s65, 1024
buffer_store_dwordx4 v[104:107], v32, s[36:39], s55 offen sc1
v_cvt_pk_bf16_f32 v108, v60, v61
v_cvt_pk_bf16_f32 v109, v62, v63
v_cvt_pk_bf16_f32 v110, v72, v73
v_cvt_pk_bf16_f32 v111, v74, v75
s_add_u32 s55, s65, 2048
buffer_store_dwordx4 v[108:111], v32, s[36:39], s55 offen sc1
v_cvt_pk_bf16_f32 v112, v76, v77
v_cvt_pk_bf16_f32 v113, v78, v79
v_cvt_pk_bf16_f32 v114, v88, v89
v_cvt_pk_bf16_f32 v115, v90, v91
s_add_u32 s55, s65, 6144
buffer_store_dwordx4 v[112:115], v32, s[36:39], s55 offen sc1
v_cvt_pk_bf16_f32 v116, v80, v81
v_cvt_pk_bf16_f32 v117, v82, v83
v_cvt_pk_bf16_f32 v118, v92, v93
v_cvt_pk_bf16_f32 v119, v94, v95
s_add_u32 s55, s65, 7168
buffer_store_dwordx4 v[116:119], v32, s[36:39], s55 offen sc1
v_cvt_pk_bf16_f32 v120, v84, v85
v_cvt_pk_bf16_f32 v121, v86, v87
v_cvt_pk_bf16_f32 v122, v96, v97
v_cvt_pk_bf16_f32 v123, v98, v99
s_add_u32 s55, s65, 8192
buffer_store_dwordx4 v[120:123], v32, s[36:39], s55 offen sc1
v_and_b32 v47, 3, v1
v_lshlrev_b32 v47, 3, v47
s_cmp_eq_u32 s40, 0
s_cbranch_scc0 L_ep_B
s_lshl_b32 s55, s42, 2
s_add_u32 s55, s55, s64
s_lshl_b32 s55, s55, 7
s_add_u32 s55, s55, 494931968
buffer_load_dwordx2 v[50:51], v47, s[36:39], s55 offen sc1
L_ep_B:
s_waitcnt vmcnt(0)
s_barrier
s_cmp_eq_u32 s40, 0
s_cbranch_scc0 L_pskip_B
s_mov_b32 s49, 0
L_nonce_B:
s_add_u32 s49, s49, 1
s_cmp_gt_u32 s49, 0x40000
s_cbranch_scc1 L_pskip_B
v_or_b32 v4, v2, v3
v_cmp_eq_u32 vcc, 0, v4
s_cbranch_vccz L_nok_B
s_sleep 2
v_mov_b32 v4, 0
buffer_load_dwordx2 v[2:3], v4, s[12:15], 0 offen sc1
s_waitcnt vmcnt(0)
s_branch L_nonce_B
L_nok_B:
s_lshl_b32 s55, s42, 2
s_add_u32 s55, s55, s64
s_lshl_b32 s55, s55, 7
s_lshr_b32 s3, s58, 2
s_lshl_b32 s3, s3, 3
s_add_u32 s55, s55, s3
s_add_u32 s55, s55, 494931968
v_mov_b32 v4, 0
buffer_store_dwordx2 v[2:3], v4, s[36:39], s55 offen sc1
L_pskip_B:
s_cmp_eq_u32 s40, 0
s_cbranch_scc0 L_skip_B
s_lshr_b32 s3, s58, 2
s_lshl_b32 s3, s3, 3
v_xor_b32 v50, v50, v2
v_xor_b32 v51, v51, v3
v_or_b32 v50, v50, v51
v_cmp_ne_u32 vcc, s3, v47
s_nop 1
v_cndmask_b32 v50, 0, v50, vcc
v_cmp_ne_u32 vcc, 0, v50
s_cbranch_vccz L_skip_B
s_mov_b32 s49, 0
s_lshl_b32 s55, s42, 2
s_add_u32 s55, s55, s64
s_lshl_b32 s55, s55, 7
s_add_u32 s55, s55, 494931968
v_and_b32 v5, 3, v1
v_lshlrev_b32 v5, 3, v5
buffer_load_dwordx2 v[6:7], v5, s[36:39], s55 offen sc1
L_poll_B:
s_add_u32 s49, s49, 1
s_cmp_gt_u32 s49, 0x40000
s_cbranch_scc1 L_pdone_B
buffer_load_dwordx2 v[48:49], v5, s[36:39], s55 offen sc1
s_waitcnt vmcnt(1)
v_xor_b32 v6, v6, v2
v_xor_b32 v7, v7, v3
v_or_b32 v6, v6, v7
v_cmp_ne_u32 vcc, 0, v6
s_cbranch_vccz L_pdone_B
buffer_load_dwordx2 v[6:7], v5, s[36:39], s55 offen sc1
s_waitcnt vmcnt(1)
v_xor_b32 v48, v48, v2
v_xor_b32 v49, v49, v3
v_or_b32 v48, v48, v49
v_cmp_ne_u32 vcc, 0, v48
s_cbranch_vccnz L_poll_B
L_pdone_B:
s_waitcnt vmcnt(0)
L_skip_B:
s_barrier
s_lshl_b32 s65, s42, 2
s_add_u32 s65, s65, s64
s_mul_i32 s65, s65, 96
s_lshr_b32 s3, s58, 2
s_mul_i32 s3, s3, 6
s_add_u32 s65, s65, s3
s_add_u32 s65, s65, s40
s_lshl_b32 s65, s65, 10
s_add_u32 s65, s65, 486539264
v_and_b32 v5, 15, v1
v_lshrrev_b32 v6, 4, v1
v_lshlrev_b32 v6, 3, v6
v_lshl_add_u32 v5, v5, 10, v6
s_mul_i32 s72, s42, 98304
s_lshl_b32 s3, s64, 8
s_add_u32 s72, s72, s3
s_lshr_b32 s3, s58, 2
s_lshl_b32 s3, s3, 6
s_add_u32 s72, s72, s3
s_lshl_b32 s3, s40, 14
s_add_u32 s72, s72, s3
s_cmp_lt_u32 s40, 2
s_cbranch_scc1 L_fin2
s_add_u32 s55, s65, 0
buffer_load_dwordx4 v[64:67], v32, s[36:39], s55 offen sc1
s_add_u32 s55, s65, 24576
buffer_load_dwordx4 v[68:71], v32, s[36:39], s55 offen sc1
s_add_u32 s55, s65, 49152
buffer_load_dwordx4 v[72:75], v32, s[36:39], s55 offen sc1
s_add_u32 s55, s65, 73728
buffer_load_dwordx4 v[76:79], v32, s[36:39], s55 offen sc1
s_waitcnt vmcnt(3)
v_lshlrev_b32 v160, 16, v64
v_and_b32 v161, 0xffff0000, v64
v_lshlrev_b32 v162, 16, v65
v_and_b32 v163, 0xffff0000, v65
v_lshlrev_b32 v164, 16, v66
v_and_b32 v165, 0xffff0000, v66
v_lshlrev_b32 v166, 16, v67
v_and_b32 v167, 0xffff0000, v67
s_waitcnt vmcnt(2)
v_lshlrev_b32 v37, 16, v68
v_and_b32 v38, 0xffff0000, v68
v_add_f32 v160, v160, v37
v_add_f32 v161, v161, v38
v_lshlrev_b32 v37, 16, v69
v_and_b32 v38, 0xffff0000, v69
v_add_f32 v162, v162, v37
v_add_f32 v163, v163, v38
v_lshlrev_b32 v37, 16, v70
v_and_b32 v38, 0xffff0000, v70
v_add_f32 v164, v164, v37
v_add_f32 v165, v165, v38
v_lshlrev_b32 v37, 16, v71
v_and_b32 v38, 0xffff0000, v71
v_add_f32 v166, v166, v37
v_add_f32 v167, v167, v38
s_waitcnt vmcnt(1)
v_lshlrev_b32 v37, 16, v72
v_and_b32 v38, 0xffff0000, v72
v_add_f32 v160, v160, v37
v_add_f32 v161, v161, v38
v_lshlrev_b32 v37, 16, v73
v_and_b32 v38, 0xffff0000, v73
v_add_f32 v162, v162, v37
v_add_f32 v163, v163, v38
v_lshlrev_b32 v37, 16, v74
v_and_b32 v38, 0xffff0000, v74
v_add_f32 v164, v164, v37
v_add_f32 v165, v165, v38
v_lshlrev_b32 v37, 16, v75
v_and_b32 v38, 0xffff0000, v75
v_add_f32 v166, v166, v37
v_add_f32 v167, v167, v38
s_waitcnt vmcnt(0)
v_lshlrev_b32 v37, 16, v76
v_and_b32 v38, 0xffff0000, v76
v_add_f32 v160, v160, v37
v_add_f32 v161, v161, v38
v_lshlrev_b32 v37, 16, v77
v_and_b32 v38, 0xffff0000, v77
v_add_f32 v162, v162, v37
v_add_f32 v163, v163, v38
v_lshlrev_b32 v37, 16, v78
v_and_b32 v38, 0xffff0000, v78
v_add_f32 v164, v164, v37
v_add_f32 v165, v165, v38
v_lshlrev_b32 v37, 16, v79
v_and_b32 v38, 0xffff0000, v79
v_add_f32 v166, v166, v37
v_add_f32 v167, v167, v38
v_cvt_pk_bf16_f32 v160, v160, v161
v_cvt_pk_bf16_f32 v161, v162, v163
s_add_u32 s55, s72, 0
buffer_store_dwordx2 v[160:161], v5, s[8:11], s55 offen
v_cvt_pk_bf16_f32 v164, v164, v165
v_cvt_pk_bf16_f32 v165, v166, v167
s_add_u32 s55, s72, 32
buffer_store_dwordx2 v[164:165], v5, s[8:11], s55 offen
s_branch L_fin_done
L_fin2:
s_add_u32 s55, s65, 0
buffer_load_dwordx4 v[64:67], v32, s[36:39], s55 offen sc1
s_add_u32 s55, s65, 24576
buffer_load_dwordx4 v[68:71], v32, s[36:39], s55 offen sc1
s_add_u32 s55, s65, 49152
buffer_load_dwordx4 v[72:75], v32, s[36:39], s55 offen sc1
s_add_u32 s55, s65, 73728
buffer_load_dwordx4 v[76:79], v32, s[36:39], s55 offen sc1
s_add_u32 s55, s65, 4096
buffer_load_dwordx4 v[80:83], v32, s[36:39], s55 offen sc1
s_add_u32 s55, s65, 28672
buffer_load_dwordx4 v[84:87], v32, s[36:39], s55 offen sc1
s_add_u32 s55, s65, 53248
buffer_load_dwordx4 v[88:91], v32, s[36:39], s55 offen sc1
s_add_u32 s55, s65, 77824
buffer_load_dwordx4 v[92:95], v32, s[36:39], s55 offen sc1
s_waitcnt vmcnt(7)
v_lshlrev_b32 v160, 16, v64
v_and_b32 v161, 0xffff0000, v64
v_lshlrev_b32 v162, 16, v65
v_and_b32 v163, 0xffff0000, v65
v_lshlrev_b32 v164, 16, v66
v_and_b32 v165, 0xffff0000, v66
v_lshlrev_b32 v166, 16, v67
v_and_b32 v167, 0xffff0000, v67
s_waitcnt vmcnt(6)
v_lshlrev_b32 v37, 16, v68
v_and_b32 v38, 0xffff0000, v68
v_add_f32 v160, v160, v37
v_add_f32 v161, v161, v38
v_lshlrev_b32 v37, 16, v69
v_and_b32 v38, 0xffff0000, v69
v_add_f32 v162, v162, v37
v_add_f32 v163, v163, v38
v_lshlrev_b32 v37, 16, v70
v_and_b32 v38, 0xffff0000, v70
v_add_f32 v164, v164, v37
v_add_f32 v165, v165, v38
v_lshlrev_b32 v37, 16, v71
v_and_b32 v38, 0xffff0000, v71
v_add_f32 v166, v166, v37
v_add_f32 v167, v167, v38
s_waitcnt vmcnt(5)
v_lshlrev_b32 v37, 16, v72
v_and_b32 v38, 0xffff0000, v72
v_add_f32 v160, v160, v37
v_add_f32 v161, v161, v38
v_lshlrev_b32 v37, 16, v73
v_and_b32 v38, 0xffff0000, v73
v_add_f32 v162, v162, v37
v_add_f32 v163, v163, v38
v_lshlrev_b32 v37, 16, v74
v_and_b32 v38, 0xffff0000, v74
v_add_f32 v164, v164, v37
v_add_f32 v165, v165, v38
v_lshlrev_b32 v37, 16, v75
v_and_b32 v38, 0xffff0000, v75
v_add_f32 v166, v166, v37
v_add_f32 v167, v167, v38
s_waitcnt vmcnt(4)
v_lshlrev_b32 v37, 16, v76
v_and_b32 v38, 0xffff0000, v76
v_add_f32 v160, v160, v37
v_add_f32 v161, v161, v38
v_lshlrev_b32 v37, 16, v77
v_and_b32 v38, 0xffff0000, v77
v_add_f32 v162, v162, v37
v_add_f32 v163, v163, v38
v_lshlrev_b32 v37, 16, v78
v_and_b32 v38, 0xffff0000, v78
v_add_f32 v164, v164, v37
v_add_f32 v165, v165, v38
v_lshlrev_b32 v37, 16, v79
v_and_b32 v38, 0xffff0000, v79
v_add_f32 v166, v166, v37
v_add_f32 v167, v167, v38
v_cvt_pk_bf16_f32 v160, v160, v161
v_cvt_pk_bf16_f32 v161, v162, v163
s_add_u32 s55, s72, 0
buffer_store_dwordx2 v[160:161], v5, s[8:11], s55 offen
v_cvt_pk_bf16_f32 v164, v164, v165
v_cvt_pk_bf16_f32 v165, v166, v167
s_add_u32 s55, s72, 32
buffer_store_dwordx2 v[164:165], v5, s[8:11], s55 offen
s_waitcnt vmcnt(3)
v_lshlrev_b32 v168, 16, v80
v_and_b32 v169, 0xffff0000, v80
v_lshlrev_b32 v170, 16, v81
v_and_b32 v171, 0xffff0000, v81
v_lshlrev_b32 v172, 16, v82
v_and_b32 v173, 0xffff0000, v82
v_lshlrev_b32 v174, 16, v83
v_and_b32 v175, 0xffff0000, v83
s_waitcnt vmcnt(2)
v_lshlrev_b32 v37, 16, v84
v_and_b32 v38, 0xffff0000, v84
v_add_f32 v168, v168, v37
v_add_f32 v169, v169, v38
v_lshlrev_b32 v37, 16, v85
v_and_b32 v38, 0xffff0000, v85
v_add_f32 v170, v170, v37
v_add_f32 v171, v171, v38
v_lshlrev_b32 v37, 16, v86
v_and_b32 v38, 0xffff0000, v86
v_add_f32 v172, v172, v37
v_add_f32 v173, v173, v38
v_lshlrev_b32 v37, 16, v87
v_and_b32 v38, 0xffff0000, v87
v_add_f32 v174, v174, v37
v_add_f32 v175, v175, v38
s_waitcnt vmcnt(1)
v_lshlrev_b32 v37, 16, v88
v_and_b32 v38, 0xffff0000, v88
v_add_f32 v168, v168, v37
v_add_f32 v169, v169, v38
v_lshlrev_b32 v37, 16, v89
v_and_b32 v38, 0xffff0000, v89
v_add_f32 v170, v170, v37
v_add_f32 v171, v171, v38
v_lshlrev_b32 v37, 16, v90
v_and_b32 v38, 0xffff0000, v90
v_add_f32 v172, v172, v37
v_add_f32 v173, v173, v38
v_lshlrev_b32 v37, 16, v91
v_and_b32 v38, 0xffff0000, v91
v_add_f32 v174, v174, v37
v_add_f32 v175, v175, v38
s_waitcnt vmcnt(0)
v_lshlrev_b32 v37, 16, v92
v_and_b32 v38, 0xffff0000, v92
v_add_f32 v168, v168, v37
v_add_f32 v169, v169, v38
v_lshlrev_b32 v37, 16, v93
v_and_b32 v38, 0xffff0000, v93
v_add_f32 v170, v170, v37
v_add_f32 v171, v171, v38
v_lshlrev_b32 v37, 16, v94
v_and_b32 v38, 0xffff0000, v94
v_add_f32 v172, v172, v37
v_add_f32 v173, v173, v38
v_lshlrev_b32 v37, 16, v95
v_and_b32 v38, 0xffff0000, v95
v_add_f32 v174, v174, v37
v_add_f32 v175, v175, v38
v_cvt_pk_bf16_f32 v168, v168, v169
v_cvt_pk_bf16_f32 v169, v170, v171
s_add_u32 s55, s72, 65536
buffer_store_dwordx2 v[168:169], v5, s[8:11], s55 offen
v_cvt_pk_bf16_f32 v172, v172, v173
v_cvt_pk_bf16_f32 v173, v174, v175
s_add_u32 s55, s72, 65568
buffer_store_dwordx2 v[172:173], v5, s[8:11], s55 offen
L_fin_done:
s_endpgm
L_rare_f0:
v_max3_f32 v41, v52, v53, v54
v_max3_f32 v42, v55, v64, v65
v_max3_f32 v41, v41, v66, v67
v_max3_f32 v41, v41, v42, 0
v_mov_b32 v42, v41
s_nop 1
v_permlane16_swap_b32 v42, v41
v_max_f32 v41, v41, v42
v_mov_b32 v42, v41
s_nop 1
v_permlane32_swap_b32 v42, v41
v_max_f32 v41, v41, v42
v_add_f32 v34, v34, v41
v_sub_f32 v52, v52, v41
v_sub_f32 v64, v64, v41
v_sub_f32 v53, v53, v41
v_sub_f32 v65, v65, v41
v_sub_f32 v54, v54, v41
v_sub_f32 v66, v66, v41
v_sub_f32 v55, v55, v41
v_sub_f32 v67, v67, v41
v_sub_f32 v42, 0, v41
v_exp_f32 v42, v42
s_nop 0
v_mul_f32 v152, v42, v152
v_mul_f32 v153, v42, v153
v_mul_f32 v154, v42, v154
v_mul_f32 v155, v42, v155
v_mul_f32 v164, v42, v164
v_mul_f32 v165, v42, v165
v_mul_f32 v166, v42, v166
v_mul_f32 v167, v42, v167
v_mul_f32 v176, v42, v176
v_mul_f32 v177, v42, v177
v_mul_f32 v178, v42, v178
v_mul_f32 v179, v42, v179
v_mul_f32 v188, v42, v188
v_mul_f32 v189, v42, v189
v_mul_f32 v190, v42, v190
v_mul_f32 v191, v42, v191
v_mul_f32 v200, v42, v200
v_mul_f32 v201, v42, v201
v_mul_f32 v202, v42, v202
v_mul_f32 v203, v42, v203
v_mul_f32 v212, v42, v212
v_mul_f32 v213, v42, v213
v_mul_f32 v214, v42, v214
v_mul_f32 v215, v42, v215
v_mul_f32 v224, v42, v224
v_mul_f32 v225, v42, v225
v_mul_f32 v226, v42, v226
v_mul_f32 v227, v42, v227
v_mul_f32 v236, v42, v236
v_mul_f32 v237, v42, v237
v_mul_f32 v238, v42, v238
v_mul_f32 v239, v42, v239
v_accvgpr_read_b32 v41, a48
v_mul_f32 v41, v42, v41
v_accvgpr_write_b32 a48, v41
v_accvgpr_read_b32 v41, a49
v_mul_f32 v41, v42, v41
v_accvgpr_write_b32 a49, v41
v_accvgpr_read_b32 v41, a50
v_mul_f32 v41, v42, v41
v_accvgpr_write_b32 a50, v41
v_accvgpr_read_b32 v41, a51
v_mul_f32 v41, v42, v41
v_accvgpr_write_b32 a51, v41
v_max3_f32 v41, v56, v57, v58
v_max3_f32 v42, v59, v68, v69
v_max3_f32 v41, v41, v70, v71
v_max3_f32 v41, v41, v42, 0
v_mov_b32 v42, v41
s_nop 1
v_permlane16_swap_b32 v42, v41
v_max_f32 v41, v41, v42
v_mov_b32 v42, v41
s_nop 1
v_permlane32_swap_b32 v42, v41
v_max_f32 v41, v41, v42
v_add_f32 v35, v35, v41
v_sub_f32 v56, v56, v41
v_sub_f32 v68, v68, v41
v_sub_f32 v57, v57, v41
v_sub_f32 v69, v69, v41
v_sub_f32 v58, v58, v41
v_sub_f32 v70, v70, v41
v_sub_f32 v59, v59, v41
v_sub_f32 v71, v71, v41
v_sub_f32 v42, 0, v41
v_exp_f32 v42, v42
s_nop 0
v_mul_f32 v156, v42, v156
v_mul_f32 v157, v42, v157
v_mul_f32 v158, v42, v158
v_mul_f32 v159, v42, v159
v_mul_f32 v168, v42, v168
v_mul_f32 v169, v42, v169
v_mul_f32 v170, v42, v170
v_mul_f32 v171, v42, v171
v_mul_f32 v180, v42, v180
v_mul_f32 v181, v42, v181
v_mul_f32 v182, v42, v182
v_mul_f32 v183, v42, v183
v_mul_f32 v192, v42, v192
v_mul_f32 v193, v42, v193
v_mul_f32 v194, v42, v194
v_mul_f32 v195, v42, v195
v_mul_f32 v204, v42, v204
v_mul_f32 v205, v42, v205
v_mul_f32 v206, v42, v206
v_mul_f32 v207, v42, v207
v_mul_f32 v216, v42, v216
v_mul_f32 v217, v42, v217
v_mul_f32 v218, v42, v218
v_mul_f32 v219, v42, v219
v_mul_f32 v228, v42, v228
v_mul_f32 v229, v42, v229
v_mul_f32 v230, v42, v230
v_mul_f32 v231, v42, v231
v_mul_f32 v240, v42, v240
v_mul_f32 v241, v42, v241
v_mul_f32 v242, v42, v242
v_mul_f32 v243, v42, v243
v_accvgpr_read_b32 v41, a52
v_mul_f32 v41, v42, v41
v_accvgpr_write_b32 a52, v41
v_accvgpr_read_b32 v41, a53
v_mul_f32 v41, v42, v41
v_accvgpr_write_b32 a53, v41
v_accvgpr_read_b32 v41, a54
v_mul_f32 v41, v42, v41
v_accvgpr_write_b32 a54, v41
v_accvgpr_read_b32 v41, a55
v_mul_f32 v41, v42, v41
v_accvgpr_write_b32 a55, v41
v_max3_f32 v41, v60, v61, v62
v_max3_f32 v42, v63, v72, v73
v_max3_f32 v41, v41, v74, v75
v_max3_f32 v41, v41, v42, 0
v_mov_b32 v42, v41
s_nop 1
v_permlane16_swap_b32 v42, v41
v_max_f32 v41, v41, v42
v_mov_b32 v42, v41
s_nop 1
v_permlane32_swap_b32 v42, v41
v_max_f32 v41, v41, v42
v_add_f32 v36, v36, v41
v_sub_f32 v60, v60, v41
v_sub_f32 v72, v72, v41
v_sub_f32 v61, v61, v41
v_sub_f32 v73, v73, v41
v_sub_f32 v62, v62, v41
v_sub_f32 v74, v74, v41
v_sub_f32 v63, v63, v41
v_sub_f32 v75, v75, v41
v_sub_f32 v42, 0, v41
v_exp_f32 v42, v42
s_nop 0
v_mul_f32 v160, v42, v160
v_mul_f32 v161, v42, v161
v_mul_f32 v162, v42, v162
v_mul_f32 v163, v42, v163
v_mul_f32 v172, v42, v172
v_mul_f32 v173, v42, v173
v_mul_f32 v174, v42, v174
v_mul_f32 v175, v42, v175
v_mul_f32 v184, v42, v184
v_mul_f32 v185, v42, v185
v_mul_f32 v186, v42, v186
v_mul_f32 v187, v42, v187
v_mul_f32 v196, v42, v196
v_mul_f32 v197, v42, v197
v_mul_f32 v198, v42, v198
v_mul_f32 v199, v42, v199
v_mul_f32 v208, v42, v208
v_mul_f32 v209, v42, v209
v_mul_f32 v210, v42, v210
v_mul_f32 v211, v42, v211
v_mul_f32 v220, v42, v220
v_mul_f32 v221, v42, v221
v_mul_f32 v222, v42, v222
v_mul_f32 v223, v42, v223
v_mul_f32 v232, v42, v232
v_mul_f32 v233, v42, v233
v_mul_f32 v234, v42, v234
v_mul_f32 v235, v42, v235
v_mul_f32 v244, v42, v244
v_mul_f32 v245, v42, v245
v_mul_f32 v246, v42, v246
v_mul_f32 v247, v42, v247
v_accvgpr_read_b32 v41, a56
v_mul_f32 v41, v42, v41
v_accvgpr_write_b32 a56, v41
v_accvgpr_read_b32 v41, a57
v_mul_f32 v41, v42, v41
v_accvgpr_write_b32 a57, v41
v_accvgpr_read_b32 v41, a58
v_mul_f32 v41, v42, v41
v_accvgpr_write_b32 a58, v41
v_accvgpr_read_b32 v41, a59
v_mul_f32 v41, v42, v41
v_accvgpr_write_b32 a59, v41
s_branch L_cont_f0
L_rare_f1:
v_max3_f32 v41, v76, v77, v78
v_max3_f32 v42, v79, v88, v89
v_max3_f32 v41, v41, v90, v91
v_max3_f32 v41, v41, v42, 0
v_mov_b32 v42, v41
s_nop 1
v_permlane16_swap_b32 v42, v41
v_max_f32 v41, v41, v42
v_mov_b32 v42, v41
s_nop 1
v_permlane32_swap_b32 v42, v41
v_max_f32 v41, v41, v42
v_add_f32 v34, v34, v41
v_sub_f32 v76, v76, v41
v_sub_f32 v88, v88, v41
v_sub_f32 v77, v77, v41
v_sub_f32 v89, v89, v41
v_sub_f32 v78, v78, v41
v_sub_f32 v90, v90, v41
v_sub_f32 v79, v79, v41
v_sub_f32 v91, v91, v41
v_sub_f32 v42, 0, v41
v_exp_f32 v42, v42
s_nop 0
v_mul_f32 v152, v42, v152
v_mul_f32 v153, v42, v153
v_mul_f32 v154, v42, v154
v_mul_f32 v155, v42, v155
v_mul_f32 v164, v42, v164
v_mul_f32 v165, v42, v165
v_mul_f32 v166, v42, v166
v_mul_f32 v167, v42, v167
v_mul_f32 v176, v42, v176
v_mul_f32 v177, v42, v177
v_mul_f32 v178, v42, v178
v_mul_f32 v179, v42, v179
v_mul_f32 v188, v42, v188
v_mul_f32 v189, v42, v189
v_mul_f32 v190, v42, v190
v_mul_f32 v191, v42, v191
v_mul_f32 v200, v42, v200
v_mul_f32 v201, v42, v201
v_mul_f32 v202, v42, v202
v_mul_f32 v203, v42, v203
v_mul_f32 v212, v42, v212
v_mul_f32 v213, v42, v213
v_mul_f32 v214, v42, v214
v_mul_f32 v215, v42, v215
v_mul_f32 v224, v42, v224
v_mul_f32 v225, v42, v225
v_mul_f32 v226, v42, v226
v_mul_f32 v227, v42, v227
v_mul_f32 v236, v42, v236
v_mul_f32 v237, v42, v237
v_mul_f32 v238, v42, v238
v_mul_f32 v239, v42, v239
v_accvgpr_read_b32 v41, a48
v_mul_f32 v41, v42, v41
v_accvgpr_write_b32 a48, v41
v_accvgpr_read_b32 v41, a49
v_mul_f32 v41, v42, v41
v_accvgpr_write_b32 a49, v41
v_accvgpr_read_b32 v41, a50
v_mul_f32 v41, v42, v41
v_accvgpr_write_b32 a50, v41
v_accvgpr_read_b32 v41, a51
v_mul_f32 v41, v42, v41
v_accvgpr_write_b32 a51, v41
v_max3_f32 v41, v80, v81, v82
v_max3_f32 v42, v83, v92, v93
v_max3_f32 v41, v41, v94, v95
v_max3_f32 v41, v41, v42, 0
v_mov_b32 v42, v41
s_nop 1
v_permlane16_swap_b32 v42, v41
v_max_f32 v41, v41, v42
v_mov_b32 v42, v41
s_nop 1
v_permlane32_swap_b32 v42, v41
v_max_f32 v41, v41, v42
v_add_f32 v35, v35, v41
v_sub_f32 v80, v80, v41
v_sub_f32 v92, v92, v41
v_sub_f32 v81, v81, v41
v_sub_f32 v93, v93, v41
v_sub_f32 v82, v82, v41
v_sub_f32 v94, v94, v41
v_sub_f32 v83, v83, v41
v_sub_f32 v95, v95, v41
v_sub_f32 v42, 0, v41
v_exp_f32 v42, v42
s_nop 0
v_mul_f32 v156, v42, v156
v_mul_f32 v157, v42, v157
v_mul_f32 v158, v42, v158
v_mul_f32 v159, v42, v159
v_mul_f32 v168, v42, v168
v_mul_f32 v169, v42, v169
v_mul_f32 v170, v42, v170
v_mul_f32 v171, v42, v171
v_mul_f32 v180, v42, v180
v_mul_f32 v181, v42, v181
v_mul_f32 v182, v42, v182
v_mul_f32 v183, v42, v183
v_mul_f32 v192, v42, v192
v_mul_f32 v193, v42, v193
v_mul_f32 v194, v42, v194
v_mul_f32 v195, v42, v195
v_mul_f32 v204, v42, v204
v_mul_f32 v205, v42, v205
v_mul_f32 v206, v42, v206
v_mul_f32 v207, v42, v207
v_mul_f32 v216, v42, v216
v_mul_f32 v217, v42, v217
v_mul_f32 v218, v42, v218
v_mul_f32 v219, v42, v219
v_mul_f32 v228, v42, v228
v_mul_f32 v229, v42, v229
v_mul_f32 v230, v42, v230
v_mul_f32 v231, v42, v231
v_mul_f32 v240, v42, v240
v_mul_f32 v241, v42, v241
v_mul_f32 v242, v42, v242
v_mul_f32 v243, v42, v243
v_accvgpr_read_b32 v41, a52
v_mul_f32 v41, v42, v41
v_accvgpr_write_b32 a52, v41
v_accvgpr_read_b32 v41, a53
v_mul_f32 v41, v42, v41
v_accvgpr_write_b32 a53, v41
v_accvgpr_read_b32 v41, a54
v_mul_f32 v41, v42, v41
v_accvgpr_write_b32 a54, v41
v_accvgpr_read_b32 v41, a55
v_mul_f32 v41, v42, v41
v_accvgpr_write_b32 a55, v41
v_max3_f32 v41, v84, v85, v86
v_max3_f32 v42, v87, v96, v97
v_max3_f32 v41, v41, v98, v99
v_max3_f32 v41, v41, v42, 0
v_mov_b32 v42, v41
s_nop 1
v_permlane16_swap_b32 v42, v41
v_max_f32 v41, v41, v42
v_mov_b32 v42, v41
s_nop 1
v_permlane32_swap_b32 v42, v41
v_max_f32 v41, v41, v42
v_add_f32 v36, v36, v41
v_sub_f32 v84, v84, v41
v_sub_f32 v96, v96, v41
v_sub_f32 v85, v85, v41
v_sub_f32 v97, v97, v41
v_sub_f32 v86, v86, v41
v_sub_f32 v98, v98, v41
v_sub_f32 v87, v87, v41
v_sub_f32 v99, v99, v41
v_sub_f32 v42, 0, v41
v_exp_f32 v42, v42
s_nop 0
v_mul_f32 v160, v42, v160
v_mul_f32 v161, v42, v161
v_mul_f32 v162, v42, v162
v_mul_f32 v163, v42, v163
v_mul_f32 v172, v42, v172
v_mul_f32 v173, v42, v173
v_mul_f32 v174, v42, v174
v_mul_f32 v175, v42, v175
v_mul_f32 v184, v42, v184
v_mul_f32 v185, v42, v185
v_mul_f32 v186, v42, v186
v_mul_f32 v187, v42, v187
v_mul_f32 v196, v42, v196
v_mul_f32 v197, v42, v197
v_mul_f32 v198, v42, v198
v_mul_f32 v199, v42, v199
v_mul_f32 v208, v42, v208
v_mul_f32 v209, v42, v209
v_mul_f32 v210, v42, v210
v_mul_f32 v211, v42, v211
v_mul_f32 v220, v42, v220
v_mul_f32 v221, v42, v221
v_mul_f32 v222, v42, v222
v_mul_f32 v223, v42, v223
v_mul_f32 v232, v42, v232
v_mul_f32 v233, v42, v233
v_mul_f32 v234, v42, v234
v_mul_f32 v235, v42, v235
v_mul_f32 v244, v42, v244
v_mul_f32 v245, v42, v245
v_mul_f32 v246, v42, v246
v_mul_f32 v247, v42, v247
v_accvgpr_read_b32 v41, a56
v_mul_f32 v41, v42, v41
v_accvgpr_write_b32 a56, v41
v_accvgpr_read_b32 v41, a57
v_mul_f32 v41, v42, v41
v_accvgpr_write_b32 a57, v41
v_accvgpr_read_b32 v41, a58
v_mul_f32 v41, v42, v41
v_accvgpr_write_b32 a58, v41
v_accvgpr_read_b32 v41, a59
v_mul_f32 v41, v42, v41
v_accvgpr_write_b32 a59, v41
s_branch L_cont_f1
L_rare_m0:
v_max3_f32 v41, v52, v53, v54
v_max3_f32 v42, v55, v64, v65
v_max3_f32 v41, v41, v66, v67
v_max3_f32 v41, v41, v42, 0
v_mov_b32 v42, v41
s_nop 1
v_permlane16_swap_b32 v42, v41
v_max_f32 v41, v41, v42
v_mov_b32 v42, v41
s_nop 1
v_permlane32_swap_b32 v42, v41
v_max_f32 v41, v41, v42
v_add_f32 v34, v34, v41
v_sub_f32 v52, v52, v41
v_sub_f32 v64, v64, v41
v_sub_f32 v53, v53, v41
v_sub_f32 v65, v65, v41
v_sub_f32 v54, v54, v41
v_sub_f32 v66, v66, v41
v_sub_f32 v55, v55, v41
v_sub_f32 v67, v67, v41
v_sub_f32 v42, 0, v41
v_exp_f32 v42, v42
s_nop 0
v_mul_f32 v152, v42, v152
v_mul_f32 v153, v42, v153
v_mul_f32 v154, v42, v154
v_mul_f32 v155, v42, v155
v_mul_f32 v164, v42, v164
v_mul_f32 v165, v42, v165
v_mul_f32 v166, v42, v166
v_mul_f32 v167, v42, v167
v_mul_f32 v176, v42, v176
v_mul_f32 v177, v42, v177
v_mul_f32 v178, v42, v178
v_mul_f32 v179, v42, v179
v_mul_f32 v188, v42, v188
v_mul_f32 v189, v42, v189
v_mul_f32 v190, v42, v190
v_mul_f32 v191, v42, v191
v_mul_f32 v200, v42, v200
v_mul_f32 v201, v42, v201
v_mul_f32 v202, v42, v202
v_mul_f32 v203, v42, v203
v_mul_f32 v212, v42, v212
v_mul_f32 v213, v42, v213
v_mul_f32 v214, v42, v214
v_mul_f32 v215, v42, v215
v_mul_f32 v224, v42, v224
v_mul_f32 v225, v42, v225
v_mul_f32 v226, v42, v226
v_mul_f32 v227, v42, v227
v_mul_f32 v236, v42, v236
v_mul_f32 v237, v42, v237
v_mul_f32 v238, v42, v238
v_mul_f32 v239, v42, v239
v_accvgpr_read_b32 v41, a48
v_mul_f32 v41, v42, v41
v_accvgpr_write_b32 a48, v41
v_accvgpr_read_b32 v41, a49
v_mul_f32 v41, v42, v41
v_accvgpr_write_b32 a49, v41
v_accvgpr_read_b32 v41, a50
v_mul_f32 v41, v42, v41
v_accvgpr_write_b32 a50, v41
v_accvgpr_read_b32 v41, a51
v_mul_f32 v41, v42, v41
v_accvgpr_write_b32 a51, v41
v_max3_f32 v41, v56, v57, v58
v_max3_f32 v42, v59, v68, v69
v_max3_f32 v41, v41, v70, v71
v_max3_f32 v41, v41, v42, 0
v_mov_b32 v42, v41
s_nop 1
v_permlane16_swap_b32 v42, v41
v_max_f32 v41, v41, v42
v_mov_b32 v42, v41
s_nop 1
v_permlane32_swap_b32 v42, v41
v_max_f32 v41, v41, v42
v_add_f32 v35, v35, v41
v_sub_f32 v56, v56, v41
v_sub_f32 v68, v68, v41
v_sub_f32 v57, v57, v41
v_sub_f32 v69, v69, v41
v_sub_f32 v58, v58, v41
v_sub_f32 v70, v70, v41
v_sub_f32 v59, v59, v41
v_sub_f32 v71, v71, v41
v_sub_f32 v42, 0, v41
v_exp_f32 v42, v42
s_nop 0
v_mul_f32 v156, v42, v156
v_mul_f32 v157, v42, v157
v_mul_f32 v158, v42, v158
v_mul_f32 v159, v42, v159
v_mul_f32 v168, v42, v168
v_mul_f32 v169, v42, v169
v_mul_f32 v170, v42, v170
v_mul_f32 v171, v42, v171
v_mul_f32 v180, v42, v180
v_mul_f32 v181, v42, v181
v_mul_f32 v182, v42, v182
v_mul_f32 v183, v42, v183
v_mul_f32 v192, v42, v192
v_mul_f32 v193, v42, v193
v_mul_f32 v194, v42, v194
v_mul_f32 v195, v42, v195
v_mul_f32 v204, v42, v204
v_mul_f32 v205, v42, v205
v_mul_f32 v206, v42, v206
v_mul_f32 v207, v42, v207
v_mul_f32 v216, v42, v216
v_mul_f32 v217, v42, v217
v_mul_f32 v218, v42, v218
v_mul_f32 v219, v42, v219
v_mul_f32 v228, v42, v228
v_mul_f32 v229, v42, v229
v_mul_f32 v230, v42, v230
v_mul_f32 v231, v42, v231
v_mul_f32 v240, v42, v240
v_mul_f32 v241, v42, v241
v_mul_f32 v242, v42, v242
v_mul_f32 v243, v42, v243
v_accvgpr_read_b32 v41, a52
v_mul_f32 v41, v42, v41
v_accvgpr_write_b32 a52, v41
v_accvgpr_read_b32 v41, a53
v_mul_f32 v41, v42, v41
v_accvgpr_write_b32 a53, v41
v_accvgpr_read_b32 v41, a54
v_mul_f32 v41, v42, v41
v_accvgpr_write_b32 a54, v41
v_accvgpr_read_b32 v41, a55
v_mul_f32 v41, v42, v41
v_accvgpr_write_b32 a55, v41
v_max3_f32 v41, v60, v61, v62
v_max3_f32 v42, v63, v72, v73
v_max3_f32 v41, v41, v74, v75
v_max3_f32 v41, v41, v42, 0
v_mov_b32 v42, v41
s_nop 1
v_permlane16_swap_b32 v42, v41
v_max_f32 v41, v41, v42
v_mov_b32 v42, v41
s_nop 1
v_permlane32_swap_b32 v42, v41
v_max_f32 v41, v41, v42
v_add_f32 v36, v36, v41
v_sub_f32 v60, v60, v41
v_sub_f32 v72, v72, v41
v_sub_f32 v61, v61, v41
v_sub_f32 v73, v73, v41
v_sub_f32 v62, v62, v41
v_sub_f32 v74, v74, v41
v_sub_f32 v63, v63, v41
v_sub_f32 v75, v75, v41
v_sub_f32 v42, 0, v41
v_exp_f32 v42, v42
s_nop 0
v_mul_f32 v160, v42, v160
v_mul_f32 v161, v42, v161
v_mul_f32 v162, v42, v162
v_mul_f32 v163, v42, v163
v_mul_f32 v172, v42, v172
v_mul_f32 v173, v42, v173
v_mul_f32 v174, v42, v174
v_mul_f32 v175, v42, v175
v_mul_f32 v184, v42, v184
v_mul_f32 v185, v42, v185
v_mul_f32 v186, v42, v186
v_mul_f32 v187, v42, v187
v_mul_f32 v196, v42, v196
v_mul_f32 v197, v42, v197
v_mul_f32 v198, v42, v198
v_mul_f32 v199, v42, v199
v_mul_f32 v208, v42, v208
v_mul_f32 v209, v42, v209
v_mul_f32 v210, v42, v210
v_mul_f32 v211, v42, v211
v_mul_f32 v220, v42, v220
v_mul_f32 v221, v42, v221
v_mul_f32 v222, v42, v222
v_mul_f32 v223, v42, v223
v_mul_f32 v232, v42, v232
v_mul_f32 v233, v42, v233
v_mul_f32 v234, v42, v234
v_mul_f32 v235, v42, v235
v_mul_f32 v244, v42, v244
v_mul_f32 v245, v42, v245
v_mul_f32 v246, v42, v246
v_mul_f32 v247, v42, v247
v_accvgpr_read_b32 v41, a56
v_mul_f32 v41, v42, v41
v_accvgpr_write_b32 a56, v41
v_accvgpr_read_b32 v41, a57
v_mul_f32 v41, v42, v41
v_accvgpr_write_b32 a57, v41
v_accvgpr_read_b32 v41, a58
v_mul_f32 v41, v42, v41
v_accvgpr_write_b32 a58, v41
v_accvgpr_read_b32 v41, a59
v_mul_f32 v41, v42, v41
v_accvgpr_write_b32 a59, v41
s_branch L_cont_m0
L_rare_m1:
v_max3_f32 v41, v76, v77, v78
v_max3_f32 v42, v79, v88, v89
v_max3_f32 v41, v41, v90, v91
v_max3_f32 v41, v41, v42, 0
v_mov_b32 v42, v41
s_nop 1
v_permlane16_swap_b32 v42, v41
v_max_f32 v41, v41, v42
v_mov_b32 v42, v41
s_nop 1
v_permlane32_swap_b32 v42, v41
v_max_f32 v41, v41, v42
v_add_f32 v34, v34, v41
v_sub_f32 v76, v76, v41
v_sub_f32 v88, v88, v41
v_sub_f32 v77, v77, v41
v_sub_f32 v89, v89, v41
v_sub_f32 v78, v78, v41
v_sub_f32 v90, v90, v41
v_sub_f32 v79, v79, v41
v_sub_f32 v91, v91, v41
v_sub_f32 v42, 0, v41
v_exp_f32 v42, v42
s_nop 0
v_mul_f32 v152, v42, v152
v_mul_f32 v153, v42, v153
v_mul_f32 v154, v42, v154
v_mul_f32 v155, v42, v155
v_mul_f32 v164, v42, v164
v_mul_f32 v165, v42, v165
v_mul_f32 v166, v42, v166
v_mul_f32 v167, v42, v167
v_mul_f32 v176, v42, v176
v_mul_f32 v177, v42, v177
v_mul_f32 v178, v42, v178
v_mul_f32 v179, v42, v179
v_mul_f32 v188, v42, v188
v_mul_f32 v189, v42, v189
v_mul_f32 v190, v42, v190
v_mul_f32 v191, v42, v191
v_mul_f32 v200, v42, v200
v_mul_f32 v201, v42, v201
v_mul_f32 v202, v42, v202
v_mul_f32 v203, v42, v203
v_mul_f32 v212, v42, v212
v_mul_f32 v213, v42, v213
v_mul_f32 v214, v42, v214
v_mul_f32 v215, v42, v215
v_mul_f32 v224, v42, v224
v_mul_f32 v225, v42, v225
v_mul_f32 v226, v42, v226
v_mul_f32 v227, v42, v227
v_mul_f32 v236, v42, v236
v_mul_f32 v237, v42, v237
v_mul_f32 v238, v42, v238
v_mul_f32 v239, v42, v239
v_accvgpr_read_b32 v41, a48
v_mul_f32 v41, v42, v41
v_accvgpr_write_b32 a48, v41
v_accvgpr_read_b32 v41, a49
v_mul_f32 v41, v42, v41
v_accvgpr_write_b32 a49, v41
v_accvgpr_read_b32 v41, a50
v_mul_f32 v41, v42, v41
v_accvgpr_write_b32 a50, v41
v_accvgpr_read_b32 v41, a51
v_mul_f32 v41, v42, v41
v_accvgpr_write_b32 a51, v41
v_max3_f32 v41, v80, v81, v82
v_max3_f32 v42, v83, v92, v93
v_max3_f32 v41, v41, v94, v95
v_max3_f32 v41, v41, v42, 0
v_mov_b32 v42, v41
s_nop 1
v_permlane16_swap_b32 v42, v41
v_max_f32 v41, v41, v42
v_mov_b32 v42, v41
s_nop 1
v_permlane32_swap_b32 v42, v41
v_max_f32 v41, v41, v42
v_add_f32 v35, v35, v41
v_sub_f32 v80, v80, v41
v_sub_f32 v92, v92, v41
v_sub_f32 v81, v81, v41
v_sub_f32 v93, v93, v41
v_sub_f32 v82, v82, v41
v_sub_f32 v94, v94, v41
v_sub_f32 v83, v83, v41
v_sub_f32 v95, v95, v41
v_sub_f32 v42, 0, v41
v_exp_f32 v42, v42
s_nop 0
v_mul_f32 v156, v42, v156
v_mul_f32 v157, v42, v157
v_mul_f32 v158, v42, v158
v_mul_f32 v159, v42, v159
v_mul_f32 v168, v42, v168
v_mul_f32 v169, v42, v169
v_mul_f32 v170, v42, v170
v_mul_f32 v171, v42, v171
v_mul_f32 v180, v42, v180
v_mul_f32 v181, v42, v181
v_mul_f32 v182, v42, v182
v_mul_f32 v183, v42, v183
v_mul_f32 v192, v42, v192
v_mul_f32 v193, v42, v193
v_mul_f32 v194, v42, v194
v_mul_f32 v195, v42, v195
v_mul_f32 v204, v42, v204
v_mul_f32 v205, v42, v205
v_mul_f32 v206, v42, v206
v_mul_f32 v207, v42, v207
v_mul_f32 v216, v42, v216
v_mul_f32 v217, v42, v217
v_mul_f32 v218, v42, v218
v_mul_f32 v219, v42, v219
v_mul_f32 v228, v42, v228
v_mul_f32 v229, v42, v229
v_mul_f32 v230, v42, v230
v_mul_f32 v231, v42, v231
v_mul_f32 v240, v42, v240
v_mul_f32 v241, v42, v241
v_mul_f32 v242, v42, v242
v_mul_f32 v243, v42, v243
v_accvgpr_read_b32 v41, a52
v_mul_f32 v41, v42, v41
v_accvgpr_write_b32 a52, v41
v_accvgpr_read_b32 v41, a53
v_mul_f32 v41, v42, v41
v_accvgpr_write_b32 a53, v41
v_accvgpr_read_b32 v41, a54
v_mul_f32 v41, v42, v41
v_accvgpr_write_b32 a54, v41
v_accvgpr_read_b32 v41, a55
v_mul_f32 v41, v42, v41
v_accvgpr_write_b32 a55, v41
v_max3_f32 v41, v84, v85, v86
v_max3_f32 v42, v87, v96, v97
v_max3_f32 v41, v41, v98, v99
v_max3_f32 v41, v41, v42, 0
v_mov_b32 v42, v41
s_nop 1
v_permlane16_swap_b32 v42, v41
v_max_f32 v41, v41, v42
v_mov_b32 v42, v41
s_nop 1
v_permlane32_swap_b32 v42, v41
v_max_f32 v41, v41, v42
v_add_f32 v36, v36, v41
v_sub_f32 v84, v84, v41
v_sub_f32 v96, v96, v41
v_sub_f32 v85, v85, v41
v_sub_f32 v97, v97, v41
v_sub_f32 v86, v86, v41
v_sub_f32 v98, v98, v41
v_sub_f32 v87, v87, v41
v_sub_f32 v99, v99, v41
v_sub_f32 v42, 0, v41
v_exp_f32 v42, v42
s_nop 0
v_mul_f32 v160, v42, v160
v_mul_f32 v161, v42, v161
v_mul_f32 v162, v42, v162
v_mul_f32 v163, v42, v163
v_mul_f32 v172, v42, v172
v_mul_f32 v173, v42, v173
v_mul_f32 v174, v42, v174
v_mul_f32 v175, v42, v175
v_mul_f32 v184, v42, v184
v_mul_f32 v185, v42, v185
v_mul_f32 v186, v42, v186
v_mul_f32 v187, v42, v187
v_mul_f32 v196, v42, v196
v_mul_f32 v197, v42, v197
v_mul_f32 v198, v42, v198
v_mul_f32 v199, v42, v199
v_mul_f32 v208, v42, v208
v_mul_f32 v209, v42, v209
v_mul_f32 v210, v42, v210
v_mul_f32 v211, v42, v211
v_mul_f32 v220, v42, v220
v_mul_f32 v221, v42, v221
v_mul_f32 v222, v42, v222
v_mul_f32 v223, v42, v223
v_mul_f32 v232, v42, v232
v_mul_f32 v233, v42, v233
v_mul_f32 v234, v42, v234
v_mul_f32 v235, v42, v235
v_mul_f32 v244, v42, v244
v_mul_f32 v245, v42, v245
v_mul_f32 v246, v42, v246
v_mul_f32 v247, v42, v247
v_accvgpr_read_b32 v41, a56
v_mul_f32 v41, v42, v41
v_accvgpr_write_b32 a56, v41
v_accvgpr_read_b32 v41, a57
v_mul_f32 v41, v42, v41
v_accvgpr_write_b32 a57, v41
v_accvgpr_read_b32 v41, a58
v_mul_f32 v41, v42, v41
v_accvgpr_write_b32 a58, v41
v_accvgpr_read_b32 v41, a59
v_mul_f32 v41, v42, v41
v_accvgpr_write_b32 a59, v41
s_branch L_cont_m1
L_rare_t0:
v_max3_f32 v41, v52, v53, v54
v_max3_f32 v42, v55, v64, v65
v_max3_f32 v41, v41, v66, v67
v_max3_f32 v41, v41, v42, 0
v_mov_b32 v42, v41
s_nop 1
v_permlane16_swap_b32 v42, v41
v_max_f32 v41, v41, v42
v_mov_b32 v42, v41
s_nop 1
v_permlane32_swap_b32 v42, v41
v_max_f32 v41, v41, v42
v_add_f32 v34, v34, v41
v_sub_f32 v52, v52, v41
v_sub_f32 v64, v64, v41
v_sub_f32 v53, v53, v41
v_sub_f32 v65, v65, v41
v_sub_f32 v54, v54, v41
v_sub_f32 v66, v66, v41
v_sub_f32 v55, v55, v41
v_sub_f32 v67, v67, v41
v_sub_f32 v42, 0, v41
v_exp_f32 v42, v42
s_nop 0
v_mul_f32 v152, v42, v152
v_mul_f32 v153, v42, v153
v_mul_f32 v154, v42, v154
v_mul_f32 v155, v42, v155
v_mul_f32 v164, v42, v164
v_mul_f32 v165, v42, v165
v_mul_f32 v166, v42, v166
v_mul_f32 v167, v42, v167
v_mul_f32 v176, v42, v176
v_mul_f32 v177, v42, v177
v_mul_f32 v178, v42, v178
v_mul_f32 v179, v42, v179
v_mul_f32 v188, v42, v188
v_mul_f32 v189, v42, v189
v_mul_f32 v190, v42, v190
v_mul_f32 v191, v42, v191
v_mul_f32 v200, v42, v200
v_mul_f32 v201, v42, v201
v_mul_f32 v202, v42, v202
v_mul_f32 v203, v42, v203
v_mul_f32 v212, v42, v212
v_mul_f32 v213, v42, v213
v_mul_f32 v214, v42, v214
v_mul_f32 v215, v42, v215
v_mul_f32 v224, v42, v224
v_mul_f32 v225, v42, v225
v_mul_f32 v226, v42, v226
v_mul_f32 v227, v42, v227
v_mul_f32 v236, v42, v236
v_mul_f32 v237, v42, v237
v_mul_f32 v238, v42, v238
v_mul_f32 v239, v42, v239
v_accvgpr_read_b32 v41, a48
v_mul_f32 v41, v42, v41
v_accvgpr_write_b32 a48, v41
v_accvgpr_read_b32 v41, a49
v_mul_f32 v41, v42, v41
v_accvgpr_write_b32 a49, v41
v_accvgpr_read_b32 v41, a50
v_mul_f32 v41, v42, v41
v_accvgpr_write_b32 a50, v41
v_accvgpr_read_b32 v41, a51
v_mul_f32 v41, v42, v41
v_accvgpr_write_b32 a51, v41
v_max3_f32 v41, v56, v57, v58
v_max3_f32 v42, v59, v68, v69
v_max3_f32 v41, v41, v70, v71
v_max3_f32 v41, v41, v42, 0
v_mov_b32 v42, v41
s_nop 1
v_permlane16_swap_b32 v42, v41
v_max_f32 v41, v41, v42
v_mov_b32 v42, v41
s_nop 1
v_permlane32_swap_b32 v42, v41
v_max_f32 v41, v41, v42
v_add_f32 v35, v35, v41
v_sub_f32 v56, v56, v41
v_sub_f32 v68, v68, v41
v_sub_f32 v57, v57, v41
v_sub_f32 v69, v69, v41
v_sub_f32 v58, v58, v41
v_sub_f32 v70, v70, v41
v_sub_f32 v59, v59, v41
v_sub_f32 v71, v71, v41
v_sub_f32 v42, 0, v41
v_exp_f32 v42, v42
s_nop 0
v_mul_f32 v156, v42, v156
v_mul_f32 v157, v42, v157
v_mul_f32 v158, v42, v158
v_mul_f32 v159, v42, v159
v_mul_f32 v168, v42, v168
v_mul_f32 v169, v42, v169
v_mul_f32 v170, v42, v170
v_mul_f32 v171, v42, v171
v_mul_f32 v180, v42, v180
v_mul_f32 v181, v42, v181
v_mul_f32 v182, v42, v182
v_mul_f32 v183, v42, v183
v_mul_f32 v192, v42, v192
v_mul_f32 v193, v42, v193
v_mul_f32 v194, v42, v194
v_mul_f32 v195, v42, v195
v_mul_f32 v204, v42, v204
v_mul_f32 v205, v42, v205
v_mul_f32 v206, v42, v206
v_mul_f32 v207, v42, v207
v_mul_f32 v216, v42, v216
v_mul_f32 v217, v42, v217
v_mul_f32 v218, v42, v218
v_mul_f32 v219, v42, v219
v_mul_f32 v228, v42, v228
v_mul_f32 v229, v42, v229
v_mul_f32 v230, v42, v230
v_mul_f32 v231, v42, v231
v_mul_f32 v240, v42, v240
v_mul_f32 v241, v42, v241
v_mul_f32 v242, v42, v242
v_mul_f32 v243, v42, v243
v_accvgpr_read_b32 v41, a52
v_mul_f32 v41, v42, v41
v_accvgpr_write_b32 a52, v41
v_accvgpr_read_b32 v41, a53
v_mul_f32 v41, v42, v41
v_accvgpr_write_b32 a53, v41
v_accvgpr_read_b32 v41, a54
v_mul_f32 v41, v42, v41
v_accvgpr_write_b32 a54, v41
v_accvgpr_read_b32 v41, a55
v_mul_f32 v41, v42, v41
v_accvgpr_write_b32 a55, v41
v_max3_f32 v41, v60, v61, v62
v_max3_f32 v42, v63, v72, v73
v_max3_f32 v41, v41, v74, v75
v_max3_f32 v41, v41, v42, 0
v_mov_b32 v42, v41
s_nop 1
v_permlane16_swap_b32 v42, v41
v_max_f32 v41, v41, v42
v_mov_b32 v42, v41
s_nop 1
v_permlane32_swap_b32 v42, v41
v_max_f32 v41, v41, v42
v_add_f32 v36, v36, v41
v_sub_f32 v60, v60, v41
v_sub_f32 v72, v72, v41
v_sub_f32 v61, v61, v41
v_sub_f32 v73, v73, v41
v_sub_f32 v62, v62, v41
v_sub_f32 v74, v74, v41
v_sub_f32 v63, v63, v41
v_sub_f32 v75, v75, v41
v_sub_f32 v42, 0, v41
v_exp_f32 v42, v42
s_nop 0
v_mul_f32 v160, v42, v160
v_mul_f32 v161, v42, v161
v_mul_f32 v162, v42, v162
v_mul_f32 v163, v42, v163
v_mul_f32 v172, v42, v172
v_mul_f32 v173, v42, v173
v_mul_f32 v174, v42, v174
v_mul_f32 v175, v42, v175
v_mul_f32 v184, v42, v184
v_mul_f32 v185, v42, v185
v_mul_f32 v186, v42, v186
v_mul_f32 v187, v42, v187
v_mul_f32 v196, v42, v196
v_mul_f32 v197, v42, v197
v_mul_f32 v198, v42, v198
v_mul_f32 v199, v42, v199
v_mul_f32 v208, v42, v208
v_mul_f32 v209, v42, v209
v_mul_f32 v210, v42, v210
v_mul_f32 v211, v42, v211
v_mul_f32 v220, v42, v220
v_mul_f32 v221, v42, v221
v_mul_f32 v222, v42, v222
v_mul_f32 v223, v42, v223
v_mul_f32 v232, v42, v232
v_mul_f32 v233, v42, v233
v_mul_f32 v234, v42, v234
v_mul_f32 v235, v42, v235
v_mul_f32 v244, v42, v244
v_mul_f32 v245, v42, v245
v_mul_f32 v246, v42, v246
v_mul_f32 v247, v42, v247
v_accvgpr_read_b32 v41, a56
v_mul_f32 v41, v42, v41
v_accvgpr_write_b32 a56, v41
v_accvgpr_read_b32 v41, a57
v_mul_f32 v41, v42, v41
v_accvgpr_write_b32 a57, v41
v_accvgpr_read_b32 v41, a58
v_mul_f32 v41, v42, v41
v_accvgpr_write_b32 a58, v41
v_accvgpr_read_b32 v41, a59
v_mul_f32 v41, v42, v41
v_accvgpr_write_b32 a59, v41
s_branch L_cont_t0
L_rare_t1:
v_max3_f32 v41, v76, v77, v78
v_max3_f32 v42, v79, v88, v89
v_max3_f32 v41, v41, v90, v91
v_max3_f32 v41, v41, v42, 0
v_mov_b32 v42, v41
s_nop 1
v_permlane16_swap_b32 v42, v41
v_max_f32 v41, v41, v42
v_mov_b32 v42, v41
s_nop 1
v_permlane32_swap_b32 v42, v41
v_max_f32 v41, v41, v42
v_add_f32 v34, v34, v41
v_sub_f32 v76, v76, v41
v_sub_f32 v88, v88, v41
v_sub_f32 v77, v77, v41
v_sub_f32 v89, v89, v41
v_sub_f32 v78, v78, v41
v_sub_f32 v90, v90, v41
v_sub_f32 v79, v79, v41
v_sub_f32 v91, v91, v41
v_sub_f32 v42, 0, v41
v_exp_f32 v42, v42
s_nop 0
v_mul_f32 v152, v42, v152
v_mul_f32 v153, v42, v153
v_mul_f32 v154, v42, v154
v_mul_f32 v155, v42, v155
v_mul_f32 v164, v42, v164
v_mul_f32 v165, v42, v165
v_mul_f32 v166, v42, v166
v_mul_f32 v167, v42, v167
v_mul_f32 v176, v42, v176
v_mul_f32 v177, v42, v177
v_mul_f32 v178, v42, v178
v_mul_f32 v179, v42, v179
v_mul_f32 v188, v42, v188
v_mul_f32 v189, v42, v189
v_mul_f32 v190, v42, v190
v_mul_f32 v191, v42, v191
v_mul_f32 v200, v42, v200
v_mul_f32 v201, v42, v201
v_mul_f32 v202, v42, v202
v_mul_f32 v203, v42, v203
v_mul_f32 v212, v42, v212
v_mul_f32 v213, v42, v213
v_mul_f32 v214, v42, v214
v_mul_f32 v215, v42, v215
v_mul_f32 v224, v42, v224
v_mul_f32 v225, v42, v225
v_mul_f32 v226, v42, v226
v_mul_f32 v227, v42, v227
v_mul_f32 v236, v42, v236
v_mul_f32 v237, v42, v237
v_mul_f32 v238, v42, v238
v_mul_f32 v239, v42, v239
v_accvgpr_read_b32 v41, a48
v_mul_f32 v41, v42, v41
v_accvgpr_write_b32 a48, v41
v_accvgpr_read_b32 v41, a49
v_mul_f32 v41, v42, v41
v_accvgpr_write_b32 a49, v41
v_accvgpr_read_b32 v41, a50
v_mul_f32 v41, v42, v41
v_accvgpr_write_b32 a50, v41
v_accvgpr_read_b32 v41, a51
v_mul_f32 v41, v42, v41
v_accvgpr_write_b32 a51, v41
v_max3_f32 v41, v80, v81, v82
v_max3_f32 v42, v83, v92, v93
v_max3_f32 v41, v41, v94, v95
v_max3_f32 v41, v41, v42, 0
v_mov_b32 v42, v41
s_nop 1
v_permlane16_swap_b32 v42, v41
v_max_f32 v41, v41, v42
v_mov_b32 v42, v41
s_nop 1
v_permlane32_swap_b32 v42, v41
v_max_f32 v41, v41, v42
v_add_f32 v35, v35, v41
v_sub_f32 v80, v80, v41
v_sub_f32 v92, v92, v41
v_sub_f32 v81, v81, v41
v_sub_f32 v93, v93, v41
v_sub_f32 v82, v82, v41
v_sub_f32 v94, v94, v41
v_sub_f32 v83, v83, v41
v_sub_f32 v95, v95, v41
v_sub_f32 v42, 0, v41
v_exp_f32 v42, v42
s_nop 0
v_mul_f32 v156, v42, v156
v_mul_f32 v157, v42, v157
v_mul_f32 v158, v42, v158
v_mul_f32 v159, v42, v159
v_mul_f32 v168, v42, v168
v_mul_f32 v169, v42, v169
v_mul_f32 v170, v42, v170
v_mul_f32 v171, v42, v171
v_mul_f32 v180, v42, v180
v_mul_f32 v181, v42, v181
v_mul_f32 v182, v42, v182
v_mul_f32 v183, v42, v183
v_mul_f32 v192, v42, v192
v_mul_f32 v193, v42, v193
v_mul_f32 v194, v42, v194
v_mul_f32 v195, v42, v195
v_mul_f32 v204, v42, v204
v_mul_f32 v205, v42, v205
v_mul_f32 v206, v42, v206
v_mul_f32 v207, v42, v207
v_mul_f32 v216, v42, v216
v_mul_f32 v217, v42, v217
v_mul_f32 v218, v42, v218
v_mul_f32 v219, v42, v219
v_mul_f32 v228, v42, v228
v_mul_f32 v229, v42, v229
v_mul_f32 v230, v42, v230
v_mul_f32 v231, v42, v231
v_mul_f32 v240, v42, v240
v_mul_f32 v241, v42, v241
v_mul_f32 v242, v42, v242
v_mul_f32 v243, v42, v243
v_accvgpr_read_b32 v41, a52
v_mul_f32 v41, v42, v41
v_accvgpr_write_b32 a52, v41
v_accvgpr_read_b32 v41, a53
v_mul_f32 v41, v42, v41
v_accvgpr_write_b32 a53, v41
v_accvgpr_read_b32 v41, a54
v_mul_f32 v41, v42, v41
v_accvgpr_write_b32 a54, v41
v_accvgpr_read_b32 v41, a55
v_mul_f32 v41, v42, v41
v_accvgpr_write_b32 a55, v41
v_max3_f32 v41, v84, v85, v86
v_max3_f32 v42, v87, v96, v97
v_max3_f32 v41, v41, v98, v99
v_max3_f32 v41, v41, v42, 0
v_mov_b32 v42, v41
s_nop 1
v_permlane16_swap_b32 v42, v41
v_max_f32 v41, v41, v42
v_mov_b32 v42, v41
s_nop 1
v_permlane32_swap_b32 v42, v41
v_max_f32 v41, v41, v42
v_add_f32 v36, v36, v41
v_sub_f32 v84, v84, v41
v_sub_f32 v96, v96, v41
v_sub_f32 v85, v85, v41
v_sub_f32 v97, v97, v41
v_sub_f32 v86, v86, v41
v_sub_f32 v98, v98, v41
v_sub_f32 v87, v87, v41
v_sub_f32 v99, v99, v41
v_sub_f32 v42, 0, v41
v_exp_f32 v42, v42
s_nop 0
v_mul_f32 v160, v42, v160
v_mul_f32 v161, v42, v161
v_mul_f32 v162, v42, v162
v_mul_f32 v163, v42, v163
v_mul_f32 v172, v42, v172
v_mul_f32 v173, v42, v173
v_mul_f32 v174, v42, v174
v_mul_f32 v175, v42, v175
v_mul_f32 v184, v42, v184
v_mul_f32 v185, v42, v185
v_mul_f32 v186, v42, v186
v_mul_f32 v187, v42, v187
v_mul_f32 v196, v42, v196
v_mul_f32 v197, v42, v197
v_mul_f32 v198, v42, v198
v_mul_f32 v199, v42, v199
v_mul_f32 v208, v42, v208
v_mul_f32 v209, v42, v209
v_mul_f32 v210, v42, v210
v_mul_f32 v211, v42, v211
v_mul_f32 v220, v42, v220
v_mul_f32 v221, v42, v221
v_mul_f32 v222, v42, v222
v_mul_f32 v223, v42, v223
v_mul_f32 v232, v42, v232
v_mul_f32 v233, v42, v233
v_mul_f32 v234, v42, v234
v_mul_f32 v235, v42, v235
v_mul_f32 v244, v42, v244
v_mul_f32 v245, v42, v245
v_mul_f32 v246, v42, v246
v_mul_f32 v247, v42, v247
v_accvgpr_read_b32 v41, a56
v_mul_f32 v41, v42, v41
v_accvgpr_write_b32 a56, v41
v_accvgpr_read_b32 v41, a57
v_mul_f32 v41, v42, v41
v_accvgpr_write_b32 a57, v41
v_accvgpr_read_b32 v41, a58
v_mul_f32 v41, v42, v41
v_accvgpr_write_b32 a58, v41
v_accvgpr_read_b32 v41, a59
v_mul_f32 v41, v42, v41
v_accvgpr_write_b32 a59, v41
s_branch L_cont_t1
L_rare_t2:
v_max3_f32 v41, v52, v53, v54
v_max3_f32 v42, v55, v64, v65
v_max3_f32 v41, v41, v66, v67
v_max3_f32 v41, v41, v42, 0
v_mov_b32 v42, v41
s_nop 1
v_permlane16_swap_b32 v42, v41
v_max_f32 v41, v41, v42
v_mov_b32 v42, v41
s_nop 1
v_permlane32_swap_b32 v42, v41
v_max_f32 v41, v41, v42
v_add_f32 v34, v34, v41
v_sub_f32 v52, v52, v41
v_sub_f32 v64, v64, v41
v_sub_f32 v53, v53, v41
v_sub_f32 v65, v65, v41
v_sub_f32 v54, v54, v41
v_sub_f32 v66, v66, v41
v_sub_f32 v55, v55, v41
v_sub_f32 v67, v67, v41
v_sub_f32 v42, 0, v41
v_exp_f32 v42, v42
s_nop 0
v_mul_f32 v152, v42, v152
v_mul_f32 v153, v42, v153
v_mul_f32 v154, v42, v154
v_mul_f32 v155, v42, v155
v_mul_f32 v164, v42, v164
v_mul_f32 v165, v42, v165
v_mul_f32 v166, v42, v166
v_mul_f32 v167, v42, v167
v_mul_f32 v176, v42, v176
v_mul_f32 v177, v42, v177
v_mul_f32 v178, v42, v178
v_mul_f32 v179, v42, v179
v_mul_f32 v188, v42, v188
v_mul_f32 v189, v42, v189
v_mul_f32 v190, v42, v190
v_mul_f32 v191, v42, v191
v_mul_f32 v200, v42, v200
v_mul_f32 v201, v42, v201
v_mul_f32 v202, v42, v202
v_mul_f32 v203, v42, v203
v_mul_f32 v212, v42, v212
v_mul_f32 v213, v42, v213
v_mul_f32 v214, v42, v214
v_mul_f32 v215, v42, v215
v_mul_f32 v224, v42, v224
v_mul_f32 v225, v42, v225
v_mul_f32 v226, v42, v226
v_mul_f32 v227, v42, v227
v_mul_f32 v236, v42, v236
v_mul_f32 v237, v42, v237
v_mul_f32 v238, v42, v238
v_mul_f32 v239, v42, v239
v_accvgpr_read_b32 v41, a48
v_mul_f32 v41, v42, v41
v_accvgpr_write_b32 a48, v41
v_accvgpr_read_b32 v41, a49
v_mul_f32 v41, v42, v41
v_accvgpr_write_b32 a49, v41
v_accvgpr_read_b32 v41, a50
v_mul_f32 v41, v42, v41
v_accvgpr_write_b32 a50, v41
v_accvgpr_read_b32 v41, a51
v_mul_f32 v41, v42, v41
v_accvgpr_write_b32 a51, v41
v_max3_f32 v41, v56, v57, v58
v_max3_f32 v42, v59, v68, v69
v_max3_f32 v41, v41, v70, v71
v_max3_f32 v41, v41, v42, 0
v_mov_b32 v42, v41
s_nop 1
v_permlane16_swap_b32 v42, v41
v_max_f32 v41, v41, v42
v_mov_b32 v42, v41
s_nop 1
v_permlane32_swap_b32 v42, v41
v_max_f32 v41, v41, v42
v_add_f32 v35, v35, v41
v_sub_f32 v56, v56, v41
v_sub_f32 v68, v68, v41
v_sub_f32 v57, v57, v41
v_sub_f32 v69, v69, v41
v_sub_f32 v58, v58, v41
v_sub_f32 v70, v70, v41
v_sub_f32 v59, v59, v41
v_sub_f32 v71, v71, v41
v_sub_f32 v42, 0, v41
v_exp_f32 v42, v42
s_nop 0
v_mul_f32 v156, v42, v156
v_mul_f32 v157, v42, v157
v_mul_f32 v158, v42, v158
v_mul_f32 v159, v42, v159
v_mul_f32 v168, v42, v168
v_mul_f32 v169, v42, v169
v_mul_f32 v170, v42, v170
v_mul_f32 v171, v42, v171
v_mul_f32 v180, v42, v180
v_mul_f32 v181, v42, v181
v_mul_f32 v182, v42, v182
v_mul_f32 v183, v42, v183
v_mul_f32 v192, v42, v192
v_mul_f32 v193, v42, v193
v_mul_f32 v194, v42, v194
v_mul_f32 v195, v42, v195
v_mul_f32 v204, v42, v204
v_mul_f32 v205, v42, v205
v_mul_f32 v206, v42, v206
v_mul_f32 v207, v42, v207
v_mul_f32 v216, v42, v216
v_mul_f32 v217, v42, v217
v_mul_f32 v218, v42, v218
v_mul_f32 v219, v42, v219
v_mul_f32 v228, v42, v228
v_mul_f32 v229, v42, v229
v_mul_f32 v230, v42, v230
v_mul_f32 v231, v42, v231
v_mul_f32 v240, v42, v240
v_mul_f32 v241, v42, v241
v_mul_f32 v242, v42, v242
v_mul_f32 v243, v42, v243
v_accvgpr_read_b32 v41, a52
v_mul_f32 v41, v42, v41
v_accvgpr_write_b32 a52, v41
v_accvgpr_read_b32 v41, a53
v_mul_f32 v41, v42, v41
v_accvgpr_write_b32 a53, v41
v_accvgpr_read_b32 v41, a54
v_mul_f32 v41, v42, v41
v_accvgpr_write_b32 a54, v41
v_accvgpr_read_b32 v41, a55
v_mul_f32 v41, v42, v41
v_accvgpr_write_b32 a55, v41
v_max3_f32 v41, v60, v61, v62
v_max3_f32 v42, v63, v72, v73
v_max3_f32 v41, v41, v74, v75
v_max3_f32 v41, v41, v42, 0
v_mov_b32 v42, v41
s_nop 1
v_permlane16_swap_b32 v42, v41
v_max_f32 v41, v41, v42
v_mov_b32 v42, v41
s_nop 1
v_permlane32_swap_b32 v42, v41
v_max_f32 v41, v41, v42
v_add_f32 v36, v36, v41
v_sub_f32 v60, v60, v41
v_sub_f32 v72, v72, v41
v_sub_f32 v61, v61, v41
v_sub_f32 v73, v73, v41
v_sub_f32 v62, v62, v41
v_sub_f32 v74, v74, v41
v_sub_f32 v63, v63, v41
v_sub_f32 v75, v75, v41
v_sub_f32 v42, 0, v41
v_exp_f32 v42, v42
s_nop 0
v_mul_f32 v160, v42, v160
v_mul_f32 v161, v42, v161
v_mul_f32 v162, v42, v162
v_mul_f32 v163, v42, v163
v_mul_f32 v172, v42, v172
v_mul_f32 v173, v42, v173
v_mul_f32 v174, v42, v174
v_mul_f32 v175, v42, v175
v_mul_f32 v184, v42, v184
v_mul_f32 v185, v42, v185
v_mul_f32 v186, v42, v186
v_mul_f32 v187, v42, v187
v_mul_f32 v196, v42, v196
v_mul_f32 v197, v42, v197
v_mul_f32 v198, v42, v198
v_mul_f32 v199, v42, v199
v_mul_f32 v208, v42, v208
v_mul_f32 v209, v42, v209
v_mul_f32 v210, v42, v210
v_mul_f32 v211, v42, v211
v_mul_f32 v220, v42, v220
v_mul_f32 v221, v42, v221
v_mul_f32 v222, v42, v222
v_mul_f32 v223, v42, v223
v_mul_f32 v232, v42, v232
v_mul_f32 v233, v42, v233
v_mul_f32 v234, v42, v234
v_mul_f32 v235, v42, v235
v_mul_f32 v244, v42, v244
v_mul_f32 v245, v42, v245
v_mul_f32 v246, v42, v246
v_mul_f32 v247, v42, v247
v_accvgpr_read_b32 v41, a56
v_mul_f32 v41, v42, v41
v_accvgpr_write_b32 a56, v41
v_accvgpr_read_b32 v41, a57
v_mul_f32 v41, v42, v41
v_accvgpr_write_b32 a57, v41
v_accvgpr_read_b32 v41, a58
v_mul_f32 v41, v42, v41
v_accvgpr_write_b32 a58, v41
v_accvgpr_read_b32 v41, a59
v_mul_f32 v41, v42, v41
v_accvgpr_write_b32 a59, v41
s_branch L_cont_t2
L_rare_t3:
v_max3_f32 v41, v76, v77, v78
v_max3_f32 v42, v79, v88, v89
v_max3_f32 v41, v41, v90, v91
v_max3_f32 v41, v41, v42, 0
v_mov_b32 v42, v41
s_nop 1
v_permlane16_swap_b32 v42, v41
v_max_f32 v41, v41, v42
v_mov_b32 v42, v41
s_nop 1
v_permlane32_swap_b32 v42, v41
v_max_f32 v41, v41, v42
v_add_f32 v34, v34, v41
v_sub_f32 v76, v76, v41
v_sub_f32 v88, v88, v41
v_sub_f32 v77, v77, v41
v_sub_f32 v89, v89, v41
v_sub_f32 v78, v78, v41
v_sub_f32 v90, v90, v41
v_sub_f32 v79, v79, v41
v_sub_f32 v91, v91, v41
v_sub_f32 v42, 0, v41
v_exp_f32 v42, v42
s_nop 0
v_mul_f32 v152, v42, v152
v_mul_f32 v153, v42, v153
v_mul_f32 v154, v42, v154
v_mul_f32 v155, v42, v155
v_mul_f32 v164, v42, v164
v_mul_f32 v165, v42, v165
v_mul_f32 v166, v42, v166
v_mul_f32 v167, v42, v167
v_mul_f32 v176, v42, v176
v_mul_f32 v177, v42, v177
v_mul_f32 v178, v42, v178
v_mul_f32 v179, v42, v179
v_mul_f32 v188, v42, v188
v_mul_f32 v189, v42, v189
v_mul_f32 v190, v42, v190
v_mul_f32 v191, v42, v191
v_mul_f32 v200, v42, v200
v_mul_f32 v201, v42, v201
v_mul_f32 v202, v42, v202
v_mul_f32 v203, v42, v203
v_mul_f32 v212, v42, v212
v_mul_f32 v213, v42, v213
v_mul_f32 v214, v42, v214
v_mul_f32 v215, v42, v215
v_mul_f32 v224, v42, v224
v_mul_f32 v225, v42, v225
v_mul_f32 v226, v42, v226
v_mul_f32 v227, v42, v227
v_mul_f32 v236, v42, v236
v_mul_f32 v237, v42, v237
v_mul_f32 v238, v42, v238
v_mul_f32 v239, v42, v239
v_accvgpr_read_b32 v41, a48
v_mul_f32 v41, v42, v41
v_accvgpr_write_b32 a48, v41
v_accvgpr_read_b32 v41, a49
v_mul_f32 v41, v42, v41
v_accvgpr_write_b32 a49, v41
v_accvgpr_read_b32 v41, a50
v_mul_f32 v41, v42, v41
v_accvgpr_write_b32 a50, v41
v_accvgpr_read_b32 v41, a51
v_mul_f32 v41, v42, v41
v_accvgpr_write_b32 a51, v41
v_max3_f32 v41, v80, v81, v82
v_max3_f32 v42, v83, v92, v93
v_max3_f32 v41, v41, v94, v95
v_max3_f32 v41, v41, v42, 0
v_mov_b32 v42, v41
s_nop 1
v_permlane16_swap_b32 v42, v41
v_max_f32 v41, v41, v42
v_mov_b32 v42, v41
s_nop 1
v_permlane32_swap_b32 v42, v41
v_max_f32 v41, v41, v42
v_add_f32 v35, v35, v41
v_sub_f32 v80, v80, v41
v_sub_f32 v92, v92, v41
v_sub_f32 v81, v81, v41
v_sub_f32 v93, v93, v41
v_sub_f32 v82, v82, v41
v_sub_f32 v94, v94, v41
v_sub_f32 v83, v83, v41
v_sub_f32 v95, v95, v41
v_sub_f32 v42, 0, v41
v_exp_f32 v42, v42
s_nop 0
v_mul_f32 v156, v42, v156
v_mul_f32 v157, v42, v157
v_mul_f32 v158, v42, v158
v_mul_f32 v159, v42, v159
v_mul_f32 v168, v42, v168
v_mul_f32 v169, v42, v169
v_mul_f32 v170, v42, v170
v_mul_f32 v171, v42, v171
v_mul_f32 v180, v42, v180
v_mul_f32 v181, v42, v181
v_mul_f32 v182, v42, v182
v_mul_f32 v183, v42, v183
v_mul_f32 v192, v42, v192
v_mul_f32 v193, v42, v193
v_mul_f32 v194, v42, v194
v_mul_f32 v195, v42, v195
v_mul_f32 v204, v42, v204
v_mul_f32 v205, v42, v205
v_mul_f32 v206, v42, v206
v_mul_f32 v207, v42, v207
v_mul_f32 v216, v42, v216
v_mul_f32 v217, v42, v217
v_mul_f32 v218, v42, v218
v_mul_f32 v219, v42, v219
v_mul_f32 v228, v42, v228
v_mul_f32 v229, v42, v229
v_mul_f32 v230, v42, v230
v_mul_f32 v231, v42, v231
v_mul_f32 v240, v42, v240
v_mul_f32 v241, v42, v241
v_mul_f32 v242, v42, v242
v_mul_f32 v243, v42, v243
v_accvgpr_read_b32 v41, a52
v_mul_f32 v41, v42, v41
v_accvgpr_write_b32 a52, v41
v_accvgpr_read_b32 v41, a53
v_mul_f32 v41, v42, v41
v_accvgpr_write_b32 a53, v41
v_accvgpr_read_b32 v41, a54
v_mul_f32 v41, v42, v41
v_accvgpr_write_b32 a54, v41
v_accvgpr_read_b32 v41, a55
v_mul_f32 v41, v42, v41
v_accvgpr_write_b32 a55, v41
v_max3_f32 v41, v84, v85, v86
v_max3_f32 v42, v87, v96, v97
v_max3_f32 v41, v41, v98, v99
v_max3_f32 v41, v41, v42, 0
v_mov_b32 v42, v41
s_nop 1
v_permlane16_swap_b32 v42, v41
v_max_f32 v41, v41, v42
v_mov_b32 v42, v41
s_nop 1
v_permlane32_swap_b32 v42, v41
v_max_f32 v41, v41, v42
v_add_f32 v36, v36, v41
v_sub_f32 v84, v84, v41
v_sub_f32 v96, v96, v41
v_sub_f32 v85, v85, v41
v_sub_f32 v97, v97, v41
v_sub_f32 v86, v86, v41
v_sub_f32 v98, v98, v41
v_sub_f32 v87, v87, v41
v_sub_f32 v99, v99, v41
v_sub_f32 v42, 0, v41
v_exp_f32 v42, v42
s_nop 0
v_mul_f32 v160, v42, v160
v_mul_f32 v161, v42, v161
v_mul_f32 v162, v42, v162
v_mul_f32 v163, v42, v163
v_mul_f32 v172, v42, v172
v_mul_f32 v173, v42, v173
v_mul_f32 v174, v42, v174
v_mul_f32 v175, v42, v175
v_mul_f32 v184, v42, v184
v_mul_f32 v185, v42, v185
v_mul_f32 v186, v42, v186
v_mul_f32 v187, v42, v187
v_mul_f32 v196, v42, v196
v_mul_f32 v197, v42, v197
v_mul_f32 v198, v42, v198
v_mul_f32 v199, v42, v199
v_mul_f32 v208, v42, v208
v_mul_f32 v209, v42, v209
v_mul_f32 v210, v42, v210
v_mul_f32 v211, v42, v211
v_mul_f32 v220, v42, v220
v_mul_f32 v221, v42, v221
v_mul_f32 v222, v42, v222
v_mul_f32 v223, v42, v223
v_mul_f32 v232, v42, v232
v_mul_f32 v233, v42, v233
v_mul_f32 v234, v42, v234
v_mul_f32 v235, v42, v235
v_mul_f32 v244, v42, v244
v_mul_f32 v245, v42, v245
v_mul_f32 v246, v42, v246
v_mul_f32 v247, v42, v247
v_accvgpr_read_b32 v41, a56
v_mul_f32 v41, v42, v41
v_accvgpr_write_b32 a56, v41
v_accvgpr_read_b32 v41, a57
v_mul_f32 v41, v42, v41
v_accvgpr_write_b32 a57, v41
v_accvgpr_read_b32 v41, a58
v_mul_f32 v41, v42, v41
v_accvgpr_write_b32 a58, v41
v_accvgpr_read_b32 v41, a59
v_mul_f32 v41, v42, v41
v_accvgpr_write_b32 a59, v41
s_branch L_cont_t3
L_end:
s_endpgm
.section .rodata,"a"
.p2align 6
.amdhsa_kernel standalone__mha_block_cached__near_ridge_kernel
  .amdhsa_next_free_vgpr 512
  .amdhsa_next_free_sgpr 100
  .amdhsa_accum_offset 256
  .amdhsa_group_segment_fixed_size 0
  .amdhsa_kernarg_size 64
  .amdhsa_user_sgpr_count 2
  .amdhsa_user_sgpr_kernarg_segment_ptr 1
  .amdhsa_system_sgpr_workgroup_id_x 1
  .amdhsa_float_denorm_mode_32 3
.end_amdhsa_kernel
```
